```python
import torch

def _softmax(x, axis=-1):
    return torch.softmax(x, dim=axis)

def _gelu(x):
    return torch.nn.functional.gelu(x, approximate='tanh')

def _silu(x):
    return torch.nn.functional.silu(x)

def _sigmoid(x):
    return torch.sigmoid(x)

def _layernorm(x, axis=-1, eps=1e-05):
    m = x.mean(dim=axis, keepdim=True)
    v = x.var(dim=axis, keepdim=True, unbiased=False)
    return (x - m) / torch.sqrt(v + eps)

def _scatter_add(tgt, idx, src, axis=0):
    return tgt.clone().index_add_(axis, idx, src)

def _segment_sum(src, seg, n):
    out = torch.zeros((n,) + src.shape[1:], dtype=src.dtype)
    return out.index_add_(0, seg, src)

def _pad(x, pw):
    flat = tuple((v for pair in reversed(pw) for v in pair))
    return torch.nn.functional.pad(x, flat)
kernel_name = 'concat_heads__linear_attn_block__memory_aug_recurrent_mem_tr__prompt'

def setup_inputs():

    _w = lambda a: (lambda t: t.to(torch.bfloat16) if t.is_floating_point() else t)(torch.as_tensor(a))

    def _A_setup():
        B, S, D = (1, 2048, 512)
        return {'x': _w((lambda *s: torch.randn(*s, dtype=torch.bfloat16) * 0.05)(B, S, D)), 'wqkv': _w((lambda *s: torch.randn(*s, dtype=torch.bfloat16) * 0.4)(D, 3 * D)), 'wo': _w((lambda *s: torch.randn(*s, dtype=torch.bfloat16) * 0.1)(D, D))}
    _A_in = _A_setup()

    def _B_setup():
        B, S, Dm = (1, 2048, 512)
        H, Dh = (32, 128)
        M, seg = (8, 32)
        seg = min(seg, S)
        S = S // seg * seg
        return {'x': _w((lambda *s: torch.randn(*s, dtype=torch.bfloat16) * 0.05)(B, S, Dm)), 'mem0': _w((lambda *s: torch.randn(*s, dtype=torch.bfloat16) * 0.4)(B, M, Dm)), 'Wq': _w((lambda *s: torch.randn(*s, dtype=torch.bfloat16) * 6.4)(Dm, H, Dh) * Dm ** (-0.5)), 'Wk': _w((lambda *s: torch.randn(*s, dtype=torch.bfloat16) * 6.4)(Dm, H, Dh) * Dm ** (-0.5)), 'Wv': _w((lambda *s: torch.randn(*s, dtype=torch.bfloat16) * 0.4)(Dm, H, Dh) * Dm ** (-0.5)), 'Wo': _w((lambda *s: torch.randn(*s, dtype=torch.bfloat16) * 0.4)(H, Dh, Dm) * (H * Dh) ** (-0.5)), 'seg_len': seg}
    _B_in = _B_setup()
    return {'A_x': _A_in['x'], 'A_wqkv': _A_in['wqkv'], 'A_wo': _A_in['wo'], 'B_x': _B_in['x'], 'B_mem0': _B_in['mem0'], 'B_Wq': _B_in['Wq'], 'B_Wk': _B_in['Wk'], 'B_Wv': _B_in['Wv'], 'B_Wo': _B_in['Wo'], 'B_seg_len': _B_in['seg_len']}

def reference(A_x, A_wqkv, A_wo, B_x, B_mem0, B_Wq, B_Wk, B_Wv, B_Wo, B_seg_len):

    def _A_ref(x, wqkv, wo):
        B, S, D = x.shape
        H = 32
        Dh = D // H
        qkv = (lambda x, *d: x.permute(*d))((x @ wqkv).reshape(B, S, 3, H, Dh), 2, 0, 3, 1, 4)
        q, k, v = (qkv[0], qkv[1], qkv[2])
        phi = lambda t: torch.where(t > 0, t + 1, torch.exp(t)) + 1e-06
        pq, pk = (phi(q), phi(k))
        kv = torch.einsum('bhsd,bhse->bhde', pk, v)
        z = torch.einsum('bhsd->bhd', pk)
        num = torch.einsum('bhqd,bhde->bhqe', pq, kv)
        den = torch.einsum('bhqd,bhd->bhq', pq, z)[..., None] + 1e-06
        o = num / den
        return (lambda x, *d: x.permute(*d))(o, 0, 2, 1, 3).reshape(B, S, D) @ wo

    def _B_ref(x, mem0, Wq, Wk, Wv, Wo, seg_len):
        B, S, Dm = x.shape
        H, Dh = (Wq.shape[1], Wq.shape[2])
        M = mem0.shape[1]
        scale = Dh ** (-0.5)
        n_seg = S // seg_len
        L = M + seg_len
        idx = torch.arange(L)
        mask = (idx[:, None] < M) | (idx[:, None] >= idx[None, :])
        mem = mem0
        outs = []
        for s in range(n_seg):
            xs = x[:, s * seg_len:(s + 1) * seg_len, :].clone()
            h = torch.concatenate([mem, xs], axis=1)
            q = torch.einsum('btd,dhe->bhte', h, Wq)
            k = torch.einsum('btd,dhe->bhte', h, Wk)
            v = torch.einsum('btd,dhe->bhte', h, Wv)
            scores = torch.einsum('bhqe,bhke->bhqk', q, k) * scale
            scores = torch.where(mask[None, None], scores, -1000000000.0)
            p = _softmax(scores, axis=-1)
            o = torch.einsum('bhqk,bhke->bhqe', p, v)
            o = torch.einsum('bhte,hed->btd', o, Wo)
            mem = o[:, :M, :].clone()
            outs.append(o[:, M:, :])
        return torch.concatenate(outs, axis=1)
    a = _A_ref(A_x, A_wqkv, A_wo)
    b = _B_ref(B_x, B_mem0, B_Wq, B_Wk, B_Wv, B_Wo, B_seg_len)
    return torch.concatenate([a, b], axis=-1)
```

```asm
; @launch grid=(256,1,1) block=(256,1,1) lds=163840
.amdgcn_target "amdgcn-amd-amdhsa--gfx950"
.text
.globl concat_heads__linear_attn_block__memory_aug_recurrent_mem_tr__prompt_kernel
.p2align 8
.type concat_heads__linear_attn_block__memory_aug_recurrent_mem_tr__prompt_kernel,@function
concat_heads__linear_attn_block__memory_aug_recurrent_mem_tr__prompt_kernel:
    s_cmp_ge_u32 s2, 256
    s_cbranch_scc1 L_exit
    s_load_dwordx16 s[64:79], s[0:1], 0
    s_load_dwordx8 s[80:87], s[0:1], 64
    s_load_dwordx2 s[88:89], s[0:1], 96
    s_getreg_b32 s26, hwreg(HW_REG_XCC_ID, 0, 4)
    v_lshrrev_b32 v1, 6, v0
    s_nop 0
    v_readfirstlane_b32 s24, v1
    v_and_b32 v0, 63, v0
    s_mov_b32 s27, 0x80000
    s_waitcnt lgkmcnt(0)
    s_mov_b32 s4, s88
    s_and_b32 s5, s89, 0xffff
    s_mov_b32 s6, 268435456
    s_mov_b32 s7, 0x20000
    s_mov_b32 s8, s86
    s_and_b32 s9, s87, 0xffff
    s_mov_b32 s10, 256
    s_mov_b32 s11, 0x20000
    s_mov_b32 s20, s84
    s_and_b32 s21, s85, 0xffff
    s_mov_b32 s22, 4194304
    s_mov_b32 s23, 0x20000
    s_cmp_lg_u32 s24, 0
    s_cbranch_scc1 L_tk_wait
    s_lshl_b32 s28, s26, 5
    v_mov_b32 v1, s28
    v_mov_b32 v2, 1
    v_mov_b32 v3, 163824
    s_mov_b64 exec, 1
    buffer_atomic_add v2, v1, s[8:11], 0 offen sc0
    s_waitcnt vmcnt(0)
    ds_write_b32 v3, v2
    s_waitcnt lgkmcnt(0)
    s_mov_b64 exec, -1
L_tk_wait:
    s_barrier
    v_mov_b32 v3, 163824
    ds_read_b32 v2, v3
    s_waitcnt lgkmcnt(0)
    v_readfirstlane_b32 s25, v2
    s_barrier
    s_cmp_ge_u32 s25, 32
    s_cbranch_scc1 L_exit
    s_cmp_eq_u32 s26, 0
    s_cbranch_scc1 L_role_r
    s_cmp_eq_u32 s26, 7
    s_cbranch_scc1 L_role_wa
    s_cmp_gt_u32 s26, 7
    s_cbranch_scc0 L_role_wb
L_exit:
    s_endpgm
L_role_r:
    v_mov_b32 v100, v0
    s_lshl_b32 s31, s25, 8
    v_bfe_u32 v107, v100, 5, 1
    v_mul_u32_u24 v101, 64, v107
    v_bfe_u32 v107, v100, 4, 1
    v_mul_u32_u24 v107, 1, v107
    v_add_u32 v101, v101, v107
    s_and_b32 s29, s24, 1
    s_mul_i32 s29, s29, 2
    s_lshr_b32 s30, s24, 1
    s_mul_i32 s30, s30, 256
    s_add_u32 s29, s29, s30
    v_add_u32 v101, s29, v101
    s_mov_b32 s29, 8192
    v_mul_lo_u32 v101, v101, s29
    v_lshrrev_b32 v107, 3, v100
    v_and_b32 v107, 6, v107
    v_xor_b32 v107, v107, v100
    v_and_b32 v107, 15, v107
    v_lshlrev_b32 v107, 4, v107
    v_add3_u32 v101, v101, v107, s31
    s_lshl_b32 s29, s25, 17
    s_lshl_b32 s30, s24, 8
    s_add_u32 s31, s29, s30
    v_bfe_u32 v107, v100, 5, 1
    v_mul_u32_u24 v102, 16, v107
    v_bfe_u32 v107, v100, 4, 1
    v_mul_u32_u24 v107, 1, v107
    v_add_u32 v102, v102, v107
    s_mov_b32 s29, 1024
    v_mul_lo_u32 v102, v102, s29
    v_lshrrev_b32 v107, 3, v100
    v_and_b32 v107, 6, v107
    v_xor_b32 v107, v107, v100
    v_and_b32 v107, 15, v107
    v_lshlrev_b32 v107, 4, v107
    v_add3_u32 v102, v102, v107, s31
    v_lshrrev_b32 v107, 2, v100
    v_lshlrev_b32 v103, 8, v107
    v_and_b32 v107, 7, v107
    v_lshl_add_u32 v103, v107, 5, v103
    v_and_b32 v107, 3, v100
    v_lshl_add_u32 v103, v107, 3, v103
    v_lshlrev_b32 v1, 4, v100
    s_lshl_b32 s28, s24, 12
    s_add_u32 s28, s28, 32768
    s_mov_b32 s12, s74
    s_and_b32 s13, s75, 0xffff
    s_mov_b32 s14, 4194304
    s_mov_b32 s15, 0x20000
    v_xor_b32 v104, 0x80, v101
    s_add_u32 m0, s28, 0
    s_mov_b32 s29, 0
    buffer_load_dwordx4 v101, s[12:15], s29 offen  lds
    s_add_u32 m0, s28, 1024
    s_mov_b32 s29, 32768
    buffer_load_dwordx4 v104, s[12:15], s29 offen  lds
    s_add_u32 m0, s28, 2048
    s_mov_b32 s29, 1048576
    buffer_load_dwordx4 v101, s[12:15], s29 offen  lds
    s_add_u32 m0, s28, 3072
    s_mov_b32 s29, 1081344
    buffer_load_dwordx4 v104, s[12:15], s29 offen  lds
    s_add_u32 m0, s28, 16384
    s_mov_b32 s29, 65536
    buffer_load_dwordx4 v101, s[12:15], s29 offen  lds
    s_add_u32 m0, s28, 17408
    s_mov_b32 s29, 98304
    buffer_load_dwordx4 v104, s[12:15], s29 offen  lds
    s_add_u32 m0, s28, 18432
    s_mov_b32 s29, 1114112
    buffer_load_dwordx4 v101, s[12:15], s29 offen  lds
    s_add_u32 m0, s28, 19456
    s_mov_b32 s29, 1146880
    buffer_load_dwordx4 v104, s[12:15], s29 offen  lds
    s_add_u32 m0, s28, 32768
    s_mov_b32 s29, 131072
    buffer_load_dwordx4 v101, s[12:15], s29 offen  lds
    s_add_u32 m0, s28, 33792
    s_mov_b32 s29, 163840
    buffer_load_dwordx4 v104, s[12:15], s29 offen  lds
    s_add_u32 m0, s28, 34816
    s_mov_b32 s29, 1179648
    buffer_load_dwordx4 v101, s[12:15], s29 offen  lds
    s_add_u32 m0, s28, 35840
    s_mov_b32 s29, 1212416
    buffer_load_dwordx4 v104, s[12:15], s29 offen  lds
    s_add_u32 m0, s28, 49152
    s_mov_b32 s29, 196608
    buffer_load_dwordx4 v101, s[12:15], s29 offen  lds
    s_add_u32 m0, s28, 50176
    s_mov_b32 s29, 229376
    buffer_load_dwordx4 v104, s[12:15], s29 offen  lds
    s_add_u32 m0, s28, 51200
    s_mov_b32 s29, 1245184
    buffer_load_dwordx4 v101, s[12:15], s29 offen  lds
    s_add_u32 m0, s28, 52224
    s_mov_b32 s29, 1277952
    buffer_load_dwordx4 v104, s[12:15], s29 offen  lds
    s_add_u32 m0, s28, 65536
    s_mov_b32 s29, 262144
    buffer_load_dwordx4 v101, s[12:15], s29 offen  lds
    s_add_u32 m0, s28, 66560
    s_mov_b32 s29, 294912
    buffer_load_dwordx4 v104, s[12:15], s29 offen  lds
    s_add_u32 m0, s28, 67584
    s_mov_b32 s29, 1310720
    buffer_load_dwordx4 v101, s[12:15], s29 offen  lds
    s_add_u32 m0, s28, 68608
    s_mov_b32 s29, 1343488
    buffer_load_dwordx4 v104, s[12:15], s29 offen  lds
    s_add_u32 m0, s28, 81920
    s_mov_b32 s29, 327680
    buffer_load_dwordx4 v101, s[12:15], s29 offen  lds
    s_add_u32 m0, s28, 82944
    s_mov_b32 s29, 360448
    buffer_load_dwordx4 v104, s[12:15], s29 offen  lds
    s_add_u32 m0, s28, 83968
    s_mov_b32 s29, 1376256
    buffer_load_dwordx4 v101, s[12:15], s29 offen  lds
    s_add_u32 m0, s28, 84992
    s_mov_b32 s29, 1409024
    buffer_load_dwordx4 v104, s[12:15], s29 offen  lds
    s_add_u32 m0, s28, 98304
    s_mov_b32 s29, 393216
    buffer_load_dwordx4 v101, s[12:15], s29 offen  lds
    s_add_u32 m0, s28, 99328
    s_mov_b32 s29, 425984
    buffer_load_dwordx4 v104, s[12:15], s29 offen  lds
    s_add_u32 m0, s28, 100352
    s_mov_b32 s29, 1441792
    buffer_load_dwordx4 v101, s[12:15], s29 offen  lds
    s_add_u32 m0, s28, 101376
    s_mov_b32 s29, 1474560
    buffer_load_dwordx4 v104, s[12:15], s29 offen  lds
    s_add_u32 m0, s28, 114688
    s_mov_b32 s29, 458752
    buffer_load_dwordx4 v101, s[12:15], s29 offen  lds
    s_add_u32 m0, s28, 115712
    s_mov_b32 s29, 491520
    buffer_load_dwordx4 v104, s[12:15], s29 offen  lds
    s_add_u32 m0, s28, 116736
    s_mov_b32 s29, 1507328
    buffer_load_dwordx4 v101, s[12:15], s29 offen  lds
    s_add_u32 m0, s28, 117760
    s_mov_b32 s29, 1540096
    buffer_load_dwordx4 v104, s[12:15], s29 offen  lds
    s_waitcnt vmcnt(28)
    s_barrier
    s_lshl_b32 s29, s24, 6
    v_xor_b32 v105, s29, v103
    v_add_u32 v105, 32768, v105
    v_xor_b32 v106, 32, v105
    ds_read_b64_tr_b16 v[128:129], v105 offset:0
    ds_read_b64_tr_b16 v[130:131], v105 offset:4096
    ds_read_b64_tr_b16 v[132:133], v105 offset:8192
    ds_read_b64_tr_b16 v[134:135], v105 offset:12288
    ds_read_b64_tr_b16 v[136:137], v106 offset:0
    ds_read_b64_tr_b16 v[138:139], v106 offset:4096
    ds_read_b64_tr_b16 v[140:141], v106 offset:8192
    ds_read_b64_tr_b16 v[142:143], v106 offset:12288
    s_waitcnt lgkmcnt(0)
    v_and_b32 v20, 15, v100
    v_lshrrev_b32 v21, 4, v100
    v_cmp_gt_u32 s[42:43], 8, v20
    v_and_b32 v22, 2, v20
    v_cmp_eq_u32 vcc, 0, v22
    s_mov_b64 s[44:45], vcc
    v_mov_b32 v22, 0x4444
    v_mov_b32 v23, 0xeeee
    v_cndmask_b32 v0, v23, v22, vcc
    v_mov_b32 v22, -1
    v_cndmask_b32 v6, 0, v22, vcc
    v_not_b32 v7, v6
    s_lshl_b32 s29, s24, 12
    s_add_u32 s29, s29, 32768
    v_add_u32 v2, s29, v1
    v_add_u32 v3, 0x10000, v2
    s_lshl_b32 s29, s24, 16
    s_lshl_b32 s30, s25, 8
    s_add_u32 s29, s29, s30
    s_add_u32 s29, s29, 262144
    v_lshlrev_b32 v4, 13, v21
    v_lshl_add_u32 v4, v20, 4, v4
    v_add_u32 v4, s29, v4
    s_lshr_b32 s29, s25, 3
    s_lshl_b32 s29, s29, 8
    s_and_b32 s30, s25, 3
    s_lshl_b32 s30, s30, 6
    s_add_u32 s29, s29, s30
    s_and_b32 s30, s25, 4
    s_lshl_b32 s30, s30, 3
    s_add_u32 s29, s29, s30
    v_bfe_u32 v22, v20, 1, 2
    v_and_b32 v23, 1, v20
    v_lshlrev_b32 v5, 11, v22
    v_lshl_add_u32 v5, v23, 4, v5
    v_lshrrev_b32 v24, 1, v21
    v_lshl_add_u32 v5, v24, 10, v5
    v_and_b32 v24, 1, v21
    v_lshl_add_u32 v5, v24, 3, v5
    v_add_u32 v5, s29, v5
    s_lshr_b32 s29, s25, 2
    s_lshl_b32 s29, s29, 10
    s_and_b32 s30, s25, 3
    s_lshl_b32 s30, s30, 5
    s_add_u32 s29, s29, s30
    v_lshlrev_b32 v16, 8, v22
    v_lshl_add_u32 v16, v23, 4, v16
    v_lshrrev_b32 v24, 1, v21
    v_lshl_add_u32 v16, v24, 7, v16
    v_and_b32 v24, 1, v21
    v_lshl_add_u32 v16, v24, 3, v16
    v_add_u32 v16, s29, v16
    v_mov_b32 v24, 0x20000000
    v_cndmask_b32 v5, v24, v5, s[42:43]
    s_lshr_b32 s29, s25, 2
    s_lshl_b32 s29, s29, 7
    s_and_b32 s30, s25, 3
    s_lshl_b32 s30, s30, 11
    s_add_u32 s29, s29, s30
    v_lshlrev_b32 v125, 10, v23
    v_lshl_add_u32 v125, v22, 5, v125
    v_lshl_add_u32 v125, v21, 3, v125
    v_add_u32 v125, s29, v125
    v_mov_b32 v25, 0x3f80
    v_mov_b32 v26, 0x3f800000
    v_cmp_eq_u32 vcc, 0, v23
    s_nop 1
    v_cndmask_b32 v27, v26, v25, vcc
    v_lshrrev_b32 v24, 2, v20
    v_cmp_eq_u32 vcc, v24, v21
    s_nop 1
    v_cndmask_b32 v27, 0, v27, vcc
    v_and_b32 v12, v6, v27
    v_and_b32 v13, v6, v27
    v_and_b32 v14, v7, v27
    v_and_b32 v15, v7, v27
    v_cmp_eq_u32 vcc, 0, v20
    s_nop 1
    v_cndmask_b32 v8, 0, v25, vcc
    v_cmp_eq_u32 vcc, 1, v20
    s_nop 1
    v_cndmask_b32 v8, v8, v26, vcc
    v_cmp_eq_u32 vcc, 2, v20
    s_nop 1
    v_cndmask_b32 v9, 0, v25, vcc
    v_cmp_eq_u32 vcc, 3, v20
    s_nop 1
    v_cndmask_b32 v9, v9, v26, vcc
    v_cmp_eq_u32 vcc, 4, v20
    s_nop 1
    v_cndmask_b32 v10, 0, v25, vcc
    v_cmp_eq_u32 vcc, 5, v20
    s_nop 1
    v_cndmask_b32 v10, v10, v26, vcc
    v_cmp_eq_u32 vcc, 6, v20
    s_nop 1
    v_cndmask_b32 v11, 0, v25, vcc
    v_cmp_eq_u32 vcc, 7, v20
    s_nop 1
    v_cndmask_b32 v11, v11, v26, vcc
    s_mov_b32 s46, 1040356334
    s_mov_b32 s47, 1040356334
    s_lshl_b32 s39, s25, 13
    s_add_u32 s39, s39, 262144
    s_add_u32 s49, s39, 4096
    s_lshl_b32 s53, s24, 10
    s_lshl_b32 s54, s24, 2
    s_lshr_b32 s29, s24, 1
    s_lshl_b32 s29, s29, 10
    s_and_b32 s30, s24, 1
    s_lshl_b32 s30, s30, 3
    s_add_u32 s55, s29, s30
    v_add_u32 v17, s53, v1
    s_cmp_eq_u32 s24, 0
    s_cselect_b64 vcc, s[42:43], 0
    v_mov_b32 v24, 0x20000000
    v_cndmask_b32 v16, v24, v16, vcc
    s_mul_i32 s36, s25, 1572864
    s_lshl_b32 s29, s24, 11
    s_add_u32 s36, s36, s29
    s_add_u32 s36, s36, 41951232
    v_lshlrev_b32 v19, 7, v20
    v_lshl_add_u32 v19, v21, 13, v19
    s_sub_u32 s29, 93347840, s36
    s_lshl_b32 s30, s25, 8
    s_add_u32 s30, s30, s29
    v_lshlrev_b32 v24, 7, v23
    v_add_u32 v24, s30, v24
    v_cmp_eq_u32 vcc, 2, v21
    s_nop 1
    v_cndmask_b32 v19, v19, v24, vcc
    s_lshl_b32 s30, s25, 7
    s_add_u32 s30, s30, s29
    s_add_u32 s30, s30, 8192
    v_mov_b32 v24, s30
    v_cmp_eq_u32 vcc, 3, v21
    s_nop 1
    v_cndmask_b32 v19, v19, v24, vcc
    s_mov_b32 s57, 32768
    s_mov_b32 s32, 0
    s_mov_b32 s33, 93323264
    s_mov_b32 s48, 93327360
    s_mov_b32 s35, 1
    s_add_u32 s51, s36, 8192
    s_mov_b32 s50, 8388608
    s_mov_b32 s59, 0
    s_lshl_b32 s37, s25, 7
    s_add_u32 s37, s37, 93331456
    s_mov_b32 s16, s72
    s_and_b32 s17, s73, 0xffff
    s_mov_b32 s18, 8192
    s_mov_b32 s19, 0x20000
    buffer_load_dwordx2 v[126:127], v125, s[16:19], 0 offen
    s_waitcnt vmcnt(25)
    s_barrier
    s_mov_b32 s12, s78
    s_and_b32 s13, s79, 0xffff
    s_mov_b32 s14, 4194304
    s_mov_b32 s15, 0x20000
    s_add_u32 m0, s28, 0
    s_mov_b32 s29, 0
    buffer_load_dwordx4 v101, s[12:15], s29 offen  lds
    s_add_u32 m0, s28, 1024
    s_mov_b32 s29, 32768
    buffer_load_dwordx4 v104, s[12:15], s29 offen  lds
    s_add_u32 m0, s28, 2048
    s_mov_b32 s29, 1048576
    buffer_load_dwordx4 v101, s[12:15], s29 offen  lds
    s_add_u32 m0, s28, 3072
    s_mov_b32 s29, 1081344
    buffer_load_dwordx4 v104, s[12:15], s29 offen  lds
    s_lshl_b32 s29, s24, 6
    v_xor_b32 v105, s29, v103
    v_add_u32 v105, 49152, v105
    v_xor_b32 v106, 32, v105
    ds_read_b64_tr_b16 v[144:145], v105 offset:0
    ds_read_b64_tr_b16 v[146:147], v105 offset:4096
    ds_read_b64_tr_b16 v[148:149], v105 offset:8192
    ds_read_b64_tr_b16 v[150:151], v105 offset:12288
    ds_read_b64_tr_b16 v[152:153], v106 offset:0
    ds_read_b64_tr_b16 v[154:155], v106 offset:4096
    ds_read_b64_tr_b16 v[156:157], v106 offset:8192
    ds_read_b64_tr_b16 v[158:159], v106 offset:12288
    s_waitcnt lgkmcnt(0)
    s_waitcnt vmcnt(25)
    s_barrier
    s_add_u32 m0, s28, 16384
    s_mov_b32 s29, 65536
    buffer_load_dwordx4 v101, s[12:15], s29 offen  lds
    s_add_u32 m0, s28, 17408
    s_mov_b32 s29, 98304
    buffer_load_dwordx4 v104, s[12:15], s29 offen  lds
    s_add_u32 m0, s28, 18432
    s_mov_b32 s29, 1114112
    buffer_load_dwordx4 v101, s[12:15], s29 offen  lds
    s_add_u32 m0, s28, 19456
    s_mov_b32 s29, 1146880
    buffer_load_dwordx4 v104, s[12:15], s29 offen  lds
    s_lshl_b32 s29, s24, 6
    v_xor_b32 v105, s29, v103
    v_add_u32 v105, 65536, v105
    v_xor_b32 v106, 32, v105
    ds_read_b64_tr_b16 v[160:161], v105 offset:0
    ds_read_b64_tr_b16 v[162:163], v105 offset:4096
    ds_read_b64_tr_b16 v[164:165], v105 offset:8192
    ds_read_b64_tr_b16 v[166:167], v105 offset:12288
    ds_read_b64_tr_b16 v[168:169], v106 offset:0
    ds_read_b64_tr_b16 v[170:171], v106 offset:4096
    ds_read_b64_tr_b16 v[172:173], v106 offset:8192
    ds_read_b64_tr_b16 v[174:175], v106 offset:12288
    s_waitcnt lgkmcnt(0)
    s_waitcnt vmcnt(25)
    s_barrier
    s_add_u32 m0, s28, 32768
    s_mov_b32 s29, 131072
    buffer_load_dwordx4 v101, s[12:15], s29 offen  lds
    s_add_u32 m0, s28, 33792
    s_mov_b32 s29, 163840
    buffer_load_dwordx4 v104, s[12:15], s29 offen  lds
    s_add_u32 m0, s28, 34816
    s_mov_b32 s29, 1179648
    buffer_load_dwordx4 v101, s[12:15], s29 offen  lds
    s_add_u32 m0, s28, 35840
    s_mov_b32 s29, 1212416
    buffer_load_dwordx4 v104, s[12:15], s29 offen  lds
    s_lshl_b32 s29, s24, 6
    v_xor_b32 v105, s29, v103
    v_add_u32 v105, 81920, v105
    v_xor_b32 v106, 32, v105
    ds_read_b64_tr_b16 v[176:177], v105 offset:0
    ds_read_b64_tr_b16 v[178:179], v105 offset:4096
    ds_read_b64_tr_b16 v[180:181], v105 offset:8192
    ds_read_b64_tr_b16 v[182:183], v105 offset:12288
    ds_read_b64_tr_b16 v[184:185], v106 offset:0
    ds_read_b64_tr_b16 v[186:187], v106 offset:4096
    ds_read_b64_tr_b16 v[188:189], v106 offset:8192
    ds_read_b64_tr_b16 v[190:191], v106 offset:12288
    s_waitcnt lgkmcnt(0)
    s_waitcnt vmcnt(25)
    s_barrier
    s_add_u32 m0, s28, 49152
    s_mov_b32 s29, 196608
    buffer_load_dwordx4 v101, s[12:15], s29 offen  lds
    s_add_u32 m0, s28, 50176
    s_mov_b32 s29, 229376
    buffer_load_dwordx4 v104, s[12:15], s29 offen  lds
    s_add_u32 m0, s28, 51200
    s_mov_b32 s29, 1245184
    buffer_load_dwordx4 v101, s[12:15], s29 offen  lds
    s_add_u32 m0, s28, 52224
    s_mov_b32 s29, 1277952
    buffer_load_dwordx4 v104, s[12:15], s29 offen  lds
    s_lshl_b32 s29, s24, 6
    v_xor_b32 v105, s29, v103
    v_add_u32 v105, 98304, v105
    v_xor_b32 v106, 32, v105
    ds_read_b64_tr_b16 v[192:193], v105 offset:0
    ds_read_b64_tr_b16 v[194:195], v105 offset:4096
    ds_read_b64_tr_b16 v[196:197], v105 offset:8192
    ds_read_b64_tr_b16 v[198:199], v105 offset:12288
    ds_read_b64_tr_b16 v[200:201], v106 offset:0
    ds_read_b64_tr_b16 v[202:203], v106 offset:4096
    ds_read_b64_tr_b16 v[204:205], v106 offset:8192
    ds_read_b64_tr_b16 v[206:207], v106 offset:12288
    s_waitcnt lgkmcnt(0)
    s_waitcnt vmcnt(25)
    s_barrier
    s_add_u32 m0, s28, 65536
    s_mov_b32 s29, 262144
    buffer_load_dwordx4 v101, s[12:15], s29 offen  lds
    s_add_u32 m0, s28, 66560
    s_mov_b32 s29, 294912
    buffer_load_dwordx4 v104, s[12:15], s29 offen  lds
    s_add_u32 m0, s28, 67584
    s_mov_b32 s29, 1310720
    buffer_load_dwordx4 v101, s[12:15], s29 offen  lds
    s_add_u32 m0, s28, 68608
    s_mov_b32 s29, 1343488
    buffer_load_dwordx4 v104, s[12:15], s29 offen  lds
    s_lshl_b32 s29, s24, 6
    v_xor_b32 v105, s29, v103
    v_add_u32 v105, 114688, v105
    v_xor_b32 v106, 32, v105
    ds_read_b64_tr_b16 v[208:209], v105 offset:0
    ds_read_b64_tr_b16 v[210:211], v105 offset:4096
    ds_read_b64_tr_b16 v[212:213], v105 offset:8192
    ds_read_b64_tr_b16 v[214:215], v105 offset:12288
    ds_read_b64_tr_b16 v[216:217], v106 offset:0
    ds_read_b64_tr_b16 v[218:219], v106 offset:4096
    ds_read_b64_tr_b16 v[220:221], v106 offset:8192
    ds_read_b64_tr_b16 v[222:223], v106 offset:12288
    s_waitcnt lgkmcnt(0)
    s_waitcnt vmcnt(25)
    s_barrier
    s_add_u32 m0, s28, 81920
    s_mov_b32 s29, 327680
    buffer_load_dwordx4 v101, s[12:15], s29 offen  lds
    s_add_u32 m0, s28, 82944
    s_mov_b32 s29, 360448
    buffer_load_dwordx4 v104, s[12:15], s29 offen  lds
    s_add_u32 m0, s28, 83968
    s_mov_b32 s29, 1376256
    buffer_load_dwordx4 v101, s[12:15], s29 offen  lds
    s_add_u32 m0, s28, 84992
    s_mov_b32 s29, 1409024
    buffer_load_dwordx4 v104, s[12:15], s29 offen  lds
    s_lshl_b32 s29, s24, 6
    v_xor_b32 v105, s29, v103
    v_add_u32 v105, 131072, v105
    v_xor_b32 v106, 32, v105
    ds_read_b64_tr_b16 v[224:225], v105 offset:0
    ds_read_b64_tr_b16 v[226:227], v105 offset:4096
    ds_read_b64_tr_b16 v[228:229], v105 offset:8192
    ds_read_b64_tr_b16 v[230:231], v105 offset:12288
    ds_read_b64_tr_b16 v[232:233], v106 offset:0
    ds_read_b64_tr_b16 v[234:235], v106 offset:4096
    ds_read_b64_tr_b16 v[236:237], v106 offset:8192
    ds_read_b64_tr_b16 v[238:239], v106 offset:12288
    s_waitcnt lgkmcnt(0)
    s_waitcnt vmcnt(25)
    s_barrier
    s_add_u32 m0, s28, 98304
    s_mov_b32 s29, 393216
    buffer_load_dwordx4 v101, s[12:15], s29 offen  lds
    s_add_u32 m0, s28, 99328
    s_mov_b32 s29, 425984
    buffer_load_dwordx4 v104, s[12:15], s29 offen  lds
    s_add_u32 m0, s28, 100352
    s_mov_b32 s29, 1441792
    buffer_load_dwordx4 v101, s[12:15], s29 offen  lds
    s_add_u32 m0, s28, 101376
    s_mov_b32 s29, 1474560
    buffer_load_dwordx4 v104, s[12:15], s29 offen  lds
    s_lshl_b32 s29, s24, 6
    v_xor_b32 v105, s29, v103
    v_add_u32 v105, 147456, v105
    v_xor_b32 v106, 32, v105
    ds_read_b64_tr_b16 v[240:241], v105 offset:0
    ds_read_b64_tr_b16 v[242:243], v105 offset:4096
    ds_read_b64_tr_b16 v[244:245], v105 offset:8192
    ds_read_b64_tr_b16 v[246:247], v105 offset:12288
    ds_read_b64_tr_b16 v[248:249], v106 offset:0
    ds_read_b64_tr_b16 v[250:251], v106 offset:4096
    ds_read_b64_tr_b16 v[252:253], v106 offset:8192
    ds_read_b64_tr_b16 v[254:255], v106 offset:12288
    s_waitcnt lgkmcnt(0)
    s_waitcnt vmcnt(24)
    s_barrier
    s_add_u32 m0, s28, 114688
    s_mov_b32 s29, 458752
    buffer_load_dwordx4 v101, s[12:15], s29 offen  lds
    s_add_u32 m0, s28, 115712
    s_mov_b32 s29, 491520
    buffer_load_dwordx4 v104, s[12:15], s29 offen  lds
    s_add_u32 m0, s28, 116736
    s_mov_b32 s29, 1507328
    buffer_load_dwordx4 v101, s[12:15], s29 offen  lds
    s_add_u32 m0, s28, 117760
    s_mov_b32 s29, 1540096
    buffer_load_dwordx4 v104, s[12:15], s29 offen  lds
    s_lshl_b32 s29, s24, 6
    v_xor_b32 v105, s29, v103
    v_add_u32 v105, 32768, v105
    v_xor_b32 v106, 32, v105
    ds_read_b64_tr_b16 a[0:1], v105 offset:0
    ds_read_b64_tr_b16 a[2:3], v105 offset:4096
    ds_read_b64_tr_b16 a[4:5], v105 offset:8192
    ds_read_b64_tr_b16 a[6:7], v105 offset:12288
    ds_read_b64_tr_b16 a[8:9], v106 offset:0
    ds_read_b64_tr_b16 a[10:11], v106 offset:4096
    ds_read_b64_tr_b16 a[12:13], v106 offset:8192
    ds_read_b64_tr_b16 a[14:15], v106 offset:12288
    s_waitcnt lgkmcnt(0)
    s_waitcnt vmcnt(24)
    s_barrier
    s_mov_b32 s12, s80
    s_and_b32 s13, s81, 0xffff
    s_mov_b32 s14, 4194304
    s_mov_b32 s15, 0x20000
    v_xor_b32 v104, 0x80, v102
    s_add_u32 m0, s28, 0
    s_mov_b32 s29, 0
    buffer_load_dwordx4 v102, s[12:15], s29 offen  lds
    s_add_u32 m0, s28, 1024
    s_mov_b32 s29, 32768
    buffer_load_dwordx4 v104, s[12:15], s29 offen  lds
    s_add_u32 m0, s28, 2048
    s_mov_b32 s29, 4096
    buffer_load_dwordx4 v102, s[12:15], s29 offen  lds
    s_add_u32 m0, s28, 3072
    s_mov_b32 s29, 36864
    buffer_load_dwordx4 v104, s[12:15], s29 offen  lds
    s_lshl_b32 s29, s24, 6
    v_xor_b32 v105, s29, v103
    v_add_u32 v105, 49152, v105
    v_xor_b32 v106, 32, v105
    ds_read_b64_tr_b16 a[16:17], v105 offset:0
    ds_read_b64_tr_b16 a[18:19], v105 offset:4096
    ds_read_b64_tr_b16 a[20:21], v105 offset:8192
    ds_read_b64_tr_b16 a[22:23], v105 offset:12288
    ds_read_b64_tr_b16 a[24:25], v106 offset:0
    ds_read_b64_tr_b16 a[26:27], v106 offset:4096
    ds_read_b64_tr_b16 a[28:29], v106 offset:8192
    ds_read_b64_tr_b16 a[30:31], v106 offset:12288
    s_waitcnt lgkmcnt(0)
    s_waitcnt vmcnt(24)
    s_barrier
    s_add_u32 m0, s28, 16384
    s_mov_b32 s29, 2048
    buffer_load_dwordx4 v102, s[12:15], s29 offen  lds
    s_add_u32 m0, s28, 17408
    s_mov_b32 s29, 34816
    buffer_load_dwordx4 v104, s[12:15], s29 offen  lds
    s_add_u32 m0, s28, 18432
    s_mov_b32 s29, 6144
    buffer_load_dwordx4 v102, s[12:15], s29 offen  lds
    s_add_u32 m0, s28, 19456
    s_mov_b32 s29, 38912
    buffer_load_dwordx4 v104, s[12:15], s29 offen  lds
    s_lshl_b32 s29, s24, 6
    v_xor_b32 v105, s29, v103
    v_add_u32 v105, 65536, v105
    v_xor_b32 v106, 32, v105
    ds_read_b64_tr_b16 a[32:33], v105 offset:0
    ds_read_b64_tr_b16 a[34:35], v105 offset:4096
    ds_read_b64_tr_b16 a[36:37], v105 offset:8192
    ds_read_b64_tr_b16 a[38:39], v105 offset:12288
    ds_read_b64_tr_b16 a[40:41], v106 offset:0
    ds_read_b64_tr_b16 a[42:43], v106 offset:4096
    ds_read_b64_tr_b16 a[44:45], v106 offset:8192
    ds_read_b64_tr_b16 a[46:47], v106 offset:12288
    s_waitcnt lgkmcnt(0)
    s_waitcnt vmcnt(24)
    s_barrier
    s_add_u32 m0, s28, 32768
    s_mov_b32 s29, 8192
    buffer_load_dwordx4 v102, s[12:15], s29 offen  lds
    s_add_u32 m0, s28, 33792
    s_mov_b32 s29, 40960
    buffer_load_dwordx4 v104, s[12:15], s29 offen  lds
    s_add_u32 m0, s28, 34816
    s_mov_b32 s29, 12288
    buffer_load_dwordx4 v102, s[12:15], s29 offen  lds
    s_add_u32 m0, s28, 35840
    s_mov_b32 s29, 45056
    buffer_load_dwordx4 v104, s[12:15], s29 offen  lds
    s_lshl_b32 s29, s24, 6
    v_xor_b32 v105, s29, v103
    v_add_u32 v105, 81920, v105
    v_xor_b32 v106, 32, v105
    ds_read_b64_tr_b16 a[48:49], v105 offset:0
    ds_read_b64_tr_b16 a[50:51], v105 offset:4096
    ds_read_b64_tr_b16 a[52:53], v105 offset:8192
    ds_read_b64_tr_b16 a[54:55], v105 offset:12288
    ds_read_b64_tr_b16 a[56:57], v106 offset:0
    ds_read_b64_tr_b16 a[58:59], v106 offset:4096
    ds_read_b64_tr_b16 a[60:61], v106 offset:8192
    ds_read_b64_tr_b16 a[62:63], v106 offset:12288
    s_waitcnt lgkmcnt(0)
    v_mov_b32 v20, 4
    buffer_load_dword v21, v20, s[8:11], 0 offen sc1
    s_waitcnt vmcnt(25)
    s_barrier
    s_add_u32 m0, s28, 49152
    s_mov_b32 s29, 10240
    buffer_load_dwordx4 v102, s[12:15], s29 offen  lds
    s_add_u32 m0, s28, 50176
    s_mov_b32 s29, 43008
    buffer_load_dwordx4 v104, s[12:15], s29 offen  lds
    s_add_u32 m0, s28, 51200
    s_mov_b32 s29, 14336
    buffer_load_dwordx4 v102, s[12:15], s29 offen  lds
    s_add_u32 m0, s28, 52224
    s_mov_b32 s29, 47104
    buffer_load_dwordx4 v104, s[12:15], s29 offen  lds
    s_lshl_b32 s29, s24, 6
    v_xor_b32 v105, s29, v103
    v_add_u32 v105, 98304, v105
    v_xor_b32 v106, 32, v105
    ds_read_b64_tr_b16 a[64:65], v105 offset:0
    ds_read_b64_tr_b16 a[66:67], v105 offset:4096
    ds_read_b64_tr_b16 a[68:69], v105 offset:8192
    ds_read_b64_tr_b16 a[70:71], v105 offset:12288
    ds_read_b64_tr_b16 a[72:73], v106 offset:0
    ds_read_b64_tr_b16 a[74:75], v106 offset:4096
    ds_read_b64_tr_b16 a[76:77], v106 offset:8192
    ds_read_b64_tr_b16 a[78:79], v106 offset:12288
    s_waitcnt lgkmcnt(0)
    s_waitcnt vmcnt(25)
    s_barrier
    s_add_u32 m0, s28, 65536
    s_mov_b32 s29, 65536
    buffer_load_dwordx4 v102, s[12:15], s29 offen  lds
    s_add_u32 m0, s28, 66560
    s_mov_b32 s29, 98304
    buffer_load_dwordx4 v104, s[12:15], s29 offen  lds
    s_add_u32 m0, s28, 67584
    s_mov_b32 s29, 69632
    buffer_load_dwordx4 v102, s[12:15], s29 offen  lds
    s_add_u32 m0, s28, 68608
    s_mov_b32 s29, 102400
    buffer_load_dwordx4 v104, s[12:15], s29 offen  lds
    s_lshl_b32 s29, s24, 6
    v_xor_b32 v105, s29, v103
    v_add_u32 v105, 114688, v105
    v_xor_b32 v106, 32, v105
    ds_read_b64_tr_b16 a[80:81], v105 offset:0
    ds_read_b64_tr_b16 a[82:83], v105 offset:4096
    ds_read_b64_tr_b16 a[84:85], v105 offset:8192
    ds_read_b64_tr_b16 a[86:87], v105 offset:12288
    ds_read_b64_tr_b16 a[88:89], v106 offset:0
    ds_read_b64_tr_b16 a[90:91], v106 offset:4096
    ds_read_b64_tr_b16 a[92:93], v106 offset:8192
    ds_read_b64_tr_b16 a[94:95], v106 offset:12288
    s_waitcnt lgkmcnt(0)
    s_waitcnt vmcnt(25)
    s_barrier
    s_add_u32 m0, s28, 81920
    s_mov_b32 s29, 67584
    buffer_load_dwordx4 v102, s[12:15], s29 offen  lds
    s_add_u32 m0, s28, 82944
    s_mov_b32 s29, 100352
    buffer_load_dwordx4 v104, s[12:15], s29 offen  lds
    s_add_u32 m0, s28, 83968
    s_mov_b32 s29, 71680
    buffer_load_dwordx4 v102, s[12:15], s29 offen  lds
    s_add_u32 m0, s28, 84992
    s_mov_b32 s29, 104448
    buffer_load_dwordx4 v104, s[12:15], s29 offen  lds
    s_lshl_b32 s29, s24, 6
    v_xor_b32 v105, s29, v103
    v_add_u32 v105, 131072, v105
    v_xor_b32 v106, 32, v105
    ds_read_b64_tr_b16 a[96:97], v105 offset:0
    ds_read_b64_tr_b16 a[98:99], v105 offset:4096
    ds_read_b64_tr_b16 a[100:101], v105 offset:8192
    ds_read_b64_tr_b16 a[102:103], v105 offset:12288
    ds_read_b64_tr_b16 a[104:105], v106 offset:0
    ds_read_b64_tr_b16 a[106:107], v106 offset:4096
    ds_read_b64_tr_b16 a[108:109], v106 offset:8192
    ds_read_b64_tr_b16 a[110:111], v106 offset:12288
    s_waitcnt lgkmcnt(0)
    s_waitcnt vmcnt(25)
    s_barrier
    s_add_u32 m0, s28, 98304
    s_mov_b32 s29, 73728
    buffer_load_dwordx4 v102, s[12:15], s29 offen  lds
    s_add_u32 m0, s28, 99328
    s_mov_b32 s29, 106496
    buffer_load_dwordx4 v104, s[12:15], s29 offen  lds
    s_add_u32 m0, s28, 100352
    s_mov_b32 s29, 77824
    buffer_load_dwordx4 v102, s[12:15], s29 offen  lds
    s_add_u32 m0, s28, 101376
    s_mov_b32 s29, 110592
    buffer_load_dwordx4 v104, s[12:15], s29 offen  lds
    s_lshl_b32 s29, s24, 6
    v_xor_b32 v105, s29, v103
    v_add_u32 v105, 147456, v105
    v_xor_b32 v106, 32, v105
    ds_read_b64_tr_b16 a[112:113], v105 offset:0
    ds_read_b64_tr_b16 a[114:115], v105 offset:4096
    ds_read_b64_tr_b16 a[116:117], v105 offset:8192
    ds_read_b64_tr_b16 a[118:119], v105 offset:12288
    ds_read_b64_tr_b16 a[120:121], v106 offset:0
    ds_read_b64_tr_b16 a[122:123], v106 offset:4096
    ds_read_b64_tr_b16 a[124:125], v106 offset:8192
    ds_read_b64_tr_b16 a[126:127], v106 offset:12288
    s_waitcnt lgkmcnt(0)
    s_waitcnt vmcnt(25)
    s_barrier
    s_add_u32 m0, s28, 114688
    s_mov_b32 s29, 75776
    buffer_load_dwordx4 v102, s[12:15], s29 offen  lds
    s_add_u32 m0, s28, 115712
    s_mov_b32 s29, 108544
    buffer_load_dwordx4 v104, s[12:15], s29 offen  lds
    s_add_u32 m0, s28, 116736
    s_mov_b32 s29, 79872
    buffer_load_dwordx4 v102, s[12:15], s29 offen  lds
    s_add_u32 m0, s28, 117760
    s_mov_b32 s29, 112640
    buffer_load_dwordx4 v104, s[12:15], s29 offen  lds
    s_add_u32 s29, s28, 0
    v_lshrrev_b32 v106, 4, v103
    v_and_b32 v106, 32, v106
    v_xor_b32 v105, v106, v103
    v_add_u32 v105, s29, v105
    ds_read_b64_tr_b16 a[128:129], v105
    v_xor_b32 v106, 64, v105
    ds_read_b64_tr_b16 a[136:137], v106
    v_xor_b32 v106, 128, v105
    ds_read_b64_tr_b16 a[144:145], v106
    v_xor_b32 v106, 192, v105
    ds_read_b64_tr_b16 a[152:153], v106
    v_xor_b32 v106, 576, v105
    ds_read_b64_tr_b16 a[160:161], v106
    v_xor_b32 v106, 512, v105
    ds_read_b64_tr_b16 a[168:169], v106
    v_xor_b32 v106, 704, v105
    ds_read_b64_tr_b16 a[176:177], v106
    v_xor_b32 v106, 640, v105
    ds_read_b64_tr_b16 a[184:185], v106
    s_waitcnt lgkmcnt(0)
    s_waitcnt vmcnt(25)
    s_barrier
    s_mov_b32 s12, s76
    s_and_b32 s13, s77, 0xffff
    s_mov_b32 s14, 4194304
    s_mov_b32 s15, 0x20000
    v_xor_b32 v104, 0x80, v101
    s_add_u32 m0, s28, 0
    s_mov_b32 s29, 0
    buffer_load_dwordx4 v101, s[12:15], s29 offen  lds
    s_add_u32 m0, s28, 1024
    s_mov_b32 s29, 32768
    buffer_load_dwordx4 v104, s[12:15], s29 offen  lds
    s_add_u32 m0, s28, 2048
    s_mov_b32 s29, 1048576
    buffer_load_dwordx4 v101, s[12:15], s29 offen  lds
    s_add_u32 m0, s28, 3072
    s_mov_b32 s29, 1081344
    buffer_load_dwordx4 v104, s[12:15], s29 offen  lds
    s_add_u32 s29, s28, 16384
    v_lshrrev_b32 v106, 4, v103
    v_and_b32 v106, 32, v106
    v_xor_b32 v105, v106, v103
    v_add_u32 v105, s29, v105
    ds_read_b64_tr_b16 a[130:131], v105
    v_xor_b32 v106, 64, v105
    ds_read_b64_tr_b16 a[138:139], v106
    v_xor_b32 v106, 128, v105
    ds_read_b64_tr_b16 a[146:147], v106
    v_xor_b32 v106, 192, v105
    ds_read_b64_tr_b16 a[154:155], v106
    v_xor_b32 v106, 576, v105
    ds_read_b64_tr_b16 a[162:163], v106
    v_xor_b32 v106, 512, v105
    ds_read_b64_tr_b16 a[170:171], v106
    v_xor_b32 v106, 704, v105
    ds_read_b64_tr_b16 a[178:179], v106
    v_xor_b32 v106, 640, v105
    ds_read_b64_tr_b16 a[186:187], v106
    s_waitcnt lgkmcnt(0)
    s_waitcnt vmcnt(25)
    s_barrier
    s_add_u32 m0, s28, 16384
    s_mov_b32 s29, 65536
    buffer_load_dwordx4 v101, s[12:15], s29 offen  lds
    s_add_u32 m0, s28, 17408
    s_mov_b32 s29, 98304
    buffer_load_dwordx4 v104, s[12:15], s29 offen  lds
    s_add_u32 m0, s28, 18432
    s_mov_b32 s29, 1114112
    buffer_load_dwordx4 v101, s[12:15], s29 offen  lds
    s_add_u32 m0, s28, 19456
    s_mov_b32 s29, 1146880
    buffer_load_dwordx4 v104, s[12:15], s29 offen  lds
    s_add_u32 s29, s28, 32768
    v_lshrrev_b32 v106, 4, v103
    v_and_b32 v106, 32, v106
    v_xor_b32 v105, v106, v103
    v_add_u32 v105, s29, v105
    ds_read_b64_tr_b16 a[132:133], v105
    v_xor_b32 v106, 64, v105
    ds_read_b64_tr_b16 a[140:141], v106
    v_xor_b32 v106, 128, v105
    ds_read_b64_tr_b16 a[148:149], v106
    v_xor_b32 v106, 192, v105
    ds_read_b64_tr_b16 a[156:157], v106
    v_xor_b32 v106, 576, v105
    ds_read_b64_tr_b16 a[164:165], v106
    v_xor_b32 v106, 512, v105
    ds_read_b64_tr_b16 a[172:173], v106
    v_xor_b32 v106, 704, v105
    ds_read_b64_tr_b16 a[180:181], v106
    v_xor_b32 v106, 640, v105
    ds_read_b64_tr_b16 a[188:189], v106
    s_waitcnt lgkmcnt(0)
    s_waitcnt vmcnt(24)
    s_barrier
    s_add_u32 m0, s28, 32768
    s_mov_b32 s29, 131072
    buffer_load_dwordx4 v101, s[12:15], s29 offen  lds
    s_add_u32 m0, s28, 33792
    s_mov_b32 s29, 163840
    buffer_load_dwordx4 v104, s[12:15], s29 offen  lds
    s_add_u32 m0, s28, 34816
    s_mov_b32 s29, 1179648
    buffer_load_dwordx4 v101, s[12:15], s29 offen  lds
    s_add_u32 m0, s28, 35840
    s_mov_b32 s29, 1212416
    buffer_load_dwordx4 v104, s[12:15], s29 offen  lds
    s_add_u32 s29, s28, 49152
    v_lshrrev_b32 v106, 4, v103
    v_and_b32 v106, 32, v106
    v_xor_b32 v105, v106, v103
    v_add_u32 v105, s29, v105
    ds_read_b64_tr_b16 a[134:135], v105
    v_xor_b32 v106, 64, v105
    ds_read_b64_tr_b16 a[142:143], v106
    v_xor_b32 v106, 128, v105
    ds_read_b64_tr_b16 a[150:151], v106
    v_xor_b32 v106, 192, v105
    ds_read_b64_tr_b16 a[158:159], v106
    v_xor_b32 v106, 576, v105
    ds_read_b64_tr_b16 a[166:167], v106
    v_xor_b32 v106, 512, v105
    ds_read_b64_tr_b16 a[174:175], v106
    v_xor_b32 v106, 704, v105
    ds_read_b64_tr_b16 a[182:183], v106
    v_xor_b32 v106, 640, v105
    ds_read_b64_tr_b16 a[190:191], v106
    s_waitcnt lgkmcnt(0)
    v_cmp_gt_u32 vcc, 32, v21
    s_cbranch_vccz L_zok_1
    v_mov_b32 v20, 4
L_poll_2:
    buffer_load_dword v21, v20, s[8:11], 0 offen offset:0 sc1
    s_waitcnt vmcnt(0)
    v_cmp_gt_u32 vcc, 32, v21
    s_cbranch_vccz L_polld_3
    s_sub_u32 s27, s27, 1
    s_cbranch_scc1 L_exit
    s_sleep 2
    s_branch L_poll_2
L_polld_3:
L_zok_1:
    v_min_u32 v126, 0xfffffffe, v126
    v_bfe_u32 v20, v1, 4, 1
    v_mul_u32_u24 v20, 24576, v20
    s_waitcnt vmcnt(24)
    s_barrier
    s_add_u32 m0, s28, 49152
    s_mov_b32 s29, 196608
    buffer_load_dwordx4 v101, s[12:15], s29 offen  lds
    s_add_u32 m0, s28, 50176
    s_mov_b32 s29, 229376
    buffer_load_dwordx4 v104, s[12:15], s29 offen  lds
    s_add_u32 m0, s28, 51200
    s_mov_b32 s29, 1245184
    buffer_load_dwordx4 v101, s[12:15], s29 offen  lds
    s_add_u32 m0, s28, 52224
    s_mov_b32 s29, 1277952
    buffer_load_dwordx4 v104, s[12:15], s29 offen  lds
    s_add_u32 s29, s28, 65536
    v_lshrrev_b32 v106, 4, v103
    v_and_b32 v106, 32, v106
    v_xor_b32 v105, v106, v103
    v_add_u32 v105, s29, v105
    ds_read_b64_tr_b16 a[192:193], v105
    v_xor_b32 v106, 64, v105
    ds_read_b64_tr_b16 a[200:201], v106
    v_xor_b32 v106, 128, v105
    ds_read_b64_tr_b16 a[208:209], v106
    v_xor_b32 v106, 192, v105
    ds_read_b64_tr_b16 a[216:217], v106
    v_xor_b32 v106, 576, v105
    ds_read_b64_tr_b16 a[224:225], v106
    v_xor_b32 v106, 512, v105
    ds_read_b64_tr_b16 a[232:233], v106
    v_xor_b32 v106, 704, v105
    ds_read_b64_tr_b16 a[240:241], v106
    v_xor_b32 v106, 640, v105
    ds_read_b64_tr_b16 a[248:249], v106
    s_waitcnt lgkmcnt(0)
    buffer_load_dword v21, v20, s[4:7], s37 offen sc1
    s_waitcnt vmcnt(25)
    s_barrier
    s_add_u32 m0, s28, 65536
    s_mov_b32 s29, 262144
    buffer_load_dwordx4 v101, s[12:15], s29 offen  lds
    s_add_u32 m0, s28, 66560
    s_mov_b32 s29, 294912
    buffer_load_dwordx4 v104, s[12:15], s29 offen  lds
    s_add_u32 m0, s28, 67584
    s_mov_b32 s29, 1310720
    buffer_load_dwordx4 v101, s[12:15], s29 offen  lds
    s_add_u32 m0, s28, 68608
    s_mov_b32 s29, 1343488
    buffer_load_dwordx4 v104, s[12:15], s29 offen  lds
    s_add_u32 s29, s28, 81920
    v_lshrrev_b32 v106, 4, v103
    v_and_b32 v106, 32, v106
    v_xor_b32 v105, v106, v103
    v_add_u32 v105, s29, v105
    ds_read_b64_tr_b16 a[194:195], v105
    v_xor_b32 v106, 64, v105
    ds_read_b64_tr_b16 a[202:203], v106
    v_xor_b32 v106, 128, v105
    ds_read_b64_tr_b16 a[210:211], v106
    v_xor_b32 v106, 192, v105
    ds_read_b64_tr_b16 a[218:219], v106
    v_xor_b32 v106, 576, v105
    ds_read_b64_tr_b16 a[226:227], v106
    v_xor_b32 v106, 512, v105
    ds_read_b64_tr_b16 a[234:235], v106
    v_xor_b32 v106, 704, v105
    ds_read_b64_tr_b16 a[242:243], v106
    v_xor_b32 v106, 640, v105
    ds_read_b64_tr_b16 a[250:251], v106
    s_waitcnt lgkmcnt(0)
    s_waitcnt vmcnt(25)
    s_barrier
    s_add_u32 m0, s28, 81920
    s_mov_b32 s29, 327680
    buffer_load_dwordx4 v101, s[12:15], s29 offen  lds
    s_add_u32 m0, s28, 82944
    s_mov_b32 s29, 360448
    buffer_load_dwordx4 v104, s[12:15], s29 offen  lds
    s_add_u32 m0, s28, 83968
    s_mov_b32 s29, 1376256
    buffer_load_dwordx4 v101, s[12:15], s29 offen  lds
    s_add_u32 m0, s28, 84992
    s_mov_b32 s29, 1409024
    buffer_load_dwordx4 v104, s[12:15], s29 offen  lds
    s_add_u32 s29, s28, 98304
    v_lshrrev_b32 v106, 4, v103
    v_and_b32 v106, 32, v106
    v_xor_b32 v105, v106, v103
    v_add_u32 v105, s29, v105
    ds_read_b64_tr_b16 a[196:197], v105
    v_xor_b32 v106, 64, v105
    ds_read_b64_tr_b16 a[204:205], v106
    v_xor_b32 v106, 128, v105
    ds_read_b64_tr_b16 a[212:213], v106
    v_xor_b32 v106, 192, v105
    ds_read_b64_tr_b16 a[220:221], v106
    v_xor_b32 v106, 576, v105
    ds_read_b64_tr_b16 a[228:229], v106
    v_xor_b32 v106, 512, v105
    ds_read_b64_tr_b16 a[236:237], v106
    v_xor_b32 v106, 704, v105
    ds_read_b64_tr_b16 a[244:245], v106
    v_xor_b32 v106, 640, v105
    ds_read_b64_tr_b16 a[252:253], v106
    s_waitcnt lgkmcnt(0)
    s_waitcnt vmcnt(25)
    s_barrier
    s_add_u32 m0, s28, 98304
    s_mov_b32 s29, 393216
    buffer_load_dwordx4 v101, s[12:15], s29 offen  lds
    s_add_u32 m0, s28, 99328
    s_mov_b32 s29, 425984
    buffer_load_dwordx4 v104, s[12:15], s29 offen  lds
    s_add_u32 m0, s28, 100352
    s_mov_b32 s29, 1441792
    buffer_load_dwordx4 v101, s[12:15], s29 offen  lds
    s_add_u32 m0, s28, 101376
    s_mov_b32 s29, 1474560
    buffer_load_dwordx4 v104, s[12:15], s29 offen  lds
    s_add_u32 s29, s28, 114688
    v_lshrrev_b32 v106, 4, v103
    v_and_b32 v106, 32, v106
    v_xor_b32 v105, v106, v103
    v_add_u32 v105, s29, v105
    ds_read_b64_tr_b16 a[198:199], v105
    v_xor_b32 v106, 64, v105
    ds_read_b64_tr_b16 a[206:207], v106
    v_xor_b32 v106, 128, v105
    ds_read_b64_tr_b16 a[214:215], v106
    v_xor_b32 v106, 192, v105
    ds_read_b64_tr_b16 a[222:223], v106
    v_xor_b32 v106, 576, v105
    ds_read_b64_tr_b16 a[230:231], v106
    v_xor_b32 v106, 512, v105
    ds_read_b64_tr_b16 a[238:239], v106
    v_xor_b32 v106, 704, v105
    ds_read_b64_tr_b16 a[246:247], v106
    v_xor_b32 v106, 640, v105
    ds_read_b64_tr_b16 a[254:255], v106
    s_waitcnt lgkmcnt(0)
    s_waitcnt vmcnt(25)
    s_barrier
    s_add_u32 m0, s28, 114688
    s_mov_b32 s29, 458752
    buffer_load_dwordx4 v101, s[12:15], s29 offen  lds
    s_add_u32 m0, s28, 115712
    s_mov_b32 s29, 491520
    buffer_load_dwordx4 v104, s[12:15], s29 offen  lds
    s_add_u32 m0, s28, 116736
    s_mov_b32 s29, 1507328
    buffer_load_dwordx4 v101, s[12:15], s29 offen  lds
    s_add_u32 m0, s28, 117760
    s_mov_b32 s29, 1540096
    buffer_load_dwordx4 v104, s[12:15], s29 offen  lds
    s_lshl_b32 s29, s24, 6
    v_xor_b32 v105, s29, v103
    v_add_u32 v105, 32768, v105
    v_xor_b32 v106, 32, v105
    ds_read_b64_tr_b16 v[52:53], v105 offset:0
    ds_read_b64_tr_b16 v[54:55], v105 offset:4096
    ds_read_b64_tr_b16 v[56:57], v105 offset:8192
    ds_read_b64_tr_b16 v[58:59], v105 offset:12288
    ds_read_b64_tr_b16 v[60:61], v106 offset:0
    ds_read_b64_tr_b16 v[62:63], v106 offset:4096
    ds_read_b64_tr_b16 v[64:65], v106 offset:8192
    ds_read_b64_tr_b16 v[66:67], v106 offset:12288
    s_waitcnt lgkmcnt(0)
    s_waitcnt vmcnt(25)
    s_barrier
    s_add_u32 s29, s28, 0
    v_add_u32 v105, s29, v1
    ds_write_b128 v105, v[52:55] offset:0
    ds_write_b128 v105, v[56:59] offset:1024
    ds_write_b128 v105, v[60:63] offset:2048
    ds_write_b128 v105, v[64:67] offset:3072
    s_lshl_b32 s29, s24, 6
    v_xor_b32 v105, s29, v103
    v_add_u32 v105, 49152, v105
    v_xor_b32 v106, 32, v105
    ds_read_b64_tr_b16 v[68:69], v105 offset:0
    ds_read_b64_tr_b16 v[70:71], v105 offset:4096
    ds_read_b64_tr_b16 v[72:73], v105 offset:8192
    ds_read_b64_tr_b16 v[74:75], v105 offset:12288
    ds_read_b64_tr_b16 v[76:77], v106 offset:0
    ds_read_b64_tr_b16 v[78:79], v106 offset:4096
    ds_read_b64_tr_b16 v[80:81], v106 offset:8192
    ds_read_b64_tr_b16 v[82:83], v106 offset:12288
    s_waitcnt lgkmcnt(0)
    s_waitcnt vmcnt(21)
    s_barrier
    s_add_u32 s29, s28, 16384
    v_add_u32 v105, s29, v1
    ds_write_b128 v105, v[68:71] offset:0
    ds_write_b128 v105, v[72:75] offset:1024
    ds_write_b128 v105, v[76:79] offset:2048
    ds_write_b128 v105, v[80:83] offset:3072
    s_lshl_b32 s29, s24, 6
    v_xor_b32 v105, s29, v103
    v_add_u32 v105, 65536, v105
    v_xor_b32 v106, 32, v105
    ds_read_b64_tr_b16 v[52:53], v105 offset:0
    ds_read_b64_tr_b16 v[54:55], v105 offset:4096
    ds_read_b64_tr_b16 v[56:57], v105 offset:8192
    ds_read_b64_tr_b16 v[58:59], v105 offset:12288
    ds_read_b64_tr_b16 v[60:61], v106 offset:0
    ds_read_b64_tr_b16 v[62:63], v106 offset:4096
    ds_read_b64_tr_b16 v[64:65], v106 offset:8192
    ds_read_b64_tr_b16 v[66:67], v106 offset:12288
    s_waitcnt lgkmcnt(0)
    s_waitcnt vmcnt(17)
    s_barrier
    s_add_u32 s29, s28, 32768
    v_add_u32 v105, s29, v1
    ds_write_b128 v105, v[52:55] offset:0
    ds_write_b128 v105, v[56:59] offset:1024
    ds_write_b128 v105, v[60:63] offset:2048
    ds_write_b128 v105, v[64:67] offset:3072
    s_lshl_b32 s29, s24, 6
    v_xor_b32 v105, s29, v103
    v_add_u32 v105, 81920, v105
    v_xor_b32 v106, 32, v105
    ds_read_b64_tr_b16 v[68:69], v105 offset:0
    ds_read_b64_tr_b16 v[70:71], v105 offset:4096
    ds_read_b64_tr_b16 v[72:73], v105 offset:8192
    ds_read_b64_tr_b16 v[74:75], v105 offset:12288
    ds_read_b64_tr_b16 v[76:77], v106 offset:0
    ds_read_b64_tr_b16 v[78:79], v106 offset:4096
    ds_read_b64_tr_b16 v[80:81], v106 offset:8192
    ds_read_b64_tr_b16 v[82:83], v106 offset:12288
    s_waitcnt lgkmcnt(0)
    s_waitcnt vmcnt(12)
    s_barrier
    s_add_u32 s29, s28, 49152
    v_add_u32 v105, s29, v1
    ds_write_b128 v105, v[68:71] offset:0
    ds_write_b128 v105, v[72:75] offset:1024
    ds_write_b128 v105, v[76:79] offset:2048
    ds_write_b128 v105, v[80:83] offset:3072
    s_lshl_b32 s29, s24, 6
    v_xor_b32 v105, s29, v103
    v_add_u32 v105, 98304, v105
    v_xor_b32 v106, 32, v105
    ds_read_b64_tr_b16 v[52:53], v105 offset:0
    ds_read_b64_tr_b16 v[54:55], v105 offset:4096
    ds_read_b64_tr_b16 v[56:57], v105 offset:8192
    ds_read_b64_tr_b16 v[58:59], v105 offset:12288
    ds_read_b64_tr_b16 v[60:61], v106 offset:0
    ds_read_b64_tr_b16 v[62:63], v106 offset:4096
    ds_read_b64_tr_b16 v[64:65], v106 offset:8192
    ds_read_b64_tr_b16 v[66:67], v106 offset:12288
    s_waitcnt lgkmcnt(0)
    s_mov_b64 exec, 0x101
    s_lshl_b32 s29, s25, 8
    s_add_u32 s29, s29, 93323264
    buffer_load_dword v18, v1, s[4:7], s29 offen sc1
    s_mov_b32 exec_lo, 0x01010101
    s_mov_b32 exec_hi, 0x01010101
    s_lshl_b32 s29, s24, 11
    s_add_u32 s29, s29, s39
    buffer_load_dword v18, v1, s[4:7], s29 offen sc1
    buffer_load_dword v18, v1, s[4:7], s29 offen offset:1024 sc1
    s_mov_b64 exec, s[42:43]
    buffer_store_dwordx2 v[126:127], v5, s[4:7], s33 offen
    s_mov_b64 exec, -1
    v_cmp_ne_u32 vcc, 1, v21
    s_cbranch_vccnz L_late_4
    s_mov_b32 s59, 1
    s_lshl_b32 m0, s24, 11
    buffer_load_dwordx4 v[116:119], v1, s[4:7], s36 offen sc1
    buffer_load_dwordx4 v[120:123], v1, s[4:7], s36 offen offset:1024 sc1
    buffer_load_dwordx4 v1, s[4:7], s51 offen sc1 lds
    buffer_load_dwordx4 v1, s[4:7], s51 offen offset:1024 sc1 lds
    buffer_load_dword v18, v19, s[4:7], s36 offen sc1
    s_add_u32 s36, s36, 24576
L_late_4:
    s_waitcnt vmcnt(12)
    s_barrier
    s_add_u32 s29, s28, 65536
    v_add_u32 v105, s29, v1
    ds_write_b128 v105, v[52:55] offset:0
    ds_write_b128 v105, v[56:59] offset:1024
    ds_write_b128 v105, v[60:63] offset:2048
    ds_write_b128 v105, v[64:67] offset:3072
    s_lshl_b32 s29, s24, 6
    v_xor_b32 v105, s29, v103
    v_add_u32 v105, 114688, v105
    v_xor_b32 v106, 32, v105
    ds_read_b64_tr_b16 v[68:69], v105 offset:0
    ds_read_b64_tr_b16 v[70:71], v105 offset:4096
    ds_read_b64_tr_b16 v[72:73], v105 offset:8192
    ds_read_b64_tr_b16 v[74:75], v105 offset:12288
    ds_read_b64_tr_b16 v[76:77], v106 offset:0
    ds_read_b64_tr_b16 v[78:79], v106 offset:4096
    ds_read_b64_tr_b16 v[80:81], v106 offset:8192
    ds_read_b64_tr_b16 v[82:83], v106 offset:12288
    s_waitcnt lgkmcnt(0)
    s_waitcnt vmcnt(8)
    s_barrier
    s_add_u32 s29, s28, 81920
    v_add_u32 v105, s29, v1
    ds_write_b128 v105, v[68:71] offset:0
    ds_write_b128 v105, v[72:75] offset:1024
    ds_write_b128 v105, v[76:79] offset:2048
    ds_write_b128 v105, v[80:83] offset:3072
    s_lshl_b32 s29, s24, 6
    v_xor_b32 v105, s29, v103
    v_add_u32 v105, 131072, v105
    v_xor_b32 v106, 32, v105
    ds_read_b64_tr_b16 v[52:53], v105 offset:0
    ds_read_b64_tr_b16 v[54:55], v105 offset:4096
    ds_read_b64_tr_b16 v[56:57], v105 offset:8192
    ds_read_b64_tr_b16 v[58:59], v105 offset:12288
    ds_read_b64_tr_b16 v[60:61], v106 offset:0
    ds_read_b64_tr_b16 v[62:63], v106 offset:4096
    ds_read_b64_tr_b16 v[64:65], v106 offset:8192
    ds_read_b64_tr_b16 v[66:67], v106 offset:12288
    s_waitcnt lgkmcnt(0)
    s_waitcnt vmcnt(4)
    s_barrier
    s_add_u32 s29, s28, 98304
    v_add_u32 v105, s29, v1
    ds_write_b128 v105, v[52:55] offset:0
    ds_write_b128 v105, v[56:59] offset:1024
    ds_write_b128 v105, v[60:63] offset:2048
    ds_write_b128 v105, v[64:67] offset:3072
    s_lshl_b32 s29, s24, 6
    v_xor_b32 v105, s29, v103
    v_add_u32 v105, 147456, v105
    v_xor_b32 v106, 32, v105
    ds_read_b64_tr_b16 v[68:69], v105 offset:0
    ds_read_b64_tr_b16 v[70:71], v105 offset:4096
    ds_read_b64_tr_b16 v[72:73], v105 offset:8192
    ds_read_b64_tr_b16 v[74:75], v105 offset:12288
    ds_read_b64_tr_b16 v[76:77], v106 offset:0
    ds_read_b64_tr_b16 v[78:79], v106 offset:4096
    ds_read_b64_tr_b16 v[80:81], v106 offset:8192
    ds_read_b64_tr_b16 v[82:83], v106 offset:12288
    s_waitcnt lgkmcnt(0)
    s_barrier
    s_add_u32 s29, s28, 114688
    v_add_u32 v105, s29, v1
    ds_write_b128 v105, v[68:71] offset:0
    ds_write_b128 v105, v[72:75] offset:1024
    ds_write_b128 v105, v[76:79] offset:2048
    ds_write_b128 v105, v[80:83] offset:3072
    s_mov_b32 s80, 0x3f803f80
    s_mov_b32 s81, 0x3f803f80
    s_cmp_eq_u32 s59, 1
    s_cbranch_scc1 L_r_early
L_poll_5:
    buffer_load_dword v21, v20, s[4:7], s37 offen offset:0 sc1
    s_waitcnt vmcnt(0)
    v_cmp_ne_u32 vcc, 1, v21
    s_cbranch_vccz L_polld_6
    s_sub_u32 s27, s27, 1
    s_cbranch_scc1 L_exit
    s_sleep 2
    s_branch L_poll_5
L_polld_6:
    s_lshl_b32 m0, s24, 11
    buffer_load_dwordx4 v[116:119], v1, s[4:7], s36 offen sc1
    buffer_load_dwordx4 v[120:123], v1, s[4:7], s36 offen offset:1024 sc1
    buffer_load_dwordx4 v1, s[4:7], s51 offen sc1 lds
    buffer_load_dwordx4 v1, s[4:7], s51 offen offset:1024 sc1 lds
    buffer_load_dword v18, v19, s[4:7], s36 offen sc1
    s_add_u32 s36, s36, 24576
L_r_early:
    s_waitcnt lgkmcnt(0)
    ds_read_b128 v[52:55], v2 offset:0
    ds_read_b128 v[56:59], v2 offset:1024
    ds_read_b128 v[60:63], v2 offset:2048
    ds_read_b128 v[64:67], v2 offset:3072
    ds_read_b128 v[68:71], v2 offset:16384
    ds_read_b128 v[72:75], v2 offset:17408
    ds_read_b128 v[76:79], v2 offset:18432
    ds_read_b128 v[80:83], v2 offset:19456
    ds_read_b128 v[84:87], v2 offset:32768
    ds_read_b128 v[88:91], v2 offset:33792
    ds_read_b128 v[92:95], v2 offset:34816
    ds_read_b128 v[96:99], v2 offset:35840
    v_mov_b64 v[100:101], 0
    v_mov_b64 v[102:103], 0
    v_mov_b64 v[104:105], 0
    v_mov_b64 v[106:107], 0
    v_mov_b64 v[108:109], 0
    v_mov_b64 v[110:111], 0
    v_mov_b64 v[112:113], 0
    v_mov_b64 v[114:115], 0
.p2align 6
L_r_b3:
    s_barrier
L_r_fill:
    buffer_load_dwordx4 v[20:23], v1, s[4:7], s33 offen offset:0
    s_nop 11
    buffer_load_dwordx4 v[24:27], v1, s[4:7], s33 offen offset:1024
    s_nop 11
    buffer_load_dwordx4 v[28:31], v1, s[4:7], s33 offen offset:2048
    s_nop 11
    buffer_load_dwordx4 v[32:35], v1, s[4:7], s33 offen offset:3072
    s_nop 11
    buffer_load_dwordx4 v[36:39], v1, s[4:7], s48 offen offset:0
L_r_att0:
    s_waitcnt vmcnt(4) lgkmcnt(0)
    v_max_u32 v124, v20, v22
    v_cmp_eq_u32 vcc, -1, v124
    buffer_load_dwordx4 v[40:43], v1, s[4:7], s48 offen offset:1024
    s_cbranch_vccnz L_r_att1
    s_waitcnt lgkmcnt(8)
    v_smfmac_f32_16x16x64_bf16 v[108:111], v[20:23], v[52:59], v0
    ds_read_b128 v[52:55], v2 offset:49152
    v_smfmac_f32_16x16x64_bf16 v[112:115], v[20:23], v[60:67], v0
    ds_read_b128 v[56:59], v2 offset:50176
    v_smfmac_f32_16x16x64_bf16 v[100:103], v[20:23], v[128:135], v0
    ds_read_b128 v[60:63], v2 offset:51200
    v_smfmac_f32_16x16x64_bf16 v[104:107], v[20:23], v[136:143], v0
    s_waitcnt vmcnt(4) lgkmcnt(7)
    ds_read_b128 v[64:67], v2 offset:52224
    v_smfmac_f32_16x16x64_bf16 v[108:111], v[24:27], v[68:75], v0
    buffer_load_dwordx4 v[44:47], v1, s[4:7], s48 offen offset:2048
    ds_read_b128 v[68:71], v3 offset:0
    v_smfmac_f32_16x16x64_bf16 v[112:115], v[24:27], v[76:83], v0
    ds_read_b128 v[72:75], v3 offset:1024
    v_smfmac_f32_16x16x64_bf16 v[100:103], v[24:27], v[144:151], v0
    ds_read_b128 v[76:79], v3 offset:2048
    v_smfmac_f32_16x16x64_bf16 v[104:107], v[24:27], v[152:159], v0
    s_waitcnt vmcnt(4) lgkmcnt(7)
    ds_read_b128 v[80:83], v3 offset:3072
    v_smfmac_f32_16x16x64_bf16 v[108:111], v[28:31], v[84:91], v0
    buffer_load_dwordx4 v[48:51], v1, s[4:7], s48 offen offset:3072
    ds_read_b128 v[84:87], v3 offset:16384
    v_smfmac_f32_16x16x64_bf16 v[112:115], v[28:31], v[92:99], v0
    ds_read_b128 v[88:91], v3 offset:17408
    v_smfmac_f32_16x16x64_bf16 v[100:103], v[28:31], v[160:167], v0
    ds_read_b128 v[92:95], v3 offset:18432
    v_smfmac_f32_16x16x64_bf16 v[104:107], v[28:31], v[168:175], v0
    s_waitcnt vmcnt(4) lgkmcnt(7)
    ds_read_b128 v[96:99], v3 offset:19456
    v_smfmac_f32_16x16x64_bf16 v[108:111], v[32:35], v[52:59], v0
    ds_read_b128 v[52:55], v3 offset:32768
    v_smfmac_f32_16x16x64_bf16 v[112:115], v[32:35], v[60:67], v0
    ds_read_b128 v[56:59], v3 offset:33792
    v_smfmac_f32_16x16x64_bf16 v[100:103], v[32:35], v[176:183], v0
    ds_read_b128 v[60:63], v3 offset:34816
    v_smfmac_f32_16x16x64_bf16 v[104:107], v[32:35], v[184:191], v0
    s_waitcnt vmcnt(3) lgkmcnt(7)
    ds_read_b128 v[64:67], v3 offset:35840
    v_smfmac_f32_16x16x64_bf16 v[108:111], v[36:39], v[68:75], v0
    ds_read_b128 v[68:71], v3 offset:49152
    v_smfmac_f32_16x16x64_bf16 v[112:115], v[36:39], v[76:83], v0
    ds_read_b128 v[72:75], v3 offset:50176
    v_smfmac_f32_16x16x64_bf16 v[100:103], v[36:39], v[192:199], v0
    ds_read_b128 v[76:79], v3 offset:51200
    v_smfmac_f32_16x16x64_bf16 v[104:107], v[36:39], v[200:207], v0
    s_waitcnt vmcnt(2) lgkmcnt(7)
    ds_read_b128 v[80:83], v3 offset:52224
    v_smfmac_f32_16x16x64_bf16 v[108:111], v[40:43], v[84:91], v0
    buffer_load_dword v18, v19, s[4:7], s36 offen sc1
    v_smfmac_f32_16x16x64_bf16 v[112:115], v[40:43], v[92:99], v0
    v_max3_u32 v124, v124, v24, v26
    v_smfmac_f32_16x16x64_bf16 v[100:103], v[40:43], v[208:215], v0
    v_max3_u32 v124, v124, v28, v30
    v_smfmac_f32_16x16x64_bf16 v[104:107], v[40:43], v[216:223], v0
    s_waitcnt vmcnt(2) lgkmcnt(4)
    v_max3_u32 v124, v124, v32, v34
    v_smfmac_f32_16x16x64_bf16 v[108:111], v[44:47], v[52:59], v0
    v_max3_u32 v124, v124, v36, v38
    v_smfmac_f32_16x16x64_bf16 v[112:115], v[44:47], v[60:67], v0
    v_max3_u32 v124, v124, v40, v42
    v_smfmac_f32_16x16x64_bf16 v[100:103], v[44:47], v[224:231], v0
    v_max3_u32 v124, v124, v44, v46
    v_smfmac_f32_16x16x64_bf16 v[104:107], v[44:47], v[232:239], v0
    s_waitcnt vmcnt(1) lgkmcnt(0)
    v_smfmac_f32_16x16x64_bf16 v[108:111], v[48:51], v[68:75], v0
    v_max3_u32 v124, v124, v48, v50
    v_smfmac_f32_16x16x64_bf16 v[100:103], v[48:51], v[240:247], v0
    v_cmp_eq_u32 vcc, -1, v124
    v_smfmac_f32_16x16x64_bf16 v[112:115], v[48:51], v[76:83], v0
    buffer_store_dwordx2 v[126:127], v16, s[4:7], s50 offen sc1
    v_smfmac_f32_16x16x64_bf16 v[104:107], v[48:51], v[248:255], v0
    s_cbranch_vccnz L_r_redo
L_r_p1ok:
    v_cvt_pk_bf16_f32 v54, v108, v109
    v_cvt_pk_bf16_f32 v55, v110, v111
    v_cvt_pk_bf16_f32 v52, v100, v101
    v_cvt_pk_bf16_f32 v53, v102, v103
    v_cvt_pk_bf16_f32 v58, v112, v113
    v_cvt_pk_bf16_f32 v59, v114, v115
    v_mfma_f32_16x16x32_bf16 v[60:63], v[52:55], v[12:15], 0
    s_mov_b64 vcc, s[44:45]
    v_cvt_pk_bf16_f32 v56, v104, v105
    v_cvt_pk_bf16_f32 v57, v106, v107
    v_mov_b64 v[84:85], 0
    v_mov_b64 v[86:87], 0
    v_mfma_f32_16x16x32_bf16 v[64:67], v[56:59], v[12:15], 0
    s_nop 0
    v_add_u32 v103, s53, v17
    v_cvt_pk_bf16_f32 v52, v60, v61
    v_smfmac_f32_16x16x64_bf16 v[84:87], v[20:23], a[0:7], v0
    s_nop 1
    v_cvt_pk_bf16_f32 v53, v62, v63
    v_mov_b64 v[88:89], 0
    v_cvt_pk_bf16_f32 v54, v64, v65
    v_cvt_pk_bf16_f32 v55, v66, v67
    v_mov_b64 v[90:91], 0
    v_add_u32 v125, s54, v1
    v_mfma_f32_16x16x32_bf16 v[76:79], v[52:55], v[52:55], 0
    v_xor_b32 v100, 0x400, v17
    v_xor_b32 v101, 0x800, v17
    v_mfma_f32_16x16x32_bf16 v[68:71], v[116:119], v[52:55], 0
    v_xor_b32 v102, 0xc00, v17
    v_mfma_f32_16x16x32_bf16 v[72:75], v[120:123], v[52:55], 0
    v_cndmask_b32_dpp v78, v79, v78, vcc quad_perm:[2,3,0,1] row_mask:0xf bank_mask:0xf
    ds_write_b32 v125, v78 offset:20480
    v_smfmac_f32_16x16x64_bf16 v[88:91], v[20:23], a[8:15], v0
    s_nop 1
    v_mov_b64 v[80:81], s[80:81]
    v_mov_b64 v[82:83], s[80:81]
    v_cndmask_b32_dpp v68, v72, v68, vcc quad_perm:[2,3,0,1] row_mask:0xf bank_mask:0xf
    v_cndmask_b32_dpp v69, v73, v69, vcc quad_perm:[2,3,0,1] row_mask:0xf bank_mask:0xf
    v_cndmask_b32_dpp v70, v74, v70, vcc quad_perm:[2,3,0,1] row_mask:0xf bank_mask:0xf
    v_cndmask_b32_dpp v71, v75, v71, vcc quad_perm:[2,3,0,1] row_mask:0xf bank_mask:0xf
    ds_write_b128 v17, v[68:71] offset:16384
    v_smfmac_f32_16x16x64_bf16 v[84:87], v[24:27], a[16:23], v0
    v_mov_b32 v75, 0
    v_smfmac_f32_16x16x64_bf16 v[88:91], v[24:27], a[24:31], v0
    v_smfmac_f32_16x16x64_bf16 v[84:87], v[28:31], a[32:39], v0
    ds_read_b128 v[92:95], v103 offset:0
    v_smfmac_f32_16x16x64_bf16 v[88:91], v[28:31], a[40:47], v0
    ds_read_b128 v[96:99], v103 offset:1024
    v_smfmac_f32_16x16x64_bf16 v[84:87], v[32:35], a[48:55], v0
    s_waitcnt lgkmcnt(2)
    v_add_u32 v105, s55, v1
    s_barrier
    ds_read_b128 v[52:55], v100 offset:16384
    v_smfmac_f32_16x16x64_bf16 v[88:91], v[32:35], a[56:63], v0
    ds_read_b128 v[56:59], v101 offset:16384
    ds_read_b128 v[60:63], v102 offset:16384
    ds_read_b128 v[64:67], v1 offset:20480
    v_smfmac_f32_16x16x64_bf16 v[84:87], v[36:39], a[64:71], v0
    v_smfmac_f32_16x16x64_bf16 v[88:91], v[36:39], a[72:79], v0
    s_waitcnt lgkmcnt(3)
    v_add_f32 v68, v68, v52
    v_smfmac_f32_16x16x64_bf16 v[84:87], v[40:43], a[80:87], v0
    v_add_f32 v69, v69, v53
    v_smfmac_f32_16x16x64_bf16 v[88:91], v[40:43], a[88:95], v0
    v_add_f32 v70, v70, v54
    v_smfmac_f32_16x16x64_bf16 v[84:87], v[44:47], a[96:103], v0
    s_waitcnt lgkmcnt(0)
    v_add_f32 v71, v71, v55
    v_add_f32 v56, v56, v60
    v_add_f32 v57, v57, v61
    v_add_f32 v58, v58, v62
    v_add_f32 v59, v59, v63
    v_add_f32 v64, v64, v65
    v_add_f32 v66, v66, v67
    v_add_f32 v68, v68, v56
    v_add_f32 v69, v69, v57
    v_add_f32 v70, v70, v58
    v_add_f32 v71, v71, v59
    v_add_f32 v64, v64, v66
    v_max3_f32 v124, v68, v69, v70
    v_max3_f32 v124, v124, v71, v64
    v_smfmac_f32_16x16x64_bf16 v[88:91], v[44:47], a[104:111], v0
    s_nop 0
    v_max_f32_dpp v124, v124, v124 quad_perm:[2,3,0,1] row_mask:0xf bank_mask:0xf
    v_mov_b32 v125, v124
    v_smfmac_f32_16x16x64_bf16 v[84:87], v[48:51], a[112:119], v0
    s_nop 0
    v_permlane16_swap_b32 v124, v125
    v_max_f32 v124, v124, v125
    v_mov_b32 v125, v124
    v_smfmac_f32_16x16x64_bf16 v[88:91], v[48:51], a[120:127], v0
    s_nop 0
    v_permlane32_swap_b32 v124, v125
    v_max_f32 v124, v124, v125
    v_mul_f32 v126, s46, v124
    v_fma_f32 v68, v68, s46, -v126
    v_fma_f32 v69, v69, s46, -v126
    v_fma_f32 v70, v70, s46, -v126
    v_fma_f32 v71, v71, s46, -v126
    v_exp_f32 v68, v68
    v_exp_f32 v69, v69
    v_exp_f32 v70, v70
    v_exp_f32 v71, v71
    v_cvt_pk_bf16_f32 v72, v68, v69
    v_cvt_pk_bf16_f32 v73, v70, v71
    v_and_b32 v52, v72, v6
    v_and_b32 v53, v73, v6
    v_and_b32_dpp v54, v72, v6 quad_perm:[2,3,0,1] row_mask:0xf bank_mask:0xf
    v_and_b32_dpp v55, v73, v6 quad_perm:[2,3,0,1] row_mask:0xf bank_mask:0xf
    v_fma_f32 v127, v64, s46, -v126
    v_exp_f32 v127, v127
    v_mfma_f32_16x16x32_bf16 v[100:103], v[92:95], v[52:55], 0
    v_cvt_pk_bf16_f32 v74, v127, 0
    v_and_b32_dpp v56, v72, v7 quad_perm:[2,3,0,1] row_mask:0xf bank_mask:0xf
    v_and_b32_dpp v57, v73, v7 quad_perm:[2,3,0,1] row_mask:0xf bank_mask:0xf
    v_and_b32 v58, v72, v7
    v_and_b32 v59, v73, v7
    v_mfma_f32_16x16x32_bf16 v[68:71], v[80:83], v[72:75], 0
    v_mov_b32_dpp v124, v127 quad_perm:[0,1,0,1] row_mask:0xf bank_mask:0xf
    v_mov_b32_dpp v125, v127 quad_perm:[2,3,2,3] row_mask:0xf bank_mask:0xf
    v_mfma_f32_16x16x32_bf16 v[100:103], v[96:99], v[56:59], v[100:103]
    v_add_f32 v84, v84, v86
    v_add_f32 v85, v85, v87
    v_add_f32 v88, v88, v90
    v_add_f32 v89, v89, v91
    v_cvt_pk_bf16_f32 v124, v124, v125
    v_cvt_pk_bf16_f32 v66, v84, v85
    v_cvt_pk_bf16_f32 v67, v88, v89
    v_and_b32 v62, v124, v6
    v_and_b32 v63, v124, v7
    v_add_f32_dpp v68, v68, v69 quad_perm:[2,3,0,1] row_mask:0xf bank_mask:0xf
    v_mov_b64 v[92:93], 0
    v_mfma_f32_16x16x16_bf16 v[100:103], v[66:67], v[62:63], v[100:103]
    s_nop 0
    v_rcp_f32 v68, v68
    v_mov_b64 v[94:95], 0
    v_mov_b64 v[96:97], 0
    v_mov_b64 v[98:99], 0
    v_mov_b64 v[108:109], 0
    v_mov_b64 v[110:111], 0
    v_mov_b64 v[112:113], 0
    v_mul_f32 v100, v100, v68
    v_mul_f32 v101, v101, v68
    v_mul_f32 v102, v102, v68
    v_mul_f32 v103, v103, v68
    v_cvt_pk_bf16_f32 v72, v100, v101
    v_cvt_pk_bf16_f32 v73, v102, v103
    ds_write_b64 v105, v[72:73] offset:21504
    v_mov_b64 v[114:115], 0
    buffer_load_dwordx4 v[116:119], v1, s[4:7], s36 offen sc1
    s_add_u32 s51, s36, 8192
    s_add_u32 s32, s32, 1
    s_add_u32 s50, s50, 8192
    s_add_u32 s33, s33, 24576
    s_add_u32 s48, s33, 4096
    s_waitcnt lgkmcnt(0)
    s_barrier
    ds_read_b128 v[20:23], v1 offset:21504
    ds_read_b128 v[28:31], v1 offset:22528
    v_xor_b32 v106, 32, v1
    ds_read_b128 v[24:27], v106 offset:21504
    ds_read_b128 v[32:35], v106 offset:22528
    buffer_load_dwordx4 v[120:123], v1, s[4:7], s36 offen offset:1024 sc1
    s_waitcnt lgkmcnt(3)
    v_smfmac_f32_16x16x64_bf16 v[92:95], v[20:23], a[128:135], v0
    v_smfmac_f32_16x16x64_bf16 v[96:99], v[20:23], a[136:143], v0
    s_waitcnt lgkmcnt(2)
    v_smfmac_f32_16x16x64_bf16 v[92:95], v[28:31], a[192:199], v0
    buffer_load_dwordx4 v1, s[4:7], s51 offen sc1 lds
    v_smfmac_f32_16x16x64_bf16 v[96:99], v[28:31], a[200:207], v0
    s_waitcnt lgkmcnt(1)
    v_smfmac_f32_16x16x64_bf16 v[92:95], v[24:27], a[160:167], v0
    v_smfmac_f32_16x16x64_bf16 v[96:99], v[24:27], a[168:175], v0
    s_waitcnt lgkmcnt(0)
    v_smfmac_f32_16x16x64_bf16 v[92:95], v[32:35], a[224:231], v0
    buffer_load_dwordx4 v1, s[4:7], s51 offen offset:1024 sc1 lds
    v_smfmac_f32_16x16x64_bf16 v[96:99], v[32:35], a[232:239], v0
    v_smfmac_f32_16x16x64_bf16 v[108:111], v[20:23], a[144:151], v0
    v_cvt_pk_bf16_f32 v52, v92, v93
    v_smfmac_f32_16x16x64_bf16 v[112:115], v[20:23], a[152:159], v0
    v_cvt_pk_bf16_f32 v53, v94, v95
    v_smfmac_f32_16x16x64_bf16 v[108:111], v[24:27], a[176:183], v0
    v_cvt_pk_bf16_f32 v54, v96, v97
    v_smfmac_f32_16x16x64_bf16 v[112:115], v[24:27], a[184:191], v0
    v_cvt_pk_bf16_f32 v55, v98, v99
    v_smfmac_f32_16x16x64_bf16 v[108:111], v[28:31], a[208:215], v0
    v_and_or_b32 v52, v52, -2, s35
    v_smfmac_f32_16x16x64_bf16 v[108:111], v[32:35], a[240:247], v0
    buffer_store_dwordx4 v[52:55], v4, s[4:7], 0 offen
    v_smfmac_f32_16x16x64_bf16 v[112:115], v[28:31], a[216:223], v0
    s_cmp_lg_u32 s24, 0
    v_smfmac_f32_16x16x64_bf16 v[112:115], v[32:35], a[248:255], v0
    s_nop 1
    v_cvt_pk_bf16_f32 v56, v108, v109
    v_cvt_pk_bf16_f32 v57, v110, v111
    v_and_or_b32 v56, v56, -2, s35
    v_mov_b64 v[100:101], 0
    v_mov_b64 v[102:103], 0
    v_mov_b64 v[104:105], 0
    v_cvt_pk_bf16_f32 v58, v112, v113
    v_cvt_pk_bf16_f32 v59, v114, v115
    buffer_store_dwordx4 v[56:59], v4, s[4:7], s57 offen
    s_barrier
    s_cbranch_scc1 L_r_other
    v_mov_b64 v[106:107], 0
    v_mov_b64 v[108:109], 0
    v_mov_b64 v[110:111], 0
    v_mov_b64 v[112:113], 0
    v_mov_b64 v[114:115], 0
    ds_read_b128 v[84:87], v2 offset:32768
    ds_read_b128 v[88:91], v2 offset:33792
    ds_read_b128 v[92:95], v2 offset:34816
    ds_read_b128 v[96:99], v2 offset:35840
    s_sub_u32 s30, s35, 1
    s_nop 15
    s_nop 15
    s_nop 15
    s_nop 15
    s_nop 1
    buffer_load_dwordx4 v[20:23], v1, s[4:7], s39 offen offset:0 sc1
    buffer_load_dwordx4 v[24:27], v1, s[4:7], s39 offen offset:1024 sc1
    buffer_load_dwordx4 v[28:31], v1, s[4:7], s39 offen offset:2048 sc1
    buffer_load_dwordx4 v[32:35], v1, s[4:7], s39 offen offset:3072 sc1
    buffer_load_dwordx4 v[36:39], v1, s[4:7], s49 offen offset:0 sc1
    buffer_load_dwordx4 v[40:43], v1, s[4:7], s49 offen offset:1024 sc1
    buffer_load_dwordx4 v[44:47], v1, s[4:7], s49 offen offset:2048 sc1
    buffer_load_dwordx4 v[48:51], v1, s[4:7], s49 offen offset:3072 sc1
    buffer_load_dwordx4 v[52:55], v1, s[4:7], s39 offen offset:0 sc1
    buffer_load_dwordx4 v[56:59], v1, s[4:7], s39 offen offset:1024 sc1
    buffer_load_dwordx4 v[60:63], v1, s[4:7], s39 offen offset:2048 sc1
    buffer_load_dwordx4 v[64:67], v1, s[4:7], s39 offen offset:3072 sc1
    buffer_load_dwordx4 v[68:71], v1, s[4:7], s49 offen offset:0 sc1
    buffer_load_dwordx4 v[72:75], v1, s[4:7], s49 offen offset:1024 sc1
    buffer_load_dwordx4 v[76:79], v1, s[4:7], s49 offen offset:2048 sc1
    buffer_load_dwordx4 v[80:83], v1, s[4:7], s49 offen offset:3072 sc1
L_r_pa2:
    s_waitcnt vmcnt(15)
    v_mfma_f32_16x16x32_bf16 v[124:127], v[20:23], v[8:11], 0
    s_waitcnt vmcnt(14)
    v_bitop3_b32 v21, 1, v20, s30 bitop3:0x60
    v_mfma_f32_16x16x32_bf16 v[124:127], v[24:27], v[8:11], v[124:127]
    s_waitcnt vmcnt(13)
    v_bitop3_b32 v21, v21, v24, s30 bitop3:0x60
    v_mfma_f32_16x16x32_bf16 v[124:127], v[28:31], v[8:11], v[124:127]
    s_waitcnt vmcnt(12)
    v_bitop3_b32 v21, v21, v28, s30 bitop3:0x60
    v_mfma_f32_16x16x32_bf16 v[124:127], v[32:35], v[8:11], v[124:127]
    s_waitcnt vmcnt(11)
    v_bitop3_b32 v21, v21, v32, s30 bitop3:0x60
    v_mfma_f32_16x16x32_bf16 v[124:127], v[36:39], v[8:11], v[124:127]
    s_waitcnt vmcnt(10)
    v_bitop3_b32 v21, v21, v36, s30 bitop3:0x60
    v_cmp_ne_u32 s[40:41], 1, v18
    v_mfma_f32_16x16x32_bf16 v[124:127], v[40:43], v[8:11], v[124:127]
    s_waitcnt vmcnt(9)
    v_bitop3_b32 v21, v21, v40, s30 bitop3:0x60
    v_mfma_f32_16x16x32_bf16 v[124:127], v[44:47], v[8:11], v[124:127]
    v_bitop3_b32 v21, v21, v44, s30 bitop3:0x60
    s_waitcnt vmcnt(8)
    v_mfma_f32_16x16x32_bf16 v[124:127], v[48:51], v[8:11], v[124:127]
    v_bitop3_b32 v21, v21, v48, s30 bitop3:0x60
    v_cmp_ne_u32 vcc, 1, v21
    s_nop 5
    v_cvt_pk_bf16_f32 v127, v126, v127
    v_cvt_pk_bf16_f32 v126, v124, v125
    v_min_u32 v126, 0xfffffffe, v126
    s_cbranch_vccnz L_r_again
L_r_pub:
    buffer_store_dwordx2 v[126:127], v5, s[4:7], s33 offen
    s_cmp_eq_u32 s32, 63
    s_cbranch_scc1 L_r_last
    s_waitcnt vmcnt(1)
    ds_read_b128 v[52:55], v2 offset:0
    ds_read_b128 v[56:59], v2 offset:1024
    ds_read_b128 v[60:63], v2 offset:2048
    ds_read_b128 v[64:67], v2 offset:3072
    ds_read_b128 v[68:71], v2 offset:16384
    ds_read_b128 v[72:75], v2 offset:17408
    ds_read_b128 v[76:79], v2 offset:18432
    ds_read_b128 v[80:83], v2 offset:19456
L_r_endstep:
    s_bitcmp1_b32 s41, 31
    s_cbranch_scc1 L_r_kvslow
    s_add_u32 s36, s36, 24576
    s_xor_b32 s35, s35, 1
    s_branch L_r_b3
L_r_again:
    s_waitcnt vmcnt(7)
    v_mfma_f32_16x16x32_bf16 v[124:127], v[52:55], v[8:11], 0
    s_waitcnt vmcnt(6)
    v_bitop3_b32 v53, 1, v52, s30 bitop3:0x60
    v_mfma_f32_16x16x32_bf16 v[124:127], v[56:59], v[8:11], v[124:127]
    s_waitcnt vmcnt(5)
    v_bitop3_b32 v53, v53, v56, s30 bitop3:0x60
    v_mfma_f32_16x16x32_bf16 v[124:127], v[60:63], v[8:11], v[124:127]
    s_waitcnt vmcnt(4)
    v_bitop3_b32 v53, v53, v60, s30 bitop3:0x60
    v_mfma_f32_16x16x32_bf16 v[124:127], v[64:67], v[8:11], v[124:127]
    s_waitcnt vmcnt(3)
    v_bitop3_b32 v53, v53, v64, s30 bitop3:0x60
    v_mfma_f32_16x16x32_bf16 v[124:127], v[68:71], v[8:11], v[124:127]
    s_waitcnt vmcnt(2)
    v_bitop3_b32 v53, v53, v68, s30 bitop3:0x60
    v_cmp_ne_u32 s[40:41], 1, v18
    v_mfma_f32_16x16x32_bf16 v[124:127], v[72:75], v[8:11], v[124:127]
    s_waitcnt vmcnt(1)
    v_bitop3_b32 v53, v53, v72, s30 bitop3:0x60
    v_mfma_f32_16x16x32_bf16 v[124:127], v[76:79], v[8:11], v[124:127]
    v_bitop3_b32 v53, v53, v76, s30 bitop3:0x60
    s_waitcnt vmcnt(0)
    v_mfma_f32_16x16x32_bf16 v[124:127], v[80:83], v[8:11], v[124:127]
    v_bitop3_b32 v53, v53, v80, s30 bitop3:0x60
    v_cmp_ne_u32 vcc, 1, v53
    s_nop 5
    v_cvt_pk_bf16_f32 v127, v126, v127
    v_cvt_pk_bf16_f32 v126, v124, v125
    v_min_u32 v126, 0xfffffffe, v126
    s_cbranch_vccz L_r_pub
    buffer_load_dwordx4 v[20:23], v1, s[4:7], s39 offen offset:0 sc1
    buffer_load_dwordx4 v[24:27], v1, s[4:7], s39 offen offset:1024 sc1
    buffer_load_dwordx4 v[28:31], v1, s[4:7], s39 offen offset:2048 sc1
    buffer_load_dwordx4 v[32:35], v1, s[4:7], s39 offen offset:3072 sc1
    buffer_load_dwordx4 v[36:39], v1, s[4:7], s49 offen offset:0 sc1
    buffer_load_dwordx4 v[40:43], v1, s[4:7], s49 offen offset:1024 sc1
    buffer_load_dwordx4 v[44:47], v1, s[4:7], s49 offen offset:2048 sc1
    buffer_load_dwordx4 v[48:51], v1, s[4:7], s49 offen offset:3072 sc1
    s_sub_u32 s27, s27, 1
    s_cbranch_scc1 L_exit
    buffer_load_dwordx4 v[52:55], v1, s[4:7], s39 offen offset:0 sc1
    buffer_load_dwordx4 v[56:59], v1, s[4:7], s39 offen offset:1024 sc1
    buffer_load_dwordx4 v[60:63], v1, s[4:7], s39 offen offset:2048 sc1
    buffer_load_dwordx4 v[64:67], v1, s[4:7], s39 offen offset:3072 sc1
    buffer_load_dwordx4 v[68:71], v1, s[4:7], s49 offen offset:0 sc1
    buffer_load_dwordx4 v[72:75], v1, s[4:7], s49 offen offset:1024 sc1
    buffer_load_dwordx4 v[76:79], v1, s[4:7], s49 offen offset:2048 sc1
    buffer_load_dwordx4 v[80:83], v1, s[4:7], s49 offen offset:3072 sc1
    s_branch L_r_pa2
L_r_other:
    s_cmp_eq_u32 s32, 63
    s_cbranch_scc1 L_r_fin
    v_mov_b64 v[106:107], 0
    v_mov_b64 v[108:109], 0
    v_mov_b64 v[110:111], 0
    v_mov_b64 v[112:113], 0
    v_mov_b64 v[114:115], 0
    s_waitcnt vmcnt(0)
    ds_read_b128 v[52:55], v2 offset:0
    ds_read_b128 v[56:59], v2 offset:1024
    ds_read_b128 v[60:63], v2 offset:2048
    ds_read_b128 v[64:67], v2 offset:3072
    ds_read_b128 v[68:71], v2 offset:16384
    ds_read_b128 v[72:75], v2 offset:17408
    ds_read_b128 v[76:79], v2 offset:18432
    ds_read_b128 v[80:83], v2 offset:19456
    ds_read_b128 v[84:87], v2 offset:32768
    ds_read_b128 v[88:91], v2 offset:33792
    ds_read_b128 v[92:95], v2 offset:34816
    ds_read_b128 v[96:99], v2 offset:35840
    v_cmp_ne_u32 s[40:41], 1, v18
    s_nop 3
    s_branch L_r_endstep
L_r_kvslow:
    buffer_load_dword v18, v19, s[4:7], s36 offen sc1
    s_sub_u32 s27, s27, 1
    s_cbranch_scc1 L_exit
    s_waitcnt vmcnt(0)
    v_cmp_ne_u32 s[40:41], 1, v18
    s_nop 3
    s_branch L_r_endstep
.p2align 6
L_r_att1:
    s_waitcnt vmcnt(4)
    v_max_u32 v124, v24, v26
    v_cmp_eq_u32 vcc, -1, v124
    buffer_load_dwordx4 v[44:47], v1, s[4:7], s48 offen offset:2048
    ds_read_b128 v[52:55], v2 offset:49152
    ds_read_b128 v[56:59], v2 offset:50176
    ds_read_b128 v[60:63], v2 offset:51200
    ds_read_b128 v[64:67], v2 offset:52224
    s_cbranch_vccz L_r_var1
L_r_att2:
    s_waitcnt vmcnt(4)
    v_max_u32 v124, v28, v30
    v_cmp_eq_u32 vcc, -1, v124
    buffer_load_dwordx4 v[48:51], v1, s[4:7], s48 offen offset:3072
    ds_read_b128 v[68:71], v3 offset:0
    ds_read_b128 v[72:75], v3 offset:1024
    ds_read_b128 v[76:79], v3 offset:2048
    ds_read_b128 v[80:83], v3 offset:3072
    s_cbranch_vccz L_r_var2
L_r_att3:
    s_waitcnt vmcnt(4)
    v_max_u32 v124, v32, v34
    v_cmp_eq_u32 vcc, -1, v124
    buffer_load_dwordx4 v[20:23], v1, s[4:7], s33 offen offset:0 sc1
    ds_read_b128 v[84:87], v3 offset:16384
    ds_read_b128 v[88:91], v3 offset:17408
    ds_read_b128 v[92:95], v3 offset:18432
    ds_read_b128 v[96:99], v3 offset:19456
    s_cbranch_vccz L_r_var3
L_r_att4:
    s_waitcnt vmcnt(4)
    v_max_u32 v124, v36, v38
    v_cmp_eq_u32 vcc, -1, v124
    buffer_load_dwordx4 v[24:27], v1, s[4:7], s33 offen offset:1024 sc1
    ds_read_b128 v[52:55], v3 offset:32768
    ds_read_b128 v[56:59], v3 offset:33792
    ds_read_b128 v[60:63], v3 offset:34816
    ds_read_b128 v[64:67], v3 offset:35840
    s_cbranch_vccz L_r_var4
L_r_att5:
    s_waitcnt vmcnt(4)
    v_max_u32 v124, v40, v42
    v_cmp_eq_u32 vcc, -1, v124
    buffer_load_dwordx4 v[28:31], v1, s[4:7], s33 offen offset:2048 sc1
    ds_read_b128 v[68:71], v3 offset:49152
    ds_read_b128 v[72:75], v3 offset:50176
    ds_read_b128 v[76:79], v3 offset:51200
    ds_read_b128 v[80:83], v3 offset:52224
    s_cbranch_vccz L_r_var5
L_r_att6:
    s_waitcnt vmcnt(4)
    v_max_u32 v124, v44, v46
    v_cmp_eq_u32 vcc, -1, v124
    buffer_load_dwordx4 v[32:35], v1, s[4:7], s33 offen offset:3072 sc1
    ds_read_b128 v[84:87], v2 offset:0
    ds_read_b128 v[88:91], v2 offset:1024
    ds_read_b128 v[92:95], v2 offset:2048
    ds_read_b128 v[96:99], v2 offset:3072
    s_cbranch_vccz L_r_var6
L_r_att7:
    s_waitcnt vmcnt(4)
    v_max_u32 v124, v48, v50
    v_cmp_eq_u32 vcc, -1, v124
    buffer_load_dwordx4 v[36:39], v1, s[4:7], s48 offen offset:0 sc1
    ds_read_b128 v[52:55], v2 offset:16384
    ds_read_b128 v[56:59], v2 offset:17408
    ds_read_b128 v[60:63], v2 offset:18432
    ds_read_b128 v[64:67], v2 offset:19456
    s_cbranch_vccz L_r_var7
    s_sub_u32 s27, s27, 1
    s_cbranch_scc1 L_exit
    s_waitcnt lgkmcnt(0)
    ds_read_b128 v[52:55], v2 offset:0
    ds_read_b128 v[56:59], v2 offset:1024
    ds_read_b128 v[60:63], v2 offset:2048
    ds_read_b128 v[64:67], v2 offset:3072
    ds_read_b128 v[68:71], v2 offset:16384
    ds_read_b128 v[72:75], v2 offset:17408
    ds_read_b128 v[76:79], v2 offset:18432
    ds_read_b128 v[80:83], v2 offset:19456
    ds_read_b128 v[84:87], v2 offset:32768
    ds_read_b128 v[88:91], v2 offset:33792
    ds_read_b128 v[92:95], v2 offset:34816
    ds_read_b128 v[96:99], v2 offset:35840
L_r_atts0:
    s_waitcnt vmcnt(4)
    v_max_u32 v124, v20, v22
    v_cmp_eq_u32 vcc, -1, v124
    buffer_load_dwordx4 v[40:43], v1, s[4:7], s48 offen offset:1024 sc1
    s_cbranch_vccz L_r_vars0
L_r_atts1:
    s_waitcnt vmcnt(4)
    v_max_u32 v124, v24, v26
    v_cmp_eq_u32 vcc, -1, v124
    buffer_load_dwordx4 v[44:47], v1, s[4:7], s48 offen offset:2048 sc1
    ds_read_b128 v[52:55], v2 offset:49152
    ds_read_b128 v[56:59], v2 offset:50176
    ds_read_b128 v[60:63], v2 offset:51200
    ds_read_b128 v[64:67], v2 offset:52224
    s_cbranch_vccz L_r_vars1
L_r_atts2:
    s_waitcnt vmcnt(4)
    v_max_u32 v124, v28, v30
    v_cmp_eq_u32 vcc, -1, v124
    buffer_load_dwordx4 v[48:51], v1, s[4:7], s48 offen offset:3072 sc1
    ds_read_b128 v[68:71], v3 offset:0
    ds_read_b128 v[72:75], v3 offset:1024
    ds_read_b128 v[76:79], v3 offset:2048
    ds_read_b128 v[80:83], v3 offset:3072
    s_cbranch_vccz L_r_vars2
    s_branch L_r_att3
L_r_var1:
    s_waitcnt lgkmcnt(8)
    v_smfmac_f32_16x16x64_bf16 v[108:111], v[24:27], v[68:75], v0
    ds_read_b128 v[68:71], v3 offset:0
    v_smfmac_f32_16x16x64_bf16 v[112:115], v[24:27], v[76:83], v0
    ds_read_b128 v[72:75], v3 offset:1024
    v_smfmac_f32_16x16x64_bf16 v[100:103], v[24:27], v[144:151], v0
    ds_read_b128 v[76:79], v3 offset:2048
    v_smfmac_f32_16x16x64_bf16 v[104:107], v[24:27], v[152:159], v0
    s_waitcnt vmcnt(4) lgkmcnt(7)
    ds_read_b128 v[80:83], v3 offset:3072
    v_smfmac_f32_16x16x64_bf16 v[108:111], v[28:31], v[84:91], v0
    buffer_load_dwordx4 v[48:51], v1, s[4:7], s48 offen offset:3072
    ds_read_b128 v[84:87], v3 offset:16384
    v_smfmac_f32_16x16x64_bf16 v[112:115], v[28:31], v[92:99], v0
    ds_read_b128 v[88:91], v3 offset:17408
    v_smfmac_f32_16x16x64_bf16 v[100:103], v[28:31], v[160:167], v0
    ds_read_b128 v[92:95], v3 offset:18432
    v_smfmac_f32_16x16x64_bf16 v[104:107], v[28:31], v[168:175], v0
    s_waitcnt vmcnt(4) lgkmcnt(7)
    ds_read_b128 v[96:99], v3 offset:19456
    v_smfmac_f32_16x16x64_bf16 v[108:111], v[32:35], v[52:59], v0
    buffer_load_dwordx4 v[20:23], v1, s[4:7], s33 offen offset:0 sc1
    ds_read_b128 v[52:55], v3 offset:32768
    v_smfmac_f32_16x16x64_bf16 v[112:115], v[32:35], v[60:67], v0
    ds_read_b128 v[56:59], v3 offset:33792
    v_smfmac_f32_16x16x64_bf16 v[100:103], v[32:35], v[176:183], v0
    ds_read_b128 v[60:63], v3 offset:34816
    v_smfmac_f32_16x16x64_bf16 v[104:107], v[32:35], v[184:191], v0
    s_waitcnt vmcnt(4) lgkmcnt(7)
    ds_read_b128 v[64:67], v3 offset:35840
    v_smfmac_f32_16x16x64_bf16 v[108:111], v[36:39], v[68:75], v0
    ds_read_b128 v[68:71], v3 offset:49152
    v_smfmac_f32_16x16x64_bf16 v[112:115], v[36:39], v[76:83], v0
    ds_read_b128 v[72:75], v3 offset:50176
    v_smfmac_f32_16x16x64_bf16 v[100:103], v[36:39], v[192:199], v0
    ds_read_b128 v[76:79], v3 offset:51200
    v_smfmac_f32_16x16x64_bf16 v[104:107], v[36:39], v[200:207], v0
    s_waitcnt vmcnt(3) lgkmcnt(7)
    ds_read_b128 v[80:83], v3 offset:52224
    v_smfmac_f32_16x16x64_bf16 v[108:111], v[40:43], v[84:91], v0
    ds_read_b128 v[84:87], v2 offset:0
    v_smfmac_f32_16x16x64_bf16 v[112:115], v[40:43], v[92:99], v0
    ds_read_b128 v[88:91], v2 offset:1024
    v_smfmac_f32_16x16x64_bf16 v[100:103], v[40:43], v[208:215], v0
    ds_read_b128 v[92:95], v2 offset:2048
    v_smfmac_f32_16x16x64_bf16 v[104:107], v[40:43], v[216:223], v0
    s_waitcnt vmcnt(2) lgkmcnt(7)
    ds_read_b128 v[96:99], v2 offset:3072
    v_smfmac_f32_16x16x64_bf16 v[108:111], v[44:47], v[52:59], v0
    buffer_load_dword v18, v19, s[4:7], s36 offen sc1
    v_smfmac_f32_16x16x64_bf16 v[112:115], v[44:47], v[60:67], v0
    v_max3_u32 v124, v124, v28, v30
    v_smfmac_f32_16x16x64_bf16 v[100:103], v[44:47], v[224:231], v0
    v_max3_u32 v124, v124, v32, v34
    v_smfmac_f32_16x16x64_bf16 v[104:107], v[44:47], v[232:239], v0
    s_waitcnt vmcnt(2) lgkmcnt(4)
    v_max3_u32 v124, v124, v36, v38
    v_smfmac_f32_16x16x64_bf16 v[108:111], v[48:51], v[68:75], v0
    v_max3_u32 v124, v124, v40, v42
    v_smfmac_f32_16x16x64_bf16 v[112:115], v[48:51], v[76:83], v0
    v_max3_u32 v124, v124, v44, v46
    v_smfmac_f32_16x16x64_bf16 v[100:103], v[48:51], v[240:247], v0
    v_max3_u32 v124, v124, v48, v50
    v_smfmac_f32_16x16x64_bf16 v[104:107], v[48:51], v[248:255], v0
    s_waitcnt vmcnt(1) lgkmcnt(0)
    v_smfmac_f32_16x16x64_bf16 v[108:111], v[20:23], v[84:91], v0
    v_max3_u32 v124, v124, v20, v22
    v_smfmac_f32_16x16x64_bf16 v[100:103], v[20:23], v[128:135], v0
    v_cmp_eq_u32 vcc, -1, v124
    v_smfmac_f32_16x16x64_bf16 v[112:115], v[20:23], v[92:99], v0
    buffer_store_dwordx2 v[126:127], v16, s[4:7], s50 offen sc1
    v_smfmac_f32_16x16x64_bf16 v[104:107], v[20:23], v[136:143], v0
    s_cbranch_vccz L_r_p1ok
    s_branch L_r_redo
L_r_var2:
    s_waitcnt lgkmcnt(8)
    v_smfmac_f32_16x16x64_bf16 v[108:111], v[28:31], v[84:91], v0
    ds_read_b128 v[84:87], v3 offset:16384
    v_smfmac_f32_16x16x64_bf16 v[112:115], v[28:31], v[92:99], v0
    ds_read_b128 v[88:91], v3 offset:17408
    v_smfmac_f32_16x16x64_bf16 v[100:103], v[28:31], v[160:167], v0
    ds_read_b128 v[92:95], v3 offset:18432
    v_smfmac_f32_16x16x64_bf16 v[104:107], v[28:31], v[168:175], v0
    s_waitcnt vmcnt(4) lgkmcnt(7)
    ds_read_b128 v[96:99], v3 offset:19456
    v_smfmac_f32_16x16x64_bf16 v[108:111], v[32:35], v[52:59], v0
    buffer_load_dwordx4 v[20:23], v1, s[4:7], s33 offen offset:0 sc1
    ds_read_b128 v[52:55], v3 offset:32768
    v_smfmac_f32_16x16x64_bf16 v[112:115], v[32:35], v[60:67], v0
    ds_read_b128 v[56:59], v3 offset:33792
    v_smfmac_f32_16x16x64_bf16 v[100:103], v[32:35], v[176:183], v0
    ds_read_b128 v[60:63], v3 offset:34816
    v_smfmac_f32_16x16x64_bf16 v[104:107], v[32:35], v[184:191], v0
    s_waitcnt vmcnt(4) lgkmcnt(7)
    ds_read_b128 v[64:67], v3 offset:35840
    v_smfmac_f32_16x16x64_bf16 v[108:111], v[36:39], v[68:75], v0
    buffer_load_dwordx4 v[24:27], v1, s[4:7], s33 offen offset:1024 sc1
    ds_read_b128 v[68:71], v3 offset:49152
    v_smfmac_f32_16x16x64_bf16 v[112:115], v[36:39], v[76:83], v0
    ds_read_b128 v[72:75], v3 offset:50176
    v_smfmac_f32_16x16x64_bf16 v[100:103], v[36:39], v[192:199], v0
    ds_read_b128 v[76:79], v3 offset:51200
    v_smfmac_f32_16x16x64_bf16 v[104:107], v[36:39], v[200:207], v0
    s_waitcnt vmcnt(4) lgkmcnt(7)
    ds_read_b128 v[80:83], v3 offset:52224
    v_smfmac_f32_16x16x64_bf16 v[108:111], v[40:43], v[84:91], v0
    ds_read_b128 v[84:87], v2 offset:0
    v_smfmac_f32_16x16x64_bf16 v[112:115], v[40:43], v[92:99], v0
    ds_read_b128 v[88:91], v2 offset:1024
    v_smfmac_f32_16x16x64_bf16 v[100:103], v[40:43], v[208:215], v0
    ds_read_b128 v[92:95], v2 offset:2048
    v_smfmac_f32_16x16x64_bf16 v[104:107], v[40:43], v[216:223], v0
    s_waitcnt vmcnt(3) lgkmcnt(7)
    ds_read_b128 v[96:99], v2 offset:3072
    v_smfmac_f32_16x16x64_bf16 v[108:111], v[44:47], v[52:59], v0
    ds_read_b128 v[52:55], v2 offset:16384
    v_smfmac_f32_16x16x64_bf16 v[112:115], v[44:47], v[60:67], v0
    ds_read_b128 v[56:59], v2 offset:17408
    v_smfmac_f32_16x16x64_bf16 v[100:103], v[44:47], v[224:231], v0
    ds_read_b128 v[60:63], v2 offset:18432
    v_smfmac_f32_16x16x64_bf16 v[104:107], v[44:47], v[232:239], v0
    s_waitcnt vmcnt(2) lgkmcnt(7)
    ds_read_b128 v[64:67], v2 offset:19456
    v_smfmac_f32_16x16x64_bf16 v[108:111], v[48:51], v[68:75], v0
    buffer_load_dword v18, v19, s[4:7], s36 offen sc1
    v_smfmac_f32_16x16x64_bf16 v[112:115], v[48:51], v[76:83], v0
    v_max3_u32 v124, v124, v32, v34
    v_smfmac_f32_16x16x64_bf16 v[100:103], v[48:51], v[240:247], v0
    v_max3_u32 v124, v124, v36, v38
    v_smfmac_f32_16x16x64_bf16 v[104:107], v[48:51], v[248:255], v0
    s_waitcnt vmcnt(2) lgkmcnt(4)
    v_max3_u32 v124, v124, v40, v42
    v_smfmac_f32_16x16x64_bf16 v[108:111], v[20:23], v[84:91], v0
    v_max3_u32 v124, v124, v44, v46
    v_smfmac_f32_16x16x64_bf16 v[112:115], v[20:23], v[92:99], v0
    v_max3_u32 v124, v124, v48, v50
    v_smfmac_f32_16x16x64_bf16 v[100:103], v[20:23], v[128:135], v0
    v_max3_u32 v124, v124, v20, v22
    v_smfmac_f32_16x16x64_bf16 v[104:107], v[20:23], v[136:143], v0
    s_waitcnt vmcnt(1) lgkmcnt(0)
    v_smfmac_f32_16x16x64_bf16 v[108:111], v[24:27], v[52:59], v0
    v_max3_u32 v124, v124, v24, v26
    v_smfmac_f32_16x16x64_bf16 v[100:103], v[24:27], v[144:151], v0
    v_cmp_eq_u32 vcc, -1, v124
    v_smfmac_f32_16x16x64_bf16 v[112:115], v[24:27], v[60:67], v0
    buffer_store_dwordx2 v[126:127], v16, s[4:7], s50 offen sc1
    v_smfmac_f32_16x16x64_bf16 v[104:107], v[24:27], v[152:159], v0
    s_cbranch_vccz L_r_p1ok
    s_branch L_r_redo
L_r_var3:
    s_waitcnt lgkmcnt(8)
    v_smfmac_f32_16x16x64_bf16 v[108:111], v[32:35], v[52:59], v0
    ds_read_b128 v[52:55], v3 offset:32768
    v_smfmac_f32_16x16x64_bf16 v[112:115], v[32:35], v[60:67], v0
    ds_read_b128 v[56:59], v3 offset:33792
    v_smfmac_f32_16x16x64_bf16 v[100:103], v[32:35], v[176:183], v0
    ds_read_b128 v[60:63], v3 offset:34816
    v_smfmac_f32_16x16x64_bf16 v[104:107], v[32:35], v[184:191], v0
    s_waitcnt vmcnt(4) lgkmcnt(7)
    ds_read_b128 v[64:67], v3 offset:35840
    v_smfmac_f32_16x16x64_bf16 v[108:111], v[36:39], v[68:75], v0
    buffer_load_dwordx4 v[24:27], v1, s[4:7], s33 offen offset:1024 sc1
    ds_read_b128 v[68:71], v3 offset:49152
    v_smfmac_f32_16x16x64_bf16 v[112:115], v[36:39], v[76:83], v0
    ds_read_b128 v[72:75], v3 offset:50176
    v_smfmac_f32_16x16x64_bf16 v[100:103], v[36:39], v[192:199], v0
    ds_read_b128 v[76:79], v3 offset:51200
    v_smfmac_f32_16x16x64_bf16 v[104:107], v[36:39], v[200:207], v0
    s_waitcnt vmcnt(4) lgkmcnt(7)
    ds_read_b128 v[80:83], v3 offset:52224
    v_smfmac_f32_16x16x64_bf16 v[108:111], v[40:43], v[84:91], v0
    buffer_load_dwordx4 v[28:31], v1, s[4:7], s33 offen offset:2048 sc1
    ds_read_b128 v[84:87], v2 offset:0
    v_smfmac_f32_16x16x64_bf16 v[112:115], v[40:43], v[92:99], v0
    ds_read_b128 v[88:91], v2 offset:1024
    v_smfmac_f32_16x16x64_bf16 v[100:103], v[40:43], v[208:215], v0
    ds_read_b128 v[92:95], v2 offset:2048
    v_smfmac_f32_16x16x64_bf16 v[104:107], v[40:43], v[216:223], v0
    s_waitcnt vmcnt(4) lgkmcnt(7)
    ds_read_b128 v[96:99], v2 offset:3072
    v_smfmac_f32_16x16x64_bf16 v[108:111], v[44:47], v[52:59], v0
    ds_read_b128 v[52:55], v2 offset:16384
    v_smfmac_f32_16x16x64_bf16 v[112:115], v[44:47], v[60:67], v0
    ds_read_b128 v[56:59], v2 offset:17408
    v_smfmac_f32_16x16x64_bf16 v[100:103], v[44:47], v[224:231], v0
    ds_read_b128 v[60:63], v2 offset:18432
    v_smfmac_f32_16x16x64_bf16 v[104:107], v[44:47], v[232:239], v0
    s_waitcnt vmcnt(3) lgkmcnt(7)
    ds_read_b128 v[64:67], v2 offset:19456
    v_smfmac_f32_16x16x64_bf16 v[108:111], v[48:51], v[68:75], v0
    ds_read_b128 v[68:71], v2 offset:32768
    v_smfmac_f32_16x16x64_bf16 v[112:115], v[48:51], v[76:83], v0
    ds_read_b128 v[72:75], v2 offset:33792
    v_smfmac_f32_16x16x64_bf16 v[100:103], v[48:51], v[240:247], v0
    ds_read_b128 v[76:79], v2 offset:34816
    v_smfmac_f32_16x16x64_bf16 v[104:107], v[48:51], v[248:255], v0
    s_waitcnt vmcnt(2) lgkmcnt(7)
    ds_read_b128 v[80:83], v2 offset:35840
    v_smfmac_f32_16x16x64_bf16 v[108:111], v[20:23], v[84:91], v0
    buffer_load_dword v18, v19, s[4:7], s36 offen sc1
    v_smfmac_f32_16x16x64_bf16 v[112:115], v[20:23], v[92:99], v0
    v_max3_u32 v124, v124, v36, v38
    v_smfmac_f32_16x16x64_bf16 v[100:103], v[20:23], v[128:135], v0
    v_max3_u32 v124, v124, v40, v42
    v_smfmac_f32_16x16x64_bf16 v[104:107], v[20:23], v[136:143], v0
    s_waitcnt vmcnt(2) lgkmcnt(4)
    v_max3_u32 v124, v124, v44, v46
    v_smfmac_f32_16x16x64_bf16 v[108:111], v[24:27], v[52:59], v0
    v_max3_u32 v124, v124, v48, v50
    v_smfmac_f32_16x16x64_bf16 v[112:115], v[24:27], v[60:67], v0
    v_max3_u32 v124, v124, v20, v22
    v_smfmac_f32_16x16x64_bf16 v[100:103], v[24:27], v[144:151], v0
    v_max3_u32 v124, v124, v24, v26
    v_smfmac_f32_16x16x64_bf16 v[104:107], v[24:27], v[152:159], v0
    s_waitcnt vmcnt(1) lgkmcnt(0)
    v_smfmac_f32_16x16x64_bf16 v[108:111], v[28:31], v[68:75], v0
    v_max3_u32 v124, v124, v28, v30
    v_smfmac_f32_16x16x64_bf16 v[100:103], v[28:31], v[160:167], v0
    v_cmp_eq_u32 vcc, -1, v124
    v_smfmac_f32_16x16x64_bf16 v[112:115], v[28:31], v[76:83], v0
    buffer_store_dwordx2 v[126:127], v16, s[4:7], s50 offen sc1
    v_smfmac_f32_16x16x64_bf16 v[104:107], v[28:31], v[168:175], v0
    s_cbranch_vccz L_r_p1ok
    s_branch L_r_redo
L_r_var4:
    s_waitcnt lgkmcnt(8)
    v_smfmac_f32_16x16x64_bf16 v[108:111], v[36:39], v[68:75], v0
    ds_read_b128 v[68:71], v3 offset:49152
    v_smfmac_f32_16x16x64_bf16 v[112:115], v[36:39], v[76:83], v0
    ds_read_b128 v[72:75], v3 offset:50176
    v_smfmac_f32_16x16x64_bf16 v[100:103], v[36:39], v[192:199], v0
    ds_read_b128 v[76:79], v3 offset:51200
    v_smfmac_f32_16x16x64_bf16 v[104:107], v[36:39], v[200:207], v0
    s_waitcnt vmcnt(4) lgkmcnt(7)
    ds_read_b128 v[80:83], v3 offset:52224
    v_smfmac_f32_16x16x64_bf16 v[108:111], v[40:43], v[84:91], v0
    buffer_load_dwordx4 v[28:31], v1, s[4:7], s33 offen offset:2048 sc1
    ds_read_b128 v[84:87], v2 offset:0
    v_smfmac_f32_16x16x64_bf16 v[112:115], v[40:43], v[92:99], v0
    ds_read_b128 v[88:91], v2 offset:1024
    v_smfmac_f32_16x16x64_bf16 v[100:103], v[40:43], v[208:215], v0
    ds_read_b128 v[92:95], v2 offset:2048
    v_smfmac_f32_16x16x64_bf16 v[104:107], v[40:43], v[216:223], v0
    s_waitcnt vmcnt(4) lgkmcnt(7)
    ds_read_b128 v[96:99], v2 offset:3072
    v_smfmac_f32_16x16x64_bf16 v[108:111], v[44:47], v[52:59], v0
    buffer_load_dwordx4 v[32:35], v1, s[4:7], s33 offen offset:3072 sc1
    ds_read_b128 v[52:55], v2 offset:16384
    v_smfmac_f32_16x16x64_bf16 v[112:115], v[44:47], v[60:67], v0
    ds_read_b128 v[56:59], v2 offset:17408
    v_smfmac_f32_16x16x64_bf16 v[100:103], v[44:47], v[224:231], v0
    ds_read_b128 v[60:63], v2 offset:18432
    v_smfmac_f32_16x16x64_bf16 v[104:107], v[44:47], v[232:239], v0
    s_waitcnt vmcnt(4) lgkmcnt(7)
    ds_read_b128 v[64:67], v2 offset:19456
    v_smfmac_f32_16x16x64_bf16 v[108:111], v[48:51], v[68:75], v0
    ds_read_b128 v[68:71], v2 offset:32768
    v_smfmac_f32_16x16x64_bf16 v[112:115], v[48:51], v[76:83], v0
    ds_read_b128 v[72:75], v2 offset:33792
    v_smfmac_f32_16x16x64_bf16 v[100:103], v[48:51], v[240:247], v0
    ds_read_b128 v[76:79], v2 offset:34816
    v_smfmac_f32_16x16x64_bf16 v[104:107], v[48:51], v[248:255], v0
    s_waitcnt vmcnt(3) lgkmcnt(7)
    ds_read_b128 v[80:83], v2 offset:35840
    v_smfmac_f32_16x16x64_bf16 v[108:111], v[20:23], v[84:91], v0
    ds_read_b128 v[84:87], v2 offset:49152
    v_smfmac_f32_16x16x64_bf16 v[112:115], v[20:23], v[92:99], v0
    ds_read_b128 v[88:91], v2 offset:50176
    v_smfmac_f32_16x16x64_bf16 v[100:103], v[20:23], v[128:135], v0
    ds_read_b128 v[92:95], v2 offset:51200
    v_smfmac_f32_16x16x64_bf16 v[104:107], v[20:23], v[136:143], v0
    s_waitcnt vmcnt(2) lgkmcnt(7)
    ds_read_b128 v[96:99], v2 offset:52224
    v_smfmac_f32_16x16x64_bf16 v[108:111], v[24:27], v[52:59], v0
    buffer_load_dword v18, v19, s[4:7], s36 offen sc1
    v_smfmac_f32_16x16x64_bf16 v[112:115], v[24:27], v[60:67], v0
    v_max3_u32 v124, v124, v40, v42
    v_smfmac_f32_16x16x64_bf16 v[100:103], v[24:27], v[144:151], v0
    v_max3_u32 v124, v124, v44, v46
    v_smfmac_f32_16x16x64_bf16 v[104:107], v[24:27], v[152:159], v0
    s_waitcnt vmcnt(2) lgkmcnt(4)
    v_max3_u32 v124, v124, v48, v50
    v_smfmac_f32_16x16x64_bf16 v[108:111], v[28:31], v[68:75], v0
    v_max3_u32 v124, v124, v20, v22
    v_smfmac_f32_16x16x64_bf16 v[112:115], v[28:31], v[76:83], v0
    v_max3_u32 v124, v124, v24, v26
    v_smfmac_f32_16x16x64_bf16 v[100:103], v[28:31], v[160:167], v0
    v_max3_u32 v124, v124, v28, v30
    v_smfmac_f32_16x16x64_bf16 v[104:107], v[28:31], v[168:175], v0
    s_waitcnt vmcnt(1) lgkmcnt(0)
    v_smfmac_f32_16x16x64_bf16 v[108:111], v[32:35], v[84:91], v0
    v_max3_u32 v124, v124, v32, v34
    v_smfmac_f32_16x16x64_bf16 v[100:103], v[32:35], v[176:183], v0
    v_cmp_eq_u32 vcc, -1, v124
    v_smfmac_f32_16x16x64_bf16 v[112:115], v[32:35], v[92:99], v0
    buffer_store_dwordx2 v[126:127], v16, s[4:7], s50 offen sc1
    v_smfmac_f32_16x16x64_bf16 v[104:107], v[32:35], v[184:191], v0
    s_cbranch_vccz L_r_p1ok
    s_branch L_r_redo
L_r_var5:
    s_waitcnt lgkmcnt(8)
    v_smfmac_f32_16x16x64_bf16 v[108:111], v[40:43], v[84:91], v0
    ds_read_b128 v[84:87], v2 offset:0
    v_smfmac_f32_16x16x64_bf16 v[112:115], v[40:43], v[92:99], v0
    ds_read_b128 v[88:91], v2 offset:1024
    v_smfmac_f32_16x16x64_bf16 v[100:103], v[40:43], v[208:215], v0
    ds_read_b128 v[92:95], v2 offset:2048
    v_smfmac_f32_16x16x64_bf16 v[104:107], v[40:43], v[216:223], v0
    s_waitcnt vmcnt(4) lgkmcnt(7)
    ds_read_b128 v[96:99], v2 offset:3072
    v_smfmac_f32_16x16x64_bf16 v[108:111], v[44:47], v[52:59], v0
    buffer_load_dwordx4 v[32:35], v1, s[4:7], s33 offen offset:3072 sc1
    ds_read_b128 v[52:55], v2 offset:16384
    v_smfmac_f32_16x16x64_bf16 v[112:115], v[44:47], v[60:67], v0
    ds_read_b128 v[56:59], v2 offset:17408
    v_smfmac_f32_16x16x64_bf16 v[100:103], v[44:47], v[224:231], v0
    ds_read_b128 v[60:63], v2 offset:18432
    v_smfmac_f32_16x16x64_bf16 v[104:107], v[44:47], v[232:239], v0
    s_waitcnt vmcnt(4) lgkmcnt(7)
    ds_read_b128 v[64:67], v2 offset:19456
    v_smfmac_f32_16x16x64_bf16 v[108:111], v[48:51], v[68:75], v0
    buffer_load_dwordx4 v[36:39], v1, s[4:7], s48 offen offset:0 sc1
    ds_read_b128 v[68:71], v2 offset:32768
    v_smfmac_f32_16x16x64_bf16 v[112:115], v[48:51], v[76:83], v0
    ds_read_b128 v[72:75], v2 offset:33792
    v_smfmac_f32_16x16x64_bf16 v[100:103], v[48:51], v[240:247], v0
    ds_read_b128 v[76:79], v2 offset:34816
    v_smfmac_f32_16x16x64_bf16 v[104:107], v[48:51], v[248:255], v0
    s_waitcnt vmcnt(4) lgkmcnt(7)
    ds_read_b128 v[80:83], v2 offset:35840
    v_smfmac_f32_16x16x64_bf16 v[108:111], v[20:23], v[84:91], v0
    ds_read_b128 v[84:87], v2 offset:49152
    v_smfmac_f32_16x16x64_bf16 v[112:115], v[20:23], v[92:99], v0
    ds_read_b128 v[88:91], v2 offset:50176
    v_smfmac_f32_16x16x64_bf16 v[100:103], v[20:23], v[128:135], v0
    ds_read_b128 v[92:95], v2 offset:51200
    v_smfmac_f32_16x16x64_bf16 v[104:107], v[20:23], v[136:143], v0
    s_waitcnt vmcnt(3) lgkmcnt(7)
    ds_read_b128 v[96:99], v2 offset:52224
    v_smfmac_f32_16x16x64_bf16 v[108:111], v[24:27], v[52:59], v0
    ds_read_b128 v[52:55], v3 offset:0
    v_smfmac_f32_16x16x64_bf16 v[112:115], v[24:27], v[60:67], v0
    ds_read_b128 v[56:59], v3 offset:1024
    v_smfmac_f32_16x16x64_bf16 v[100:103], v[24:27], v[144:151], v0
    ds_read_b128 v[60:63], v3 offset:2048
    v_smfmac_f32_16x16x64_bf16 v[104:107], v[24:27], v[152:159], v0
    s_waitcnt vmcnt(2) lgkmcnt(7)
    ds_read_b128 v[64:67], v3 offset:3072
    v_smfmac_f32_16x16x64_bf16 v[108:111], v[28:31], v[68:75], v0
    buffer_load_dword v18, v19, s[4:7], s36 offen sc1
    v_smfmac_f32_16x16x64_bf16 v[112:115], v[28:31], v[76:83], v0
    v_max3_u32 v124, v124, v44, v46
    v_smfmac_f32_16x16x64_bf16 v[100:103], v[28:31], v[160:167], v0
    v_max3_u32 v124, v124, v48, v50
    v_smfmac_f32_16x16x64_bf16 v[104:107], v[28:31], v[168:175], v0
    s_waitcnt vmcnt(2) lgkmcnt(4)
    v_max3_u32 v124, v124, v20, v22
    v_smfmac_f32_16x16x64_bf16 v[108:111], v[32:35], v[84:91], v0
    v_max3_u32 v124, v124, v24, v26
    v_smfmac_f32_16x16x64_bf16 v[112:115], v[32:35], v[92:99], v0
    v_max3_u32 v124, v124, v28, v30
    v_smfmac_f32_16x16x64_bf16 v[100:103], v[32:35], v[176:183], v0
    v_max3_u32 v124, v124, v32, v34
    v_smfmac_f32_16x16x64_bf16 v[104:107], v[32:35], v[184:191], v0
    s_waitcnt vmcnt(1) lgkmcnt(0)
    v_smfmac_f32_16x16x64_bf16 v[108:111], v[36:39], v[52:59], v0
    v_max3_u32 v124, v124, v36, v38
    v_smfmac_f32_16x16x64_bf16 v[100:103], v[36:39], v[192:199], v0
    v_cmp_eq_u32 vcc, -1, v124
    v_smfmac_f32_16x16x64_bf16 v[112:115], v[36:39], v[60:67], v0
    buffer_store_dwordx2 v[126:127], v16, s[4:7], s50 offen sc1
    v_smfmac_f32_16x16x64_bf16 v[104:107], v[36:39], v[200:207], v0
    s_cbranch_vccz L_r_p1ok
    s_branch L_r_redo
L_r_var6:
    s_waitcnt lgkmcnt(8)
    v_smfmac_f32_16x16x64_bf16 v[108:111], v[44:47], v[52:59], v0
    ds_read_b128 v[52:55], v2 offset:16384
    v_smfmac_f32_16x16x64_bf16 v[112:115], v[44:47], v[60:67], v0
    ds_read_b128 v[56:59], v2 offset:17408
    v_smfmac_f32_16x16x64_bf16 v[100:103], v[44:47], v[224:231], v0
    ds_read_b128 v[60:63], v2 offset:18432
    v_smfmac_f32_16x16x64_bf16 v[104:107], v[44:47], v[232:239], v0
    s_waitcnt vmcnt(4) lgkmcnt(7)
    ds_read_b128 v[64:67], v2 offset:19456
    v_smfmac_f32_16x16x64_bf16 v[108:111], v[48:51], v[68:75], v0
    buffer_load_dwordx4 v[36:39], v1, s[4:7], s48 offen offset:0 sc1
    ds_read_b128 v[68:71], v2 offset:32768
    v_smfmac_f32_16x16x64_bf16 v[112:115], v[48:51], v[76:83], v0
    ds_read_b128 v[72:75], v2 offset:33792
    v_smfmac_f32_16x16x64_bf16 v[100:103], v[48:51], v[240:247], v0
    ds_read_b128 v[76:79], v2 offset:34816
    v_smfmac_f32_16x16x64_bf16 v[104:107], v[48:51], v[248:255], v0
    s_waitcnt vmcnt(4) lgkmcnt(7)
    ds_read_b128 v[80:83], v2 offset:35840
    v_smfmac_f32_16x16x64_bf16 v[108:111], v[20:23], v[84:91], v0
    buffer_load_dwordx4 v[40:43], v1, s[4:7], s48 offen offset:1024 sc1
    ds_read_b128 v[84:87], v2 offset:49152
    v_smfmac_f32_16x16x64_bf16 v[112:115], v[20:23], v[92:99], v0
    ds_read_b128 v[88:91], v2 offset:50176
    v_smfmac_f32_16x16x64_bf16 v[100:103], v[20:23], v[128:135], v0
    ds_read_b128 v[92:95], v2 offset:51200
    v_smfmac_f32_16x16x64_bf16 v[104:107], v[20:23], v[136:143], v0
    s_waitcnt vmcnt(4) lgkmcnt(7)
    ds_read_b128 v[96:99], v2 offset:52224
    v_smfmac_f32_16x16x64_bf16 v[108:111], v[24:27], v[52:59], v0
    ds_read_b128 v[52:55], v3 offset:0
    v_smfmac_f32_16x16x64_bf16 v[112:115], v[24:27], v[60:67], v0
    ds_read_b128 v[56:59], v3 offset:1024
    v_smfmac_f32_16x16x64_bf16 v[100:103], v[24:27], v[144:151], v0
    ds_read_b128 v[60:63], v3 offset:2048
    v_smfmac_f32_16x16x64_bf16 v[104:107], v[24:27], v[152:159], v0
    s_waitcnt vmcnt(3) lgkmcnt(7)
    ds_read_b128 v[64:67], v3 offset:3072
    v_smfmac_f32_16x16x64_bf16 v[108:111], v[28:31], v[68:75], v0
    ds_read_b128 v[68:71], v3 offset:16384
    v_smfmac_f32_16x16x64_bf16 v[112:115], v[28:31], v[76:83], v0
    ds_read_b128 v[72:75], v3 offset:17408
    v_smfmac_f32_16x16x64_bf16 v[100:103], v[28:31], v[160:167], v0
    ds_read_b128 v[76:79], v3 offset:18432
    v_smfmac_f32_16x16x64_bf16 v[104:107], v[28:31], v[168:175], v0
    s_waitcnt vmcnt(2) lgkmcnt(7)
    ds_read_b128 v[80:83], v3 offset:19456
    v_smfmac_f32_16x16x64_bf16 v[108:111], v[32:35], v[84:91], v0
    buffer_load_dword v18, v19, s[4:7], s36 offen sc1
    v_smfmac_f32_16x16x64_bf16 v[112:115], v[32:35], v[92:99], v0
    v_max3_u32 v124, v124, v48, v50
    v_smfmac_f32_16x16x64_bf16 v[100:103], v[32:35], v[176:183], v0
    v_max3_u32 v124, v124, v20, v22
    v_smfmac_f32_16x16x64_bf16 v[104:107], v[32:35], v[184:191], v0
    s_waitcnt vmcnt(2) lgkmcnt(4)
    v_max3_u32 v124, v124, v24, v26
    v_smfmac_f32_16x16x64_bf16 v[108:111], v[36:39], v[52:59], v0
    v_max3_u32 v124, v124, v28, v30
    v_smfmac_f32_16x16x64_bf16 v[112:115], v[36:39], v[60:67], v0
    v_max3_u32 v124, v124, v32, v34
    v_smfmac_f32_16x16x64_bf16 v[100:103], v[36:39], v[192:199], v0
    v_max3_u32 v124, v124, v36, v38
    v_smfmac_f32_16x16x64_bf16 v[104:107], v[36:39], v[200:207], v0
    s_waitcnt vmcnt(1) lgkmcnt(0)
    v_smfmac_f32_16x16x64_bf16 v[108:111], v[40:43], v[68:75], v0
    v_max3_u32 v124, v124, v40, v42
    v_smfmac_f32_16x16x64_bf16 v[100:103], v[40:43], v[208:215], v0
    v_cmp_eq_u32 vcc, -1, v124
    v_smfmac_f32_16x16x64_bf16 v[112:115], v[40:43], v[76:83], v0
    buffer_store_dwordx2 v[126:127], v16, s[4:7], s50 offen sc1
    v_smfmac_f32_16x16x64_bf16 v[104:107], v[40:43], v[216:223], v0
    s_cbranch_vccz L_r_p1ok
    s_branch L_r_redo
L_r_var7:
    s_waitcnt lgkmcnt(8)
    v_smfmac_f32_16x16x64_bf16 v[108:111], v[48:51], v[68:75], v0
    ds_read_b128 v[68:71], v2 offset:32768
    v_smfmac_f32_16x16x64_bf16 v[112:115], v[48:51], v[76:83], v0
    ds_read_b128 v[72:75], v2 offset:33792
    v_smfmac_f32_16x16x64_bf16 v[100:103], v[48:51], v[240:247], v0
    ds_read_b128 v[76:79], v2 offset:34816
    v_smfmac_f32_16x16x64_bf16 v[104:107], v[48:51], v[248:255], v0
    s_waitcnt vmcnt(4) lgkmcnt(7)
    ds_read_b128 v[80:83], v2 offset:35840
    v_smfmac_f32_16x16x64_bf16 v[108:111], v[20:23], v[84:91], v0
    buffer_load_dwordx4 v[40:43], v1, s[4:7], s48 offen offset:1024 sc1
    ds_read_b128 v[84:87], v2 offset:49152
    v_smfmac_f32_16x16x64_bf16 v[112:115], v[20:23], v[92:99], v0
    ds_read_b128 v[88:91], v2 offset:50176
    v_smfmac_f32_16x16x64_bf16 v[100:103], v[20:23], v[128:135], v0
    ds_read_b128 v[92:95], v2 offset:51200
    v_smfmac_f32_16x16x64_bf16 v[104:107], v[20:23], v[136:143], v0
    s_waitcnt vmcnt(4) lgkmcnt(7)
    ds_read_b128 v[96:99], v2 offset:52224
    v_smfmac_f32_16x16x64_bf16 v[108:111], v[24:27], v[52:59], v0
    buffer_load_dwordx4 v[44:47], v1, s[4:7], s48 offen offset:2048 sc1
    ds_read_b128 v[52:55], v3 offset:0
    v_smfmac_f32_16x16x64_bf16 v[112:115], v[24:27], v[60:67], v0
    ds_read_b128 v[56:59], v3 offset:1024
    v_smfmac_f32_16x16x64_bf16 v[100:103], v[24:27], v[144:151], v0
    ds_read_b128 v[60:63], v3 offset:2048
    v_smfmac_f32_16x16x64_bf16 v[104:107], v[24:27], v[152:159], v0
    s_waitcnt vmcnt(4) lgkmcnt(7)
    ds_read_b128 v[64:67], v3 offset:3072
    v_smfmac_f32_16x16x64_bf16 v[108:111], v[28:31], v[68:75], v0
    ds_read_b128 v[68:71], v3 offset:16384
    v_smfmac_f32_16x16x64_bf16 v[112:115], v[28:31], v[76:83], v0
    ds_read_b128 v[72:75], v3 offset:17408
    v_smfmac_f32_16x16x64_bf16 v[100:103], v[28:31], v[160:167], v0
    ds_read_b128 v[76:79], v3 offset:18432
    v_smfmac_f32_16x16x64_bf16 v[104:107], v[28:31], v[168:175], v0
    s_waitcnt vmcnt(3) lgkmcnt(7)
    ds_read_b128 v[80:83], v3 offset:19456
    v_smfmac_f32_16x16x64_bf16 v[108:111], v[32:35], v[84:91], v0
    ds_read_b128 v[84:87], v3 offset:32768
    v_smfmac_f32_16x16x64_bf16 v[112:115], v[32:35], v[92:99], v0
    ds_read_b128 v[88:91], v3 offset:33792
    v_smfmac_f32_16x16x64_bf16 v[100:103], v[32:35], v[176:183], v0
    ds_read_b128 v[92:95], v3 offset:34816
    v_smfmac_f32_16x16x64_bf16 v[104:107], v[32:35], v[184:191], v0
    s_waitcnt vmcnt(2) lgkmcnt(7)
    ds_read_b128 v[96:99], v3 offset:35840
    v_smfmac_f32_16x16x64_bf16 v[108:111], v[36:39], v[52:59], v0
    buffer_load_dword v18, v19, s[4:7], s36 offen sc1
    v_smfmac_f32_16x16x64_bf16 v[112:115], v[36:39], v[60:67], v0
    v_max3_u32 v124, v124, v20, v22
    v_smfmac_f32_16x16x64_bf16 v[100:103], v[36:39], v[192:199], v0
    v_max3_u32 v124, v124, v24, v26
    v_smfmac_f32_16x16x64_bf16 v[104:107], v[36:39], v[200:207], v0
    s_waitcnt vmcnt(2) lgkmcnt(4)
    v_max3_u32 v124, v124, v28, v30
    v_smfmac_f32_16x16x64_bf16 v[108:111], v[40:43], v[68:75], v0
    v_max3_u32 v124, v124, v32, v34
    v_smfmac_f32_16x16x64_bf16 v[112:115], v[40:43], v[76:83], v0
    v_max3_u32 v124, v124, v36, v38
    v_smfmac_f32_16x16x64_bf16 v[100:103], v[40:43], v[208:215], v0
    v_max3_u32 v124, v124, v40, v42
    v_smfmac_f32_16x16x64_bf16 v[104:107], v[40:43], v[216:223], v0
    s_waitcnt vmcnt(1) lgkmcnt(0)
    v_smfmac_f32_16x16x64_bf16 v[108:111], v[44:47], v[84:91], v0
    v_max3_u32 v124, v124, v44, v46
    v_smfmac_f32_16x16x64_bf16 v[100:103], v[44:47], v[224:231], v0
    v_cmp_eq_u32 vcc, -1, v124
    v_smfmac_f32_16x16x64_bf16 v[112:115], v[44:47], v[92:99], v0
    buffer_store_dwordx2 v[126:127], v16, s[4:7], s50 offen sc1
    v_smfmac_f32_16x16x64_bf16 v[104:107], v[44:47], v[232:239], v0
    s_cbranch_vccz L_r_p1ok
    s_branch L_r_redo
L_r_vars0:
    s_waitcnt lgkmcnt(8)
    v_smfmac_f32_16x16x64_bf16 v[108:111], v[20:23], v[52:59], v0
    ds_read_b128 v[52:55], v2 offset:49152
    v_smfmac_f32_16x16x64_bf16 v[112:115], v[20:23], v[60:67], v0
    ds_read_b128 v[56:59], v2 offset:50176
    v_smfmac_f32_16x16x64_bf16 v[100:103], v[20:23], v[128:135], v0
    ds_read_b128 v[60:63], v2 offset:51200
    v_smfmac_f32_16x16x64_bf16 v[104:107], v[20:23], v[136:143], v0
    s_waitcnt vmcnt(4) lgkmcnt(7)
    ds_read_b128 v[64:67], v2 offset:52224
    v_smfmac_f32_16x16x64_bf16 v[108:111], v[24:27], v[68:75], v0
    buffer_load_dwordx4 v[44:47], v1, s[4:7], s48 offen offset:2048 sc1
    ds_read_b128 v[68:71], v3 offset:0
    v_smfmac_f32_16x16x64_bf16 v[112:115], v[24:27], v[76:83], v0
    ds_read_b128 v[72:75], v3 offset:1024
    v_smfmac_f32_16x16x64_bf16 v[100:103], v[24:27], v[144:151], v0
    ds_read_b128 v[76:79], v3 offset:2048
    v_smfmac_f32_16x16x64_bf16 v[104:107], v[24:27], v[152:159], v0
    s_waitcnt vmcnt(4) lgkmcnt(7)
    ds_read_b128 v[80:83], v3 offset:3072
    v_smfmac_f32_16x16x64_bf16 v[108:111], v[28:31], v[84:91], v0
    buffer_load_dwordx4 v[48:51], v1, s[4:7], s48 offen offset:3072 sc1
    ds_read_b128 v[84:87], v3 offset:16384
    v_smfmac_f32_16x16x64_bf16 v[112:115], v[28:31], v[92:99], v0
    ds_read_b128 v[88:91], v3 offset:17408
    v_smfmac_f32_16x16x64_bf16 v[100:103], v[28:31], v[160:167], v0
    ds_read_b128 v[92:95], v3 offset:18432
    v_smfmac_f32_16x16x64_bf16 v[104:107], v[28:31], v[168:175], v0
    s_waitcnt vmcnt(4) lgkmcnt(7)
    ds_read_b128 v[96:99], v3 offset:19456
    v_smfmac_f32_16x16x64_bf16 v[108:111], v[32:35], v[52:59], v0
    ds_read_b128 v[52:55], v3 offset:32768
    v_smfmac_f32_16x16x64_bf16 v[112:115], v[32:35], v[60:67], v0
    ds_read_b128 v[56:59], v3 offset:33792
    v_smfmac_f32_16x16x64_bf16 v[100:103], v[32:35], v[176:183], v0
    ds_read_b128 v[60:63], v3 offset:34816
    v_smfmac_f32_16x16x64_bf16 v[104:107], v[32:35], v[184:191], v0
    s_waitcnt vmcnt(3) lgkmcnt(7)
    ds_read_b128 v[64:67], v3 offset:35840
    v_smfmac_f32_16x16x64_bf16 v[108:111], v[36:39], v[68:75], v0
    ds_read_b128 v[68:71], v3 offset:49152
    v_smfmac_f32_16x16x64_bf16 v[112:115], v[36:39], v[76:83], v0
    ds_read_b128 v[72:75], v3 offset:50176
    v_smfmac_f32_16x16x64_bf16 v[100:103], v[36:39], v[192:199], v0
    ds_read_b128 v[76:79], v3 offset:51200
    v_smfmac_f32_16x16x64_bf16 v[104:107], v[36:39], v[200:207], v0
    s_waitcnt vmcnt(2) lgkmcnt(7)
    ds_read_b128 v[80:83], v3 offset:52224
    v_smfmac_f32_16x16x64_bf16 v[108:111], v[40:43], v[84:91], v0
    buffer_load_dword v18, v19, s[4:7], s36 offen sc1
    v_smfmac_f32_16x16x64_bf16 v[112:115], v[40:43], v[92:99], v0
    v_max3_u32 v124, v124, v24, v26
    v_smfmac_f32_16x16x64_bf16 v[100:103], v[40:43], v[208:215], v0
    v_max3_u32 v124, v124, v28, v30
    v_smfmac_f32_16x16x64_bf16 v[104:107], v[40:43], v[216:223], v0
    s_waitcnt vmcnt(2) lgkmcnt(4)
    v_max3_u32 v124, v124, v32, v34
    v_smfmac_f32_16x16x64_bf16 v[108:111], v[44:47], v[52:59], v0
    v_max3_u32 v124, v124, v36, v38
    v_smfmac_f32_16x16x64_bf16 v[112:115], v[44:47], v[60:67], v0
    v_max3_u32 v124, v124, v40, v42
    v_smfmac_f32_16x16x64_bf16 v[100:103], v[44:47], v[224:231], v0
    v_max3_u32 v124, v124, v44, v46
    v_smfmac_f32_16x16x64_bf16 v[104:107], v[44:47], v[232:239], v0
    s_waitcnt vmcnt(1) lgkmcnt(0)
    v_smfmac_f32_16x16x64_bf16 v[108:111], v[48:51], v[68:75], v0
    v_max3_u32 v124, v124, v48, v50
    v_smfmac_f32_16x16x64_bf16 v[100:103], v[48:51], v[240:247], v0
    v_cmp_eq_u32 vcc, -1, v124
    v_smfmac_f32_16x16x64_bf16 v[112:115], v[48:51], v[76:83], v0
    buffer_store_dwordx2 v[126:127], v16, s[4:7], s50 offen sc1
    v_smfmac_f32_16x16x64_bf16 v[104:107], v[48:51], v[248:255], v0
    s_cbranch_vccz L_r_p1ok
    s_branch L_r_redo
L_r_vars1:
    s_waitcnt lgkmcnt(8)
    v_smfmac_f32_16x16x64_bf16 v[108:111], v[24:27], v[68:75], v0
    ds_read_b128 v[68:71], v3 offset:0
    v_smfmac_f32_16x16x64_bf16 v[112:115], v[24:27], v[76:83], v0
    ds_read_b128 v[72:75], v3 offset:1024
    v_smfmac_f32_16x16x64_bf16 v[100:103], v[24:27], v[144:151], v0
    ds_read_b128 v[76:79], v3 offset:2048
    v_smfmac_f32_16x16x64_bf16 v[104:107], v[24:27], v[152:159], v0
    s_waitcnt vmcnt(4) lgkmcnt(7)
    ds_read_b128 v[80:83], v3 offset:3072
    v_smfmac_f32_16x16x64_bf16 v[108:111], v[28:31], v[84:91], v0
    buffer_load_dwordx4 v[48:51], v1, s[4:7], s48 offen offset:3072 sc1
    ds_read_b128 v[84:87], v3 offset:16384
    v_smfmac_f32_16x16x64_bf16 v[112:115], v[28:31], v[92:99], v0
    ds_read_b128 v[88:91], v3 offset:17408
    v_smfmac_f32_16x16x64_bf16 v[100:103], v[28:31], v[160:167], v0
    ds_read_b128 v[92:95], v3 offset:18432
    v_smfmac_f32_16x16x64_bf16 v[104:107], v[28:31], v[168:175], v0
    s_waitcnt vmcnt(4) lgkmcnt(7)
    ds_read_b128 v[96:99], v3 offset:19456
    v_smfmac_f32_16x16x64_bf16 v[108:111], v[32:35], v[52:59], v0
    buffer_load_dwordx4 v[20:23], v1, s[4:7], s33 offen offset:0 sc1
    ds_read_b128 v[52:55], v3 offset:32768
    v_smfmac_f32_16x16x64_bf16 v[112:115], v[32:35], v[60:67], v0
    ds_read_b128 v[56:59], v3 offset:33792
    v_smfmac_f32_16x16x64_bf16 v[100:103], v[32:35], v[176:183], v0
    ds_read_b128 v[60:63], v3 offset:34816
    v_smfmac_f32_16x16x64_bf16 v[104:107], v[32:35], v[184:191], v0
    s_waitcnt vmcnt(4) lgkmcnt(7)
    ds_read_b128 v[64:67], v3 offset:35840
    v_smfmac_f32_16x16x64_bf16 v[108:111], v[36:39], v[68:75], v0
    ds_read_b128 v[68:71], v3 offset:49152
    v_smfmac_f32_16x16x64_bf16 v[112:115], v[36:39], v[76:83], v0
    ds_read_b128 v[72:75], v3 offset:50176
    v_smfmac_f32_16x16x64_bf16 v[100:103], v[36:39], v[192:199], v0
    ds_read_b128 v[76:79], v3 offset:51200
    v_smfmac_f32_16x16x64_bf16 v[104:107], v[36:39], v[200:207], v0
    s_waitcnt vmcnt(3) lgkmcnt(7)
    ds_read_b128 v[80:83], v3 offset:52224
    v_smfmac_f32_16x16x64_bf16 v[108:111], v[40:43], v[84:91], v0
    ds_read_b128 v[84:87], v2 offset:0
    v_smfmac_f32_16x16x64_bf16 v[112:115], v[40:43], v[92:99], v0
    ds_read_b128 v[88:91], v2 offset:1024
    v_smfmac_f32_16x16x64_bf16 v[100:103], v[40:43], v[208:215], v0
    ds_read_b128 v[92:95], v2 offset:2048
    v_smfmac_f32_16x16x64_bf16 v[104:107], v[40:43], v[216:223], v0
    s_waitcnt vmcnt(2) lgkmcnt(7)
    ds_read_b128 v[96:99], v2 offset:3072
    v_smfmac_f32_16x16x64_bf16 v[108:111], v[44:47], v[52:59], v0
    buffer_load_dword v18, v19, s[4:7], s36 offen sc1
    v_smfmac_f32_16x16x64_bf16 v[112:115], v[44:47], v[60:67], v0
    v_max3_u32 v124, v124, v28, v30
    v_smfmac_f32_16x16x64_bf16 v[100:103], v[44:47], v[224:231], v0
    v_max3_u32 v124, v124, v32, v34
    v_smfmac_f32_16x16x64_bf16 v[104:107], v[44:47], v[232:239], v0
    s_waitcnt vmcnt(2) lgkmcnt(4)
    v_max3_u32 v124, v124, v36, v38
    v_smfmac_f32_16x16x64_bf16 v[108:111], v[48:51], v[68:75], v0
    v_max3_u32 v124, v124, v40, v42
    v_smfmac_f32_16x16x64_bf16 v[112:115], v[48:51], v[76:83], v0
    v_max3_u32 v124, v124, v44, v46
    v_smfmac_f32_16x16x64_bf16 v[100:103], v[48:51], v[240:247], v0
    v_max3_u32 v124, v124, v48, v50
    v_smfmac_f32_16x16x64_bf16 v[104:107], v[48:51], v[248:255], v0
    s_waitcnt vmcnt(1) lgkmcnt(0)
    v_smfmac_f32_16x16x64_bf16 v[108:111], v[20:23], v[84:91], v0
    v_max3_u32 v124, v124, v20, v22
    v_smfmac_f32_16x16x64_bf16 v[100:103], v[20:23], v[128:135], v0
    v_cmp_eq_u32 vcc, -1, v124
    v_smfmac_f32_16x16x64_bf16 v[112:115], v[20:23], v[92:99], v0
    buffer_store_dwordx2 v[126:127], v16, s[4:7], s50 offen sc1
    v_smfmac_f32_16x16x64_bf16 v[104:107], v[20:23], v[136:143], v0
    s_cbranch_vccz L_r_p1ok
    s_branch L_r_redo
L_r_vars2:
    s_waitcnt lgkmcnt(8)
    v_smfmac_f32_16x16x64_bf16 v[108:111], v[28:31], v[84:91], v0
    ds_read_b128 v[84:87], v3 offset:16384
    v_smfmac_f32_16x16x64_bf16 v[112:115], v[28:31], v[92:99], v0
    ds_read_b128 v[88:91], v3 offset:17408
    v_smfmac_f32_16x16x64_bf16 v[100:103], v[28:31], v[160:167], v0
    ds_read_b128 v[92:95], v3 offset:18432
    v_smfmac_f32_16x16x64_bf16 v[104:107], v[28:31], v[168:175], v0
    s_waitcnt vmcnt(4) lgkmcnt(7)
    ds_read_b128 v[96:99], v3 offset:19456
    v_smfmac_f32_16x16x64_bf16 v[108:111], v[32:35], v[52:59], v0
    buffer_load_dwordx4 v[20:23], v1, s[4:7], s33 offen offset:0 sc1
    ds_read_b128 v[52:55], v3 offset:32768
    v_smfmac_f32_16x16x64_bf16 v[112:115], v[32:35], v[60:67], v0
    ds_read_b128 v[56:59], v3 offset:33792
    v_smfmac_f32_16x16x64_bf16 v[100:103], v[32:35], v[176:183], v0
    ds_read_b128 v[60:63], v3 offset:34816
    v_smfmac_f32_16x16x64_bf16 v[104:107], v[32:35], v[184:191], v0
    s_waitcnt vmcnt(4) lgkmcnt(7)
    ds_read_b128 v[64:67], v3 offset:35840
    v_smfmac_f32_16x16x64_bf16 v[108:111], v[36:39], v[68:75], v0
    buffer_load_dwordx4 v[24:27], v1, s[4:7], s33 offen offset:1024 sc1
    ds_read_b128 v[68:71], v3 offset:49152
    v_smfmac_f32_16x16x64_bf16 v[112:115], v[36:39], v[76:83], v0
    ds_read_b128 v[72:75], v3 offset:50176
    v_smfmac_f32_16x16x64_bf16 v[100:103], v[36:39], v[192:199], v0
    ds_read_b128 v[76:79], v3 offset:51200
    v_smfmac_f32_16x16x64_bf16 v[104:107], v[36:39], v[200:207], v0
    s_waitcnt vmcnt(4) lgkmcnt(7)
    ds_read_b128 v[80:83], v3 offset:52224
    v_smfmac_f32_16x16x64_bf16 v[108:111], v[40:43], v[84:91], v0
    ds_read_b128 v[84:87], v2 offset:0
    v_smfmac_f32_16x16x64_bf16 v[112:115], v[40:43], v[92:99], v0
    ds_read_b128 v[88:91], v2 offset:1024
    v_smfmac_f32_16x16x64_bf16 v[100:103], v[40:43], v[208:215], v0
    ds_read_b128 v[92:95], v2 offset:2048
    v_smfmac_f32_16x16x64_bf16 v[104:107], v[40:43], v[216:223], v0
    s_waitcnt vmcnt(3) lgkmcnt(7)
    ds_read_b128 v[96:99], v2 offset:3072
    v_smfmac_f32_16x16x64_bf16 v[108:111], v[44:47], v[52:59], v0
    ds_read_b128 v[52:55], v2 offset:16384
    v_smfmac_f32_16x16x64_bf16 v[112:115], v[44:47], v[60:67], v0
    ds_read_b128 v[56:59], v2 offset:17408
    v_smfmac_f32_16x16x64_bf16 v[100:103], v[44:47], v[224:231], v0
    ds_read_b128 v[60:63], v2 offset:18432
    v_smfmac_f32_16x16x64_bf16 v[104:107], v[44:47], v[232:239], v0
    s_waitcnt vmcnt(2) lgkmcnt(7)
    ds_read_b128 v[64:67], v2 offset:19456
    v_smfmac_f32_16x16x64_bf16 v[108:111], v[48:51], v[68:75], v0
    buffer_load_dword v18, v19, s[4:7], s36 offen sc1
    v_smfmac_f32_16x16x64_bf16 v[112:115], v[48:51], v[76:83], v0
    v_max3_u32 v124, v124, v32, v34
    v_smfmac_f32_16x16x64_bf16 v[100:103], v[48:51], v[240:247], v0
    v_max3_u32 v124, v124, v36, v38
    v_smfmac_f32_16x16x64_bf16 v[104:107], v[48:51], v[248:255], v0
    s_waitcnt vmcnt(2) lgkmcnt(4)
    v_max3_u32 v124, v124, v40, v42
    v_smfmac_f32_16x16x64_bf16 v[108:111], v[20:23], v[84:91], v0
    v_max3_u32 v124, v124, v44, v46
    v_smfmac_f32_16x16x64_bf16 v[112:115], v[20:23], v[92:99], v0
    v_max3_u32 v124, v124, v48, v50
    v_smfmac_f32_16x16x64_bf16 v[100:103], v[20:23], v[128:135], v0
    v_max3_u32 v124, v124, v20, v22
    v_smfmac_f32_16x16x64_bf16 v[104:107], v[20:23], v[136:143], v0
    s_waitcnt vmcnt(1) lgkmcnt(0)
    v_smfmac_f32_16x16x64_bf16 v[108:111], v[24:27], v[52:59], v0
    v_max3_u32 v124, v124, v24, v26
    v_smfmac_f32_16x16x64_bf16 v[100:103], v[24:27], v[144:151], v0
    v_cmp_eq_u32 vcc, -1, v124
    v_smfmac_f32_16x16x64_bf16 v[112:115], v[24:27], v[60:67], v0
    buffer_store_dwordx2 v[126:127], v16, s[4:7], s50 offen sc1
    v_smfmac_f32_16x16x64_bf16 v[104:107], v[24:27], v[152:159], v0
    s_cbranch_vccz L_r_p1ok
    s_branch L_r_redo
L_r_redo:
    s_sub_u32 s27, s27, 1
    s_cbranch_scc1 L_exit
    s_nop 7
    s_waitcnt lgkmcnt(0)
    ds_read_b128 v[52:55], v2 offset:0
    ds_read_b128 v[56:59], v2 offset:1024
    ds_read_b128 v[60:63], v2 offset:2048
    ds_read_b128 v[64:67], v2 offset:3072
    ds_read_b128 v[68:71], v2 offset:16384
    ds_read_b128 v[72:75], v2 offset:17408
    ds_read_b128 v[76:79], v2 offset:18432
    ds_read_b128 v[80:83], v2 offset:19456
    ds_read_b128 v[84:87], v2 offset:32768
    ds_read_b128 v[88:91], v2 offset:33792
    ds_read_b128 v[92:95], v2 offset:34816
    ds_read_b128 v[96:99], v2 offset:35840
    v_mov_b64 v[100:101], 0
    v_mov_b64 v[102:103], 0
    v_mov_b64 v[104:105], 0
    v_mov_b64 v[106:107], 0
    v_mov_b64 v[108:109], 0
    v_mov_b64 v[110:111], 0
    v_mov_b64 v[112:113], 0
    v_mov_b64 v[114:115], 0
    buffer_load_dwordx4 v[20:23], v1, s[4:7], s33 offen offset:0 sc1
    s_nop 11
    buffer_load_dwordx4 v[24:27], v1, s[4:7], s33 offen offset:1024 sc1
    s_nop 11
    buffer_load_dwordx4 v[28:31], v1, s[4:7], s33 offen offset:2048 sc1
    s_nop 11
    buffer_load_dwordx4 v[32:35], v1, s[4:7], s33 offen offset:3072 sc1
    s_nop 11
    buffer_load_dwordx4 v[36:39], v1, s[4:7], s48 offen offset:0 sc1
    s_branch L_r_atts0
L_r_last:
    buffer_store_dwordx2 v[126:127], v16, s[4:7], s50 offen sc1
    s_mov_b64 exec, -1
    s_waitcnt vmcnt(0)
    s_cmp_lg_u32 s25, 0
    s_cbranch_scc1 L_r_fin
    buffer_wbl2 sc1
L_r_fin:
    s_waitcnt vmcnt(0)
    s_endpgm
L_role_wb:
    s_sub_u32 s28, s26, 1
    s_lshl_b32 s28, s28, 5
    s_add_u32 s28, s28, s25
    s_mul_i32 s29, s28, 171
    s_lshr_b32 s29, s29, 10
    s_mul_i32 s34, s29, 6
    s_sub_u32 s30, s28, s34
    s_lshr_b32 s31, s28, 4
    s_and_b32 s32, s28, 15
    s_lshl_b32 s33, s24, 15
    s_mov_b32 s16, s70
    s_and_b32 s17, s71, 0xffff
    s_mov_b32 s18, 2097152
    s_mov_b32 s19, 0x20000
    v_lshlrev_b32 v5, 4, v0
    s_mov_b32 s37, s30
    s_mov_b32 s38, 131072
    s_mov_b32 s39, 0
    s_lshl_b32 s36, s37, 15
    s_and_b32 s34, s24, 1
    s_lshl_b32 s34, s34, 3
    v_xor_b32 v14, s34, v0
    s_lshl_b32 s34, s24, 13
    s_add_u32 s35, s34, s36
    s_add_u32 s34, s34, s38
    v_xor_b32 v15, 0, v14
    v_lshlrev_b32 v15, 4, v15
    s_add_u32 m0, s34, 0
    s_nop 0
    buffer_load_dwordx4 v15, s[16:19], s35 offen lds
    v_xor_b32 v15, 1, v14
    v_lshlrev_b32 v15, 4, v15
    s_add_u32 m0, s34, 1024
    s_add_u32 s35, s35, 1024
    buffer_load_dwordx4 v15, s[16:19], s35 offen lds
    v_xor_b32 v15, 2, v14
    v_lshlrev_b32 v15, 4, v15
    s_add_u32 m0, s34, 2048
    s_add_u32 s35, s35, 1024
    buffer_load_dwordx4 v15, s[16:19], s35 offen lds
    v_xor_b32 v15, 3, v14
    v_lshlrev_b32 v15, 4, v15
    s_add_u32 m0, s34, 3072
    s_add_u32 s35, s35, 1024
    buffer_load_dwordx4 v15, s[16:19], s35 offen lds
    v_xor_b32 v15, 4, v14
    v_lshlrev_b32 v15, 4, v15
    s_add_u32 m0, s34, 4096
    s_add_u32 s35, s35, 1024
    buffer_load_dwordx4 v15, s[16:19], s35 offen lds
    v_xor_b32 v15, 5, v14
    v_lshlrev_b32 v15, 4, v15
    s_add_u32 m0, s34, 5120
    s_add_u32 s35, s35, 1024
    buffer_load_dwordx4 v15, s[16:19], s35 offen lds
    v_xor_b32 v15, 6, v14
    v_lshlrev_b32 v15, 4, v15
    s_add_u32 m0, s34, 6144
    s_add_u32 s35, s35, 1024
    buffer_load_dwordx4 v15, s[16:19], s35 offen lds
    v_xor_b32 v15, 7, v14
    v_lshlrev_b32 v15, 4, v15
    s_add_u32 m0, s34, 7168
    s_add_u32 s35, s35, 1024
    buffer_load_dwordx4 v15, s[16:19], s35 offen lds
    s_lshl_b32 s36, s29, 8
    v_bfe_u32 v14, v0, 5, 1
    v_mul_u32_u24 v1, 2, v14
    v_bfe_u32 v14, v0, 4, 1
    v_mul_u32_u24 v14, 1, v14
    v_add_u32 v1, v1, v14
    s_and_b32 s34, s24, 1
    s_mul_i32 s34, s34, 4
    s_lshr_b32 s35, s24, 1
    s_mul_i32 s35, s35, 32
    s_add_u32 s34, s34, s35
    v_add_u32 v1, s34, v1
    s_mov_b32 s34, 8192
    v_mul_lo_u32 v1, v1, s34
    v_lshrrev_b32 v14, 3, v0
    v_and_b32 v14, 6, v14
    v_xor_b32 v14, v14, v0
    v_and_b32 v14, 15, v14
    v_lshlrev_b32 v14, 4, v14
    v_add3_u32 v1, v1, v14, s36
    v_lshrrev_b32 v14, 2, v0
    v_lshlrev_b32 v2, 8, v14
    v_and_b32 v14, 7, v14
    v_lshl_add_u32 v2, v14, 5, v2
    v_and_b32 v14, 3, v0
    v_lshl_add_u32 v2, v14, 3, v2
    v_and_b32 v14, 15, v0
    v_lshrrev_b32 v15, 4, v0
    v_add_u32 v6, 0, v15
    v_xor_b32 v6, v6, v14
    v_lshlrev_b32 v6, 4, v6
    v_lshl_add_u32 v6, v14, 10, v6
    v_add_u32 v7, 4, v15
    v_xor_b32 v7, v7, v14
    v_lshlrev_b32 v7, 4, v7
    v_lshl_add_u32 v7, v14, 10, v7
    v_add_u32 v8, 8, v15
    v_xor_b32 v8, v8, v14
    v_lshlrev_b32 v8, 4, v8
    v_lshl_add_u32 v8, v14, 10, v8
    v_add_u32 v9, 12, v15
    v_xor_b32 v9, v9, v14
    v_lshlrev_b32 v9, 4, v9
    v_lshl_add_u32 v9, v14, 10, v9
    s_lshl_b32 s36, s24, 12
    s_add_u32 s36, s36, 0
    s_mov_b32 s12, s74
    s_and_b32 s13, s75, 0xffff
    s_mov_b32 s14, 4194304
    s_mov_b32 s15, 0x20000
    v_xor_b32 v3, 0x80, v1
    s_add_u32 m0, s36, 0
    s_mov_b32 s34, 0
    buffer_load_dwordx4 v1, s[12:15], s34 offen  lds
    s_add_u32 m0, s36, 1024
    s_mov_b32 s34, 65536
    buffer_load_dwordx4 v3, s[12:15], s34 offen  lds
    s_add_u32 m0, s36, 2048
    s_mov_b32 s34, 131072
    buffer_load_dwordx4 v1, s[12:15], s34 offen  lds
    s_add_u32 m0, s36, 3072
    s_mov_b32 s34, 196608
    buffer_load_dwordx4 v3, s[12:15], s34 offen  lds
    s_add_u32 m0, s36, 16384
    s_mov_b32 s34, 524288
    buffer_load_dwordx4 v1, s[12:15], s34 offen  lds
    s_add_u32 m0, s36, 17408
    s_mov_b32 s34, 589824
    buffer_load_dwordx4 v3, s[12:15], s34 offen  lds
    s_add_u32 m0, s36, 18432
    s_mov_b32 s34, 655360
    buffer_load_dwordx4 v1, s[12:15], s34 offen  lds
    s_add_u32 m0, s36, 19456
    s_mov_b32 s34, 720896
    buffer_load_dwordx4 v3, s[12:15], s34 offen  lds
    s_add_u32 m0, s36, 32768
    s_mov_b32 s34, 1048576
    buffer_load_dwordx4 v1, s[12:15], s34 offen  lds
    s_add_u32 m0, s36, 33792
    s_mov_b32 s34, 1114112
    buffer_load_dwordx4 v3, s[12:15], s34 offen  lds
    s_add_u32 m0, s36, 34816
    s_mov_b32 s34, 1179648
    buffer_load_dwordx4 v1, s[12:15], s34 offen  lds
    s_add_u32 m0, s36, 35840
    s_mov_b32 s34, 1245184
    buffer_load_dwordx4 v3, s[12:15], s34 offen  lds
    s_add_u32 m0, s36, 49152
    s_mov_b32 s34, 1572864
    buffer_load_dwordx4 v1, s[12:15], s34 offen  lds
    s_add_u32 m0, s36, 50176
    s_mov_b32 s34, 1638400
    buffer_load_dwordx4 v3, s[12:15], s34 offen  lds
    s_add_u32 m0, s36, 51200
    s_mov_b32 s34, 1703936
    buffer_load_dwordx4 v1, s[12:15], s34 offen  lds
    s_add_u32 m0, s36, 52224
    s_mov_b32 s34, 1769472
    buffer_load_dwordx4 v3, s[12:15], s34 offen  lds
    s_add_u32 m0, s36, 65536
    s_mov_b32 s34, 2097152
    buffer_load_dwordx4 v1, s[12:15], s34 offen  lds
    s_add_u32 m0, s36, 66560
    s_mov_b32 s34, 2162688
    buffer_load_dwordx4 v3, s[12:15], s34 offen  lds
    s_add_u32 m0, s36, 67584
    s_mov_b32 s34, 2228224
    buffer_load_dwordx4 v1, s[12:15], s34 offen  lds
    s_add_u32 m0, s36, 68608
    s_mov_b32 s34, 2293760
    buffer_load_dwordx4 v3, s[12:15], s34 offen  lds
    s_add_u32 m0, s36, 81920
    s_mov_b32 s34, 2621440
    buffer_load_dwordx4 v1, s[12:15], s34 offen  lds
    s_add_u32 m0, s36, 82944
    s_mov_b32 s34, 2686976
    buffer_load_dwordx4 v3, s[12:15], s34 offen  lds
    s_add_u32 m0, s36, 83968
    s_mov_b32 s34, 2752512
    buffer_load_dwordx4 v1, s[12:15], s34 offen  lds
    s_add_u32 m0, s36, 84992
    s_mov_b32 s34, 2818048
    buffer_load_dwordx4 v3, s[12:15], s34 offen  lds
    s_add_u32 m0, s36, 98304
    s_mov_b32 s34, 3145728
    buffer_load_dwordx4 v1, s[12:15], s34 offen  lds
    s_add_u32 m0, s36, 99328
    s_mov_b32 s34, 3211264
    buffer_load_dwordx4 v3, s[12:15], s34 offen  lds
    s_add_u32 m0, s36, 100352
    s_mov_b32 s34, 3276800
    buffer_load_dwordx4 v1, s[12:15], s34 offen  lds
    s_add_u32 m0, s36, 101376
    s_mov_b32 s34, 3342336
    buffer_load_dwordx4 v3, s[12:15], s34 offen  lds
    s_add_u32 m0, s36, 114688
    s_mov_b32 s34, 3670016
    buffer_load_dwordx4 v1, s[12:15], s34 offen  lds
    s_add_u32 m0, s36, 115712
    s_mov_b32 s34, 3735552
    buffer_load_dwordx4 v3, s[12:15], s34 offen  lds
    s_add_u32 m0, s36, 116736
    s_mov_b32 s34, 3801088
    buffer_load_dwordx4 v1, s[12:15], s34 offen  lds
    s_add_u32 m0, s36, 117760
    s_mov_b32 s34, 3866624
    buffer_load_dwordx4 v3, s[12:15], s34 offen  lds
    s_waitcnt vmcnt(28)
    s_barrier
    s_lshl_b32 s34, s24, 6
    v_xor_b32 v14, s34, v2
    v_add_u32 v14, 0, v14
    v_xor_b32 v15, 32, v14
    ds_read_b64_tr_b16 v[128:129], v14 offset:0
    ds_read_b64_tr_b16 v[130:131], v14 offset:4096
    ds_read_b64_tr_b16 v[132:133], v14 offset:8192
    ds_read_b64_tr_b16 v[134:135], v14 offset:12288
    ds_read_b64_tr_b16 v[136:137], v15 offset:0
    ds_read_b64_tr_b16 v[138:139], v15 offset:4096
    ds_read_b64_tr_b16 v[140:141], v15 offset:8192
    ds_read_b64_tr_b16 v[142:143], v15 offset:12288
    s_waitcnt lgkmcnt(0)
    s_waitcnt vmcnt(24)
    s_barrier
    s_mov_b32 s12, s78
    s_and_b32 s13, s79, 0xffff
    s_mov_b32 s14, 4194304
    s_mov_b32 s15, 0x20000
    s_add_u32 m0, s36, 0
    s_mov_b32 s34, 0
    buffer_load_dwordx4 v1, s[12:15], s34 offen  lds
    s_add_u32 m0, s36, 1024
    s_mov_b32 s34, 65536
    buffer_load_dwordx4 v3, s[12:15], s34 offen  lds
    s_add_u32 m0, s36, 2048
    s_mov_b32 s34, 131072
    buffer_load_dwordx4 v1, s[12:15], s34 offen  lds
    s_add_u32 m0, s36, 3072
    s_mov_b32 s34, 196608
    buffer_load_dwordx4 v3, s[12:15], s34 offen  lds
    s_lshl_b32 s34, s24, 6
    v_xor_b32 v14, s34, v2
    v_add_u32 v14, 16384, v14
    v_xor_b32 v15, 32, v14
    ds_read_b64_tr_b16 v[144:145], v14 offset:0
    ds_read_b64_tr_b16 v[146:147], v14 offset:4096
    ds_read_b64_tr_b16 v[148:149], v14 offset:8192
    ds_read_b64_tr_b16 v[150:151], v14 offset:12288
    ds_read_b64_tr_b16 v[152:153], v15 offset:0
    ds_read_b64_tr_b16 v[154:155], v15 offset:4096
    ds_read_b64_tr_b16 v[156:157], v15 offset:8192
    ds_read_b64_tr_b16 v[158:159], v15 offset:12288
    s_waitcnt lgkmcnt(0)
    s_waitcnt vmcnt(24)
    s_barrier
    s_add_u32 m0, s36, 16384
    s_mov_b32 s34, 524288
    buffer_load_dwordx4 v1, s[12:15], s34 offen  lds
    s_add_u32 m0, s36, 17408
    s_mov_b32 s34, 589824
    buffer_load_dwordx4 v3, s[12:15], s34 offen  lds
    s_add_u32 m0, s36, 18432
    s_mov_b32 s34, 655360
    buffer_load_dwordx4 v1, s[12:15], s34 offen  lds
    s_add_u32 m0, s36, 19456
    s_mov_b32 s34, 720896
    buffer_load_dwordx4 v3, s[12:15], s34 offen  lds
    s_lshl_b32 s34, s24, 6
    v_xor_b32 v14, s34, v2
    v_add_u32 v14, 32768, v14
    v_xor_b32 v15, 32, v14
    ds_read_b64_tr_b16 v[160:161], v14 offset:0
    ds_read_b64_tr_b16 v[162:163], v14 offset:4096
    ds_read_b64_tr_b16 v[164:165], v14 offset:8192
    ds_read_b64_tr_b16 v[166:167], v14 offset:12288
    ds_read_b64_tr_b16 v[168:169], v15 offset:0
    ds_read_b64_tr_b16 v[170:171], v15 offset:4096
    ds_read_b64_tr_b16 v[172:173], v15 offset:8192
    ds_read_b64_tr_b16 v[174:175], v15 offset:12288
    s_waitcnt lgkmcnt(0)
    s_waitcnt vmcnt(24)
    s_barrier
    s_add_u32 m0, s36, 32768
    s_mov_b32 s34, 1048576
    buffer_load_dwordx4 v1, s[12:15], s34 offen  lds
    s_add_u32 m0, s36, 33792
    s_mov_b32 s34, 1114112
    buffer_load_dwordx4 v3, s[12:15], s34 offen  lds
    s_add_u32 m0, s36, 34816
    s_mov_b32 s34, 1179648
    buffer_load_dwordx4 v1, s[12:15], s34 offen  lds
    s_add_u32 m0, s36, 35840
    s_mov_b32 s34, 1245184
    buffer_load_dwordx4 v3, s[12:15], s34 offen  lds
    s_lshl_b32 s34, s24, 6
    v_xor_b32 v14, s34, v2
    v_add_u32 v14, 49152, v14
    v_xor_b32 v15, 32, v14
    ds_read_b64_tr_b16 v[176:177], v14 offset:0
    ds_read_b64_tr_b16 v[178:179], v14 offset:4096
    ds_read_b64_tr_b16 v[180:181], v14 offset:8192
    ds_read_b64_tr_b16 v[182:183], v14 offset:12288
    ds_read_b64_tr_b16 v[184:185], v15 offset:0
    ds_read_b64_tr_b16 v[186:187], v15 offset:4096
    ds_read_b64_tr_b16 v[188:189], v15 offset:8192
    ds_read_b64_tr_b16 v[190:191], v15 offset:12288
    s_waitcnt lgkmcnt(0)
    s_waitcnt vmcnt(24)
    s_barrier
    s_add_u32 m0, s36, 49152
    s_mov_b32 s34, 1572864
    buffer_load_dwordx4 v1, s[12:15], s34 offen  lds
    s_add_u32 m0, s36, 50176
    s_mov_b32 s34, 1638400
    buffer_load_dwordx4 v3, s[12:15], s34 offen  lds
    s_add_u32 m0, s36, 51200
    s_mov_b32 s34, 1703936
    buffer_load_dwordx4 v1, s[12:15], s34 offen  lds
    s_add_u32 m0, s36, 52224
    s_mov_b32 s34, 1769472
    buffer_load_dwordx4 v3, s[12:15], s34 offen  lds
    s_lshl_b32 s34, s24, 6
    v_xor_b32 v14, s34, v2
    v_add_u32 v14, 65536, v14
    v_xor_b32 v15, 32, v14
    ds_read_b64_tr_b16 v[192:193], v14 offset:0
    ds_read_b64_tr_b16 v[194:195], v14 offset:4096
    ds_read_b64_tr_b16 v[196:197], v14 offset:8192
    ds_read_b64_tr_b16 v[198:199], v14 offset:12288
    ds_read_b64_tr_b16 v[200:201], v15 offset:0
    ds_read_b64_tr_b16 v[202:203], v15 offset:4096
    ds_read_b64_tr_b16 v[204:205], v15 offset:8192
    ds_read_b64_tr_b16 v[206:207], v15 offset:12288
    s_waitcnt lgkmcnt(0)
    s_waitcnt vmcnt(24)
    s_barrier
    s_add_u32 m0, s36, 65536
    s_mov_b32 s34, 2097152
    buffer_load_dwordx4 v1, s[12:15], s34 offen  lds
    s_add_u32 m0, s36, 66560
    s_mov_b32 s34, 2162688
    buffer_load_dwordx4 v3, s[12:15], s34 offen  lds
    s_add_u32 m0, s36, 67584
    s_mov_b32 s34, 2228224
    buffer_load_dwordx4 v1, s[12:15], s34 offen  lds
    s_add_u32 m0, s36, 68608
    s_mov_b32 s34, 2293760
    buffer_load_dwordx4 v3, s[12:15], s34 offen  lds
    s_lshl_b32 s34, s24, 6
    v_xor_b32 v14, s34, v2
    v_add_u32 v14, 81920, v14
    v_xor_b32 v15, 32, v14
    ds_read_b64_tr_b16 v[208:209], v14 offset:0
    ds_read_b64_tr_b16 v[210:211], v14 offset:4096
    ds_read_b64_tr_b16 v[212:213], v14 offset:8192
    ds_read_b64_tr_b16 v[214:215], v14 offset:12288
    ds_read_b64_tr_b16 v[216:217], v15 offset:0
    ds_read_b64_tr_b16 v[218:219], v15 offset:4096
    ds_read_b64_tr_b16 v[220:221], v15 offset:8192
    ds_read_b64_tr_b16 v[222:223], v15 offset:12288
    s_waitcnt lgkmcnt(0)
    s_waitcnt vmcnt(24)
    s_barrier
    s_add_u32 m0, s36, 81920
    s_mov_b32 s34, 2621440
    buffer_load_dwordx4 v1, s[12:15], s34 offen  lds
    s_add_u32 m0, s36, 82944
    s_mov_b32 s34, 2686976
    buffer_load_dwordx4 v3, s[12:15], s34 offen  lds
    s_add_u32 m0, s36, 83968
    s_mov_b32 s34, 2752512
    buffer_load_dwordx4 v1, s[12:15], s34 offen  lds
    s_add_u32 m0, s36, 84992
    s_mov_b32 s34, 2818048
    buffer_load_dwordx4 v3, s[12:15], s34 offen  lds
    s_lshl_b32 s34, s24, 6
    v_xor_b32 v14, s34, v2
    v_add_u32 v14, 98304, v14
    v_xor_b32 v15, 32, v14
    ds_read_b64_tr_b16 v[224:225], v14 offset:0
    ds_read_b64_tr_b16 v[226:227], v14 offset:4096
    ds_read_b64_tr_b16 v[228:229], v14 offset:8192
    ds_read_b64_tr_b16 v[230:231], v14 offset:12288
    ds_read_b64_tr_b16 v[232:233], v15 offset:0
    ds_read_b64_tr_b16 v[234:235], v15 offset:4096
    ds_read_b64_tr_b16 v[236:237], v15 offset:8192
    ds_read_b64_tr_b16 v[238:239], v15 offset:12288
    s_waitcnt lgkmcnt(0)
    s_waitcnt vmcnt(24)
    s_barrier
    s_add_u32 m0, s36, 98304
    s_mov_b32 s34, 3145728
    buffer_load_dwordx4 v1, s[12:15], s34 offen  lds
    s_add_u32 m0, s36, 99328
    s_mov_b32 s34, 3211264
    buffer_load_dwordx4 v3, s[12:15], s34 offen  lds
    s_add_u32 m0, s36, 100352
    s_mov_b32 s34, 3276800
    buffer_load_dwordx4 v1, s[12:15], s34 offen  lds
    s_add_u32 m0, s36, 101376
    s_mov_b32 s34, 3342336
    buffer_load_dwordx4 v3, s[12:15], s34 offen  lds
    s_lshl_b32 s34, s24, 6
    v_xor_b32 v14, s34, v2
    v_add_u32 v14, 114688, v14
    v_xor_b32 v15, 32, v14
    ds_read_b64_tr_b16 v[240:241], v14 offset:0
    ds_read_b64_tr_b16 v[242:243], v14 offset:4096
    ds_read_b64_tr_b16 v[244:245], v14 offset:8192
    ds_read_b64_tr_b16 v[246:247], v14 offset:12288
    ds_read_b64_tr_b16 v[248:249], v15 offset:0
    ds_read_b64_tr_b16 v[250:251], v15 offset:4096
    ds_read_b64_tr_b16 v[252:253], v15 offset:8192
    ds_read_b64_tr_b16 v[254:255], v15 offset:12288
    s_waitcnt lgkmcnt(0)
    s_waitcnt vmcnt(24)
    s_barrier
    s_add_u32 m0, s36, 114688
    s_mov_b32 s34, 3670016
    buffer_load_dwordx4 v1, s[12:15], s34 offen  lds
    s_add_u32 m0, s36, 115712
    s_mov_b32 s34, 3735552
    buffer_load_dwordx4 v3, s[12:15], s34 offen  lds
    s_add_u32 m0, s36, 116736
    s_mov_b32 s34, 3801088
    buffer_load_dwordx4 v1, s[12:15], s34 offen  lds
    s_add_u32 m0, s36, 117760
    s_mov_b32 s34, 3866624
    buffer_load_dwordx4 v3, s[12:15], s34 offen  lds
    s_lshl_b32 s34, s24, 6
    v_xor_b32 v14, s34, v2
    v_add_u32 v14, 0, v14
    v_xor_b32 v15, 32, v14
    ds_read_b64_tr_b16 a[128:129], v14 offset:0
    ds_read_b64_tr_b16 a[130:131], v14 offset:4096
    ds_read_b64_tr_b16 a[132:133], v14 offset:8192
    ds_read_b64_tr_b16 a[134:135], v14 offset:12288
    ds_read_b64_tr_b16 a[136:137], v15 offset:0
    ds_read_b64_tr_b16 a[138:139], v15 offset:4096
    ds_read_b64_tr_b16 a[140:141], v15 offset:8192
    ds_read_b64_tr_b16 a[142:143], v15 offset:12288
    s_waitcnt lgkmcnt(0)
    s_waitcnt vmcnt(24)
    s_barrier
    s_mov_b32 s12, s76
    s_and_b32 s13, s77, 0xffff
    s_mov_b32 s14, 4194304
    s_mov_b32 s15, 0x20000
    s_add_u32 m0, s36, 0
    s_mov_b32 s34, 0
    buffer_load_dwordx4 v1, s[12:15], s34 offen  lds
    s_add_u32 m0, s36, 1024
    s_mov_b32 s34, 65536
    buffer_load_dwordx4 v3, s[12:15], s34 offen  lds
    s_add_u32 m0, s36, 2048
    s_mov_b32 s34, 131072
    buffer_load_dwordx4 v1, s[12:15], s34 offen  lds
    s_add_u32 m0, s36, 3072
    s_mov_b32 s34, 196608
    buffer_load_dwordx4 v3, s[12:15], s34 offen  lds
    s_lshl_b32 s34, s24, 6
    v_xor_b32 v14, s34, v2
    v_add_u32 v14, 16384, v14
    v_xor_b32 v15, 32, v14
    ds_read_b64_tr_b16 a[144:145], v14 offset:0
    ds_read_b64_tr_b16 a[146:147], v14 offset:4096
    ds_read_b64_tr_b16 a[148:149], v14 offset:8192
    ds_read_b64_tr_b16 a[150:151], v14 offset:12288
    ds_read_b64_tr_b16 a[152:153], v15 offset:0
    ds_read_b64_tr_b16 a[154:155], v15 offset:4096
    ds_read_b64_tr_b16 a[156:157], v15 offset:8192
    ds_read_b64_tr_b16 a[158:159], v15 offset:12288
    s_waitcnt lgkmcnt(0)
    s_waitcnt vmcnt(24)
    s_barrier
    s_add_u32 m0, s36, 16384
    s_mov_b32 s34, 524288
    buffer_load_dwordx4 v1, s[12:15], s34 offen  lds
    s_add_u32 m0, s36, 17408
    s_mov_b32 s34, 589824
    buffer_load_dwordx4 v3, s[12:15], s34 offen  lds
    s_add_u32 m0, s36, 18432
    s_mov_b32 s34, 655360
    buffer_load_dwordx4 v1, s[12:15], s34 offen  lds
    s_add_u32 m0, s36, 19456
    s_mov_b32 s34, 720896
    buffer_load_dwordx4 v3, s[12:15], s34 offen  lds
    s_lshl_b32 s34, s24, 6
    v_xor_b32 v14, s34, v2
    v_add_u32 v14, 32768, v14
    v_xor_b32 v15, 32, v14
    ds_read_b64_tr_b16 a[160:161], v14 offset:0
    ds_read_b64_tr_b16 a[162:163], v14 offset:4096
    ds_read_b64_tr_b16 a[164:165], v14 offset:8192
    ds_read_b64_tr_b16 a[166:167], v14 offset:12288
    ds_read_b64_tr_b16 a[168:169], v15 offset:0
    ds_read_b64_tr_b16 a[170:171], v15 offset:4096
    ds_read_b64_tr_b16 a[172:173], v15 offset:8192
    ds_read_b64_tr_b16 a[174:175], v15 offset:12288
    s_waitcnt lgkmcnt(0)
    s_waitcnt vmcnt(24)
    s_barrier
    s_add_u32 m0, s36, 32768
    s_mov_b32 s34, 1048576
    buffer_load_dwordx4 v1, s[12:15], s34 offen  lds
    s_add_u32 m0, s36, 33792
    s_mov_b32 s34, 1114112
    buffer_load_dwordx4 v3, s[12:15], s34 offen  lds
    s_add_u32 m0, s36, 34816
    s_mov_b32 s34, 1179648
    buffer_load_dwordx4 v1, s[12:15], s34 offen  lds
    s_add_u32 m0, s36, 35840
    s_mov_b32 s34, 1245184
    buffer_load_dwordx4 v3, s[12:15], s34 offen  lds
    s_lshl_b32 s34, s24, 6
    v_xor_b32 v14, s34, v2
    v_add_u32 v14, 49152, v14
    v_xor_b32 v15, 32, v14
    ds_read_b64_tr_b16 a[176:177], v14 offset:0
    ds_read_b64_tr_b16 a[178:179], v14 offset:4096
    ds_read_b64_tr_b16 a[180:181], v14 offset:8192
    ds_read_b64_tr_b16 a[182:183], v14 offset:12288
    ds_read_b64_tr_b16 a[184:185], v15 offset:0
    ds_read_b64_tr_b16 a[186:187], v15 offset:4096
    ds_read_b64_tr_b16 a[188:189], v15 offset:8192
    ds_read_b64_tr_b16 a[190:191], v15 offset:12288
    s_waitcnt lgkmcnt(0)
    s_waitcnt vmcnt(24)
    s_barrier
    s_add_u32 m0, s36, 49152
    s_mov_b32 s34, 1572864
    buffer_load_dwordx4 v1, s[12:15], s34 offen  lds
    s_add_u32 m0, s36, 50176
    s_mov_b32 s34, 1638400
    buffer_load_dwordx4 v3, s[12:15], s34 offen  lds
    s_add_u32 m0, s36, 51200
    s_mov_b32 s34, 1703936
    buffer_load_dwordx4 v1, s[12:15], s34 offen  lds
    s_add_u32 m0, s36, 52224
    s_mov_b32 s34, 1769472
    buffer_load_dwordx4 v3, s[12:15], s34 offen  lds
    s_lshl_b32 s34, s24, 6
    v_xor_b32 v14, s34, v2
    v_add_u32 v14, 65536, v14
    v_xor_b32 v15, 32, v14
    ds_read_b64_tr_b16 a[192:193], v14 offset:0
    ds_read_b64_tr_b16 a[194:195], v14 offset:4096
    ds_read_b64_tr_b16 a[196:197], v14 offset:8192
    ds_read_b64_tr_b16 a[198:199], v14 offset:12288
    ds_read_b64_tr_b16 a[200:201], v15 offset:0
    ds_read_b64_tr_b16 a[202:203], v15 offset:4096
    ds_read_b64_tr_b16 a[204:205], v15 offset:8192
    ds_read_b64_tr_b16 a[206:207], v15 offset:12288
    s_waitcnt lgkmcnt(0)
    s_waitcnt vmcnt(24)
    s_barrier
    s_add_u32 m0, s36, 65536
    s_mov_b32 s34, 2097152
    buffer_load_dwordx4 v1, s[12:15], s34 offen  lds
    s_add_u32 m0, s36, 66560
    s_mov_b32 s34, 2162688
    buffer_load_dwordx4 v3, s[12:15], s34 offen  lds
    s_add_u32 m0, s36, 67584
    s_mov_b32 s34, 2228224
    buffer_load_dwordx4 v1, s[12:15], s34 offen  lds
    s_add_u32 m0, s36, 68608
    s_mov_b32 s34, 2293760
    buffer_load_dwordx4 v3, s[12:15], s34 offen  lds
    s_lshl_b32 s34, s24, 6
    v_xor_b32 v14, s34, v2
    v_add_u32 v14, 81920, v14
    v_xor_b32 v15, 32, v14
    ds_read_b64_tr_b16 a[208:209], v14 offset:0
    ds_read_b64_tr_b16 a[210:211], v14 offset:4096
    ds_read_b64_tr_b16 a[212:213], v14 offset:8192
    ds_read_b64_tr_b16 a[214:215], v14 offset:12288
    ds_read_b64_tr_b16 a[216:217], v15 offset:0
    ds_read_b64_tr_b16 a[218:219], v15 offset:4096
    ds_read_b64_tr_b16 a[220:221], v15 offset:8192
    ds_read_b64_tr_b16 a[222:223], v15 offset:12288
    s_waitcnt lgkmcnt(0)
    s_waitcnt vmcnt(24)
    s_barrier
    s_add_u32 m0, s36, 81920
    s_mov_b32 s34, 2621440
    buffer_load_dwordx4 v1, s[12:15], s34 offen  lds
    s_add_u32 m0, s36, 82944
    s_mov_b32 s34, 2686976
    buffer_load_dwordx4 v3, s[12:15], s34 offen  lds
    s_add_u32 m0, s36, 83968
    s_mov_b32 s34, 2752512
    buffer_load_dwordx4 v1, s[12:15], s34 offen  lds
    s_add_u32 m0, s36, 84992
    s_mov_b32 s34, 2818048
    buffer_load_dwordx4 v3, s[12:15], s34 offen  lds
    s_lshl_b32 s34, s24, 6
    v_xor_b32 v14, s34, v2
    v_add_u32 v14, 98304, v14
    v_xor_b32 v15, 32, v14
    ds_read_b64_tr_b16 a[224:225], v14 offset:0
    ds_read_b64_tr_b16 a[226:227], v14 offset:4096
    ds_read_b64_tr_b16 a[228:229], v14 offset:8192
    ds_read_b64_tr_b16 a[230:231], v14 offset:12288
    ds_read_b64_tr_b16 a[232:233], v15 offset:0
    ds_read_b64_tr_b16 a[234:235], v15 offset:4096
    ds_read_b64_tr_b16 a[236:237], v15 offset:8192
    ds_read_b64_tr_b16 a[238:239], v15 offset:12288
    s_waitcnt lgkmcnt(0)
    s_waitcnt vmcnt(24)
    s_barrier
    s_add_u32 m0, s36, 98304
    s_mov_b32 s34, 3145728
    buffer_load_dwordx4 v1, s[12:15], s34 offen  lds
    s_add_u32 m0, s36, 99328
    s_mov_b32 s34, 3211264
    buffer_load_dwordx4 v3, s[12:15], s34 offen  lds
    s_add_u32 m0, s36, 100352
    s_mov_b32 s34, 3276800
    buffer_load_dwordx4 v1, s[12:15], s34 offen  lds
    s_add_u32 m0, s36, 101376
    s_mov_b32 s34, 3342336
    buffer_load_dwordx4 v3, s[12:15], s34 offen  lds
    s_lshl_b32 s34, s24, 6
    v_xor_b32 v14, s34, v2
    v_add_u32 v14, 114688, v14
    v_xor_b32 v15, 32, v14
    ds_read_b64_tr_b16 a[240:241], v14 offset:0
    ds_read_b64_tr_b16 a[242:243], v14 offset:4096
    ds_read_b64_tr_b16 a[244:245], v14 offset:8192
    ds_read_b64_tr_b16 a[246:247], v14 offset:12288
    ds_read_b64_tr_b16 a[248:249], v15 offset:0
    ds_read_b64_tr_b16 a[250:251], v15 offset:4096
    ds_read_b64_tr_b16 a[252:253], v15 offset:8192
    ds_read_b64_tr_b16 a[254:255], v15 offset:12288
    s_waitcnt lgkmcnt(0)
    s_waitcnt vmcnt(24)
    s_barrier
    s_add_u32 m0, s36, 114688
    s_mov_b32 s34, 3670016
    buffer_load_dwordx4 v1, s[12:15], s34 offen  lds
    s_add_u32 m0, s36, 115712
    s_mov_b32 s34, 3735552
    buffer_load_dwordx4 v3, s[12:15], s34 offen  lds
    s_add_u32 m0, s36, 116736
    s_mov_b32 s34, 3801088
    buffer_load_dwordx4 v1, s[12:15], s34 offen  lds
    s_add_u32 m0, s36, 117760
    s_mov_b32 s34, 3866624
    buffer_load_dwordx4 v3, s[12:15], s34 offen  lds
    s_lshl_b32 s34, s24, 6
    v_xor_b32 v14, s34, v2
    v_add_u32 v14, 0, v14
    v_xor_b32 v15, 32, v14
    ds_read_b64_tr_b16 a[0:1], v14 offset:0
    ds_read_b64_tr_b16 a[2:3], v14 offset:4096
    ds_read_b64_tr_b16 a[4:5], v14 offset:8192
    ds_read_b64_tr_b16 a[6:7], v14 offset:12288
    ds_read_b64_tr_b16 a[8:9], v15 offset:0
    ds_read_b64_tr_b16 a[10:11], v15 offset:4096
    ds_read_b64_tr_b16 a[12:13], v15 offset:8192
    ds_read_b64_tr_b16 a[14:15], v15 offset:12288
    s_waitcnt lgkmcnt(0)
    s_waitcnt vmcnt(24)
    s_barrier
    s_lshl_b32 s34, s24, 6
    v_xor_b32 v14, s34, v2
    v_add_u32 v14, 16384, v14
    v_xor_b32 v15, 32, v14
    ds_read_b64_tr_b16 a[16:17], v14 offset:0
    ds_read_b64_tr_b16 a[18:19], v14 offset:4096
    ds_read_b64_tr_b16 a[20:21], v14 offset:8192
    ds_read_b64_tr_b16 a[22:23], v14 offset:12288
    ds_read_b64_tr_b16 a[24:25], v15 offset:0
    ds_read_b64_tr_b16 a[26:27], v15 offset:4096
    ds_read_b64_tr_b16 a[28:29], v15 offset:8192
    ds_read_b64_tr_b16 a[30:31], v15 offset:12288
    s_waitcnt lgkmcnt(0)
    s_waitcnt vmcnt(20)
    s_barrier
    s_lshl_b32 s34, s24, 6
    v_xor_b32 v14, s34, v2
    v_add_u32 v14, 32768, v14
    v_xor_b32 v15, 32, v14
    ds_read_b64_tr_b16 a[32:33], v14 offset:0
    ds_read_b64_tr_b16 a[34:35], v14 offset:4096
    ds_read_b64_tr_b16 a[36:37], v14 offset:8192
    ds_read_b64_tr_b16 a[38:39], v14 offset:12288
    ds_read_b64_tr_b16 a[40:41], v15 offset:0
    ds_read_b64_tr_b16 a[42:43], v15 offset:4096
    ds_read_b64_tr_b16 a[44:45], v15 offset:8192
    ds_read_b64_tr_b16 a[46:47], v15 offset:12288
    s_waitcnt lgkmcnt(0)
    s_waitcnt vmcnt(16)
    s_barrier
    s_lshl_b32 s34, s24, 6
    v_xor_b32 v14, s34, v2
    v_add_u32 v14, 49152, v14
    v_xor_b32 v15, 32, v14
    ds_read_b64_tr_b16 a[48:49], v14 offset:0
    ds_read_b64_tr_b16 a[50:51], v14 offset:4096
    ds_read_b64_tr_b16 a[52:53], v14 offset:8192
    ds_read_b64_tr_b16 a[54:55], v14 offset:12288
    ds_read_b64_tr_b16 a[56:57], v15 offset:0
    ds_read_b64_tr_b16 a[58:59], v15 offset:4096
    ds_read_b64_tr_b16 a[60:61], v15 offset:8192
    ds_read_b64_tr_b16 a[62:63], v15 offset:12288
    s_waitcnt lgkmcnt(0)
    s_waitcnt vmcnt(12)
    s_barrier
    s_lshl_b32 s34, s24, 6
    v_xor_b32 v14, s34, v2
    v_add_u32 v14, 65536, v14
    v_xor_b32 v15, 32, v14
    ds_read_b64_tr_b16 a[64:65], v14 offset:0
    ds_read_b64_tr_b16 a[66:67], v14 offset:4096
    ds_read_b64_tr_b16 a[68:69], v14 offset:8192
    ds_read_b64_tr_b16 a[70:71], v14 offset:12288
    ds_read_b64_tr_b16 a[72:73], v15 offset:0
    ds_read_b64_tr_b16 a[74:75], v15 offset:4096
    ds_read_b64_tr_b16 a[76:77], v15 offset:8192
    ds_read_b64_tr_b16 a[78:79], v15 offset:12288
    s_waitcnt lgkmcnt(0)
    s_waitcnt vmcnt(8)
    s_barrier
    s_lshl_b32 s34, s24, 6
    v_xor_b32 v14, s34, v2
    v_add_u32 v14, 81920, v14
    v_xor_b32 v15, 32, v14
    ds_read_b64_tr_b16 a[80:81], v14 offset:0
    ds_read_b64_tr_b16 a[82:83], v14 offset:4096
    ds_read_b64_tr_b16 a[84:85], v14 offset:8192
    ds_read_b64_tr_b16 a[86:87], v14 offset:12288
    ds_read_b64_tr_b16 a[88:89], v15 offset:0
    ds_read_b64_tr_b16 a[90:91], v15 offset:4096
    ds_read_b64_tr_b16 a[92:93], v15 offset:8192
    ds_read_b64_tr_b16 a[94:95], v15 offset:12288
    s_waitcnt lgkmcnt(0)
    s_waitcnt vmcnt(4)
    s_barrier
    s_lshl_b32 s34, s24, 6
    v_xor_b32 v14, s34, v2
    v_add_u32 v14, 98304, v14
    v_xor_b32 v15, 32, v14
    ds_read_b64_tr_b16 a[96:97], v14 offset:0
    ds_read_b64_tr_b16 a[98:99], v14 offset:4096
    ds_read_b64_tr_b16 a[100:101], v14 offset:8192
    ds_read_b64_tr_b16 a[102:103], v14 offset:12288
    ds_read_b64_tr_b16 a[104:105], v15 offset:0
    ds_read_b64_tr_b16 a[106:107], v15 offset:4096
    ds_read_b64_tr_b16 a[108:109], v15 offset:8192
    ds_read_b64_tr_b16 a[110:111], v15 offset:12288
    s_waitcnt lgkmcnt(0)
    s_waitcnt vmcnt(0)
    s_barrier
    s_lshl_b32 s34, s24, 6
    v_xor_b32 v14, s34, v2
    v_add_u32 v14, 114688, v14
    v_xor_b32 v15, 32, v14
    ds_read_b64_tr_b16 a[112:113], v14 offset:0
    ds_read_b64_tr_b16 a[114:115], v14 offset:4096
    ds_read_b64_tr_b16 a[116:117], v14 offset:8192
    ds_read_b64_tr_b16 a[118:119], v14 offset:12288
    ds_read_b64_tr_b16 a[120:121], v15 offset:0
    ds_read_b64_tr_b16 a[122:123], v15 offset:4096
    ds_read_b64_tr_b16 a[124:125], v15 offset:8192
    ds_read_b64_tr_b16 a[126:127], v15 offset:12288
    s_waitcnt lgkmcnt(0)
    v_mov_b32 v14, 4
L_poll_7:
    buffer_load_dword v15, v14, s[8:11], 0 offen offset:0 sc1
    s_waitcnt vmcnt(0)
    v_cmp_gt_u32 vcc, 32, v15
    s_cbranch_vccz L_polld_8
    s_sub_u32 s27, s27, 1
    s_cbranch_scc1 L_exit
    s_sleep 2
    s_branch L_poll_7
L_polld_8:
    s_mul_i32 s40, s29, 1572864
    s_add_u32 s40, s40, 41943040
    s_lshl_b32 s34, s24, 11
    s_add_u32 s40, s40, s34
L_wb_p1:
    s_waitcnt vmcnt(0)
    s_barrier
    s_cmp_lt_u32 s37, 6
    s_cbranch_scc1 L_wb_noflag
    s_cmp_lg_u32 s24, 0
    s_cbranch_scc1 L_wb_noflag
    s_sub_u32 s34, s37, 6
    s_mul_i32 s34, s34, 24576
    s_lshl_b32 s35, s29, 7
    s_add_u32 s34, s34, s35
    s_add_u32 s34, s34, 93331456
    v_mov_b32 v14, s34
    v_mov_b32 v15, 1
    s_mov_b64 exec, 1
    buffer_store_dword v15, v14, s[4:7], 0 offen offset:0 sc1
    s_mov_b64 exec, -1
L_wb_noflag:
    s_cmp_ge_u32 s37, 64
    s_cbranch_scc1 L_wb_p1_done
    s_add_u32 s36, s37, 6
    s_cmp_ge_u32 s36, 64
    s_cbranch_scc1 L_wb_nopf
    s_lshl_b32 s36, s36, 15
    s_and_b32 s34, s24, 1
    s_lshl_b32 s34, s34, 3
    v_xor_b32 v14, s34, v0
    s_lshl_b32 s34, s24, 13
    s_add_u32 s35, s34, s36
    s_add_u32 s34, s34, s39
    v_xor_b32 v15, 0, v14
    v_lshlrev_b32 v15, 4, v15
    s_add_u32 m0, s34, 0
    s_nop 0
    buffer_load_dwordx4 v15, s[16:19], s35 offen lds
    v_xor_b32 v15, 1, v14
    v_lshlrev_b32 v15, 4, v15
    s_add_u32 m0, s34, 1024
    s_add_u32 s35, s35, 1024
    buffer_load_dwordx4 v15, s[16:19], s35 offen lds
    v_xor_b32 v15, 2, v14
    v_lshlrev_b32 v15, 4, v15
    s_add_u32 m0, s34, 2048
    s_add_u32 s35, s35, 1024
    buffer_load_dwordx4 v15, s[16:19], s35 offen lds
    v_xor_b32 v15, 3, v14
    v_lshlrev_b32 v15, 4, v15
    s_add_u32 m0, s34, 3072
    s_add_u32 s35, s35, 1024
    buffer_load_dwordx4 v15, s[16:19], s35 offen lds
    v_xor_b32 v15, 4, v14
    v_lshlrev_b32 v15, 4, v15
    s_add_u32 m0, s34, 4096
    s_add_u32 s35, s35, 1024
    buffer_load_dwordx4 v15, s[16:19], s35 offen lds
    v_xor_b32 v15, 5, v14
    v_lshlrev_b32 v15, 4, v15
    s_add_u32 m0, s34, 5120
    s_add_u32 s35, s35, 1024
    buffer_load_dwordx4 v15, s[16:19], s35 offen lds
    v_xor_b32 v15, 6, v14
    v_lshlrev_b32 v15, 4, v15
    s_add_u32 m0, s34, 6144
    s_add_u32 s35, s35, 1024
    buffer_load_dwordx4 v15, s[16:19], s35 offen lds
    v_xor_b32 v15, 7, v14
    v_lshlrev_b32 v15, 4, v15
    s_add_u32 m0, s34, 7168
    s_add_u32 s35, s35, 1024
    buffer_load_dwordx4 v15, s[16:19], s35 offen lds
L_wb_nopf:
    v_add_u32 v10, s38, v6
    v_add_u32 v11, s38, v7
    v_add_u32 v12, s38, v8
    v_add_u32 v13, s38, v9
    ds_read_b128 v[32:35], v10 offset:0
    ds_read_b128 v[36:39], v10 offset:16384
    ds_read_b128 v[40:43], v11 offset:0
    s_waitcnt lgkmcnt(2)
    v_mfma_f32_16x16x32_bf16 v[64:67], v[128:131], v[32:35], 0
    v_mfma_f32_16x16x32_bf16 v[68:71], v[136:139], v[32:35], 0
    ds_read_b128 v[44:47], v11 offset:16384
    v_mfma_f32_16x16x32_bf16 v[80:83], a[0:3], v[32:35], 0
    v_mfma_f32_16x16x32_bf16 v[84:87], a[8:11], v[32:35], 0
    v_mfma_f32_16x16x32_bf16 v[96:99], v[32:35], a[128:131], 0
    v_mfma_f32_16x16x32_bf16 v[104:107], v[32:35], a[136:139], 0
    s_waitcnt lgkmcnt(2)
    v_mfma_f32_16x16x32_bf16 v[72:75], v[128:131], v[36:39], 0
    v_mfma_f32_16x16x32_bf16 v[76:79], v[136:139], v[36:39], 0
    ds_read_b128 v[32:35], v12 offset:0
    v_mfma_f32_16x16x32_bf16 v[88:91], a[0:3], v[36:39], 0
    v_mfma_f32_16x16x32_bf16 v[92:95], a[8:11], v[36:39], 0
    v_mfma_f32_16x16x32_bf16 v[100:103], v[36:39], a[128:131], 0
    v_mfma_f32_16x16x32_bf16 v[108:111], v[36:39], a[136:139], 0
    s_waitcnt lgkmcnt(2)
    v_mfma_f32_16x16x32_bf16 v[64:67], v[132:135], v[40:43], v[64:67]
    v_mfma_f32_16x16x32_bf16 v[68:71], v[140:143], v[40:43], v[68:71]
    ds_read_b128 v[36:39], v12 offset:16384
    v_mfma_f32_16x16x32_bf16 v[80:83], a[4:7], v[40:43], v[80:83]
    v_mfma_f32_16x16x32_bf16 v[84:87], a[12:15], v[40:43], v[84:87]
    v_mfma_f32_16x16x32_bf16 v[96:99], v[40:43], a[132:135], v[96:99]
    v_mfma_f32_16x16x32_bf16 v[104:107], v[40:43], a[140:143], v[104:107]
    s_waitcnt lgkmcnt(2)
    v_mfma_f32_16x16x32_bf16 v[72:75], v[132:135], v[44:47], v[72:75]
    v_mfma_f32_16x16x32_bf16 v[76:79], v[140:143], v[44:47], v[76:79]
    ds_read_b128 v[40:43], v13 offset:0
    v_mfma_f32_16x16x32_bf16 v[88:91], a[4:7], v[44:47], v[88:91]
    v_mfma_f32_16x16x32_bf16 v[92:95], a[12:15], v[44:47], v[92:95]
    v_mfma_f32_16x16x32_bf16 v[100:103], v[44:47], a[132:135], v[100:103]
    v_mfma_f32_16x16x32_bf16 v[108:111], v[44:47], a[140:143], v[108:111]
    s_waitcnt lgkmcnt(2)
    v_mfma_f32_16x16x32_bf16 v[64:67], v[144:147], v[32:35], v[64:67]
    v_mfma_f32_16x16x32_bf16 v[68:71], v[152:155], v[32:35], v[68:71]
    ds_read_b128 v[44:47], v13 offset:16384
    v_mfma_f32_16x16x32_bf16 v[80:83], a[16:19], v[32:35], v[80:83]
    v_mfma_f32_16x16x32_bf16 v[84:87], a[24:27], v[32:35], v[84:87]
    v_mfma_f32_16x16x32_bf16 v[96:99], v[32:35], a[144:147], v[96:99]
    v_mfma_f32_16x16x32_bf16 v[104:107], v[32:35], a[152:155], v[104:107]
    s_waitcnt lgkmcnt(2)
    v_mfma_f32_16x16x32_bf16 v[72:75], v[144:147], v[36:39], v[72:75]
    v_mfma_f32_16x16x32_bf16 v[76:79], v[152:155], v[36:39], v[76:79]
    ds_read_b128 v[32:35], v10 offset:256
    v_mfma_f32_16x16x32_bf16 v[88:91], a[16:19], v[36:39], v[88:91]
    v_mfma_f32_16x16x32_bf16 v[92:95], a[24:27], v[36:39], v[92:95]
    v_mfma_f32_16x16x32_bf16 v[100:103], v[36:39], a[144:147], v[100:103]
    v_mfma_f32_16x16x32_bf16 v[108:111], v[36:39], a[152:155], v[108:111]
    s_waitcnt lgkmcnt(2)
    v_mfma_f32_16x16x32_bf16 v[64:67], v[148:151], v[40:43], v[64:67]
    v_mfma_f32_16x16x32_bf16 v[68:71], v[156:159], v[40:43], v[68:71]
    ds_read_b128 v[36:39], v10 offset:16640
    v_mfma_f32_16x16x32_bf16 v[80:83], a[20:23], v[40:43], v[80:83]
    v_mfma_f32_16x16x32_bf16 v[84:87], a[28:31], v[40:43], v[84:87]
    v_mfma_f32_16x16x32_bf16 v[96:99], v[40:43], a[148:151], v[96:99]
    v_mfma_f32_16x16x32_bf16 v[104:107], v[40:43], a[156:159], v[104:107]
    s_waitcnt lgkmcnt(2)
    v_mfma_f32_16x16x32_bf16 v[72:75], v[148:151], v[44:47], v[72:75]
    v_mfma_f32_16x16x32_bf16 v[76:79], v[156:159], v[44:47], v[76:79]
    ds_read_b128 v[40:43], v11 offset:256
    v_mfma_f32_16x16x32_bf16 v[88:91], a[20:23], v[44:47], v[88:91]
    v_mfma_f32_16x16x32_bf16 v[92:95], a[28:31], v[44:47], v[92:95]
    v_mfma_f32_16x16x32_bf16 v[100:103], v[44:47], a[148:151], v[100:103]
    v_mfma_f32_16x16x32_bf16 v[108:111], v[44:47], a[156:159], v[108:111]
    s_waitcnt lgkmcnt(2)
    v_mfma_f32_16x16x32_bf16 v[64:67], v[160:163], v[32:35], v[64:67]
    v_mfma_f32_16x16x32_bf16 v[68:71], v[168:171], v[32:35], v[68:71]
    ds_read_b128 v[44:47], v11 offset:16640
    v_mfma_f32_16x16x32_bf16 v[80:83], a[32:35], v[32:35], v[80:83]
    v_mfma_f32_16x16x32_bf16 v[84:87], a[40:43], v[32:35], v[84:87]
    v_mfma_f32_16x16x32_bf16 v[96:99], v[32:35], a[160:163], v[96:99]
    v_mfma_f32_16x16x32_bf16 v[104:107], v[32:35], a[168:171], v[104:107]
    s_waitcnt lgkmcnt(2)
    v_mfma_f32_16x16x32_bf16 v[72:75], v[160:163], v[36:39], v[72:75]
    v_mfma_f32_16x16x32_bf16 v[76:79], v[168:171], v[36:39], v[76:79]
    ds_read_b128 v[32:35], v12 offset:256
    v_mfma_f32_16x16x32_bf16 v[88:91], a[32:35], v[36:39], v[88:91]
    v_mfma_f32_16x16x32_bf16 v[92:95], a[40:43], v[36:39], v[92:95]
    v_mfma_f32_16x16x32_bf16 v[100:103], v[36:39], a[160:163], v[100:103]
    v_mfma_f32_16x16x32_bf16 v[108:111], v[36:39], a[168:171], v[108:111]
    s_waitcnt lgkmcnt(2)
    v_mfma_f32_16x16x32_bf16 v[64:67], v[164:167], v[40:43], v[64:67]
    v_mfma_f32_16x16x32_bf16 v[68:71], v[172:175], v[40:43], v[68:71]
    ds_read_b128 v[36:39], v12 offset:16640
    v_mfma_f32_16x16x32_bf16 v[80:83], a[36:39], v[40:43], v[80:83]
    v_mfma_f32_16x16x32_bf16 v[84:87], a[44:47], v[40:43], v[84:87]
    v_mfma_f32_16x16x32_bf16 v[96:99], v[40:43], a[164:167], v[96:99]
    v_mfma_f32_16x16x32_bf16 v[104:107], v[40:43], a[172:175], v[104:107]
    s_waitcnt lgkmcnt(2)
    v_mfma_f32_16x16x32_bf16 v[72:75], v[164:167], v[44:47], v[72:75]
    v_mfma_f32_16x16x32_bf16 v[76:79], v[172:175], v[44:47], v[76:79]
    ds_read_b128 v[40:43], v13 offset:256
    v_mfma_f32_16x16x32_bf16 v[88:91], a[36:39], v[44:47], v[88:91]
    v_mfma_f32_16x16x32_bf16 v[92:95], a[44:47], v[44:47], v[92:95]
    v_mfma_f32_16x16x32_bf16 v[100:103], v[44:47], a[164:167], v[100:103]
    v_mfma_f32_16x16x32_bf16 v[108:111], v[44:47], a[172:175], v[108:111]
    s_waitcnt lgkmcnt(2)
    v_mfma_f32_16x16x32_bf16 v[64:67], v[176:179], v[32:35], v[64:67]
    v_mfma_f32_16x16x32_bf16 v[68:71], v[184:187], v[32:35], v[68:71]
    ds_read_b128 v[44:47], v13 offset:16640
    v_mfma_f32_16x16x32_bf16 v[80:83], a[48:51], v[32:35], v[80:83]
    v_mfma_f32_16x16x32_bf16 v[84:87], a[56:59], v[32:35], v[84:87]
    v_mfma_f32_16x16x32_bf16 v[96:99], v[32:35], a[176:179], v[96:99]
    v_mfma_f32_16x16x32_bf16 v[104:107], v[32:35], a[184:187], v[104:107]
    s_waitcnt lgkmcnt(2)
    v_mfma_f32_16x16x32_bf16 v[72:75], v[176:179], v[36:39], v[72:75]
    v_mfma_f32_16x16x32_bf16 v[76:79], v[184:187], v[36:39], v[76:79]
    ds_read_b128 v[32:35], v10 offset:512
    v_mfma_f32_16x16x32_bf16 v[88:91], a[48:51], v[36:39], v[88:91]
    v_mfma_f32_16x16x32_bf16 v[92:95], a[56:59], v[36:39], v[92:95]
    v_mfma_f32_16x16x32_bf16 v[100:103], v[36:39], a[176:179], v[100:103]
    v_mfma_f32_16x16x32_bf16 v[108:111], v[36:39], a[184:187], v[108:111]
    s_waitcnt lgkmcnt(2)
    v_mfma_f32_16x16x32_bf16 v[64:67], v[180:183], v[40:43], v[64:67]
    v_mfma_f32_16x16x32_bf16 v[68:71], v[188:191], v[40:43], v[68:71]
    ds_read_b128 v[36:39], v10 offset:16896
    v_mfma_f32_16x16x32_bf16 v[80:83], a[52:55], v[40:43], v[80:83]
    v_mfma_f32_16x16x32_bf16 v[84:87], a[60:63], v[40:43], v[84:87]
    v_mfma_f32_16x16x32_bf16 v[96:99], v[40:43], a[180:183], v[96:99]
    v_mfma_f32_16x16x32_bf16 v[104:107], v[40:43], a[188:191], v[104:107]
    s_waitcnt lgkmcnt(2)
    v_mfma_f32_16x16x32_bf16 v[72:75], v[180:183], v[44:47], v[72:75]
    v_mfma_f32_16x16x32_bf16 v[76:79], v[188:191], v[44:47], v[76:79]
    ds_read_b128 v[40:43], v11 offset:512
    v_mfma_f32_16x16x32_bf16 v[88:91], a[52:55], v[44:47], v[88:91]
    v_mfma_f32_16x16x32_bf16 v[92:95], a[60:63], v[44:47], v[92:95]
    v_mfma_f32_16x16x32_bf16 v[100:103], v[44:47], a[180:183], v[100:103]
    v_mfma_f32_16x16x32_bf16 v[108:111], v[44:47], a[188:191], v[108:111]
    s_waitcnt lgkmcnt(2)
    v_mfma_f32_16x16x32_bf16 v[64:67], v[192:195], v[32:35], v[64:67]
    v_mfma_f32_16x16x32_bf16 v[68:71], v[200:203], v[32:35], v[68:71]
    ds_read_b128 v[44:47], v11 offset:16896
    v_mfma_f32_16x16x32_bf16 v[80:83], a[64:67], v[32:35], v[80:83]
    v_mfma_f32_16x16x32_bf16 v[84:87], a[72:75], v[32:35], v[84:87]
    v_mfma_f32_16x16x32_bf16 v[96:99], v[32:35], a[192:195], v[96:99]
    v_mfma_f32_16x16x32_bf16 v[104:107], v[32:35], a[200:203], v[104:107]
    s_waitcnt lgkmcnt(2)
    v_mfma_f32_16x16x32_bf16 v[72:75], v[192:195], v[36:39], v[72:75]
    v_mfma_f32_16x16x32_bf16 v[76:79], v[200:203], v[36:39], v[76:79]
    ds_read_b128 v[32:35], v12 offset:512
    v_mfma_f32_16x16x32_bf16 v[88:91], a[64:67], v[36:39], v[88:91]
    v_mfma_f32_16x16x32_bf16 v[92:95], a[72:75], v[36:39], v[92:95]
    v_mfma_f32_16x16x32_bf16 v[100:103], v[36:39], a[192:195], v[100:103]
    v_mfma_f32_16x16x32_bf16 v[108:111], v[36:39], a[200:203], v[108:111]
    s_waitcnt lgkmcnt(2)
    v_mfma_f32_16x16x32_bf16 v[64:67], v[196:199], v[40:43], v[64:67]
    v_mfma_f32_16x16x32_bf16 v[68:71], v[204:207], v[40:43], v[68:71]
    ds_read_b128 v[36:39], v12 offset:16896
    v_mfma_f32_16x16x32_bf16 v[80:83], a[68:71], v[40:43], v[80:83]
    v_mfma_f32_16x16x32_bf16 v[84:87], a[76:79], v[40:43], v[84:87]
    v_mfma_f32_16x16x32_bf16 v[96:99], v[40:43], a[196:199], v[96:99]
    v_mfma_f32_16x16x32_bf16 v[104:107], v[40:43], a[204:207], v[104:107]
    s_waitcnt lgkmcnt(2)
    v_mfma_f32_16x16x32_bf16 v[72:75], v[196:199], v[44:47], v[72:75]
    v_mfma_f32_16x16x32_bf16 v[76:79], v[204:207], v[44:47], v[76:79]
    ds_read_b128 v[40:43], v13 offset:512
    v_mfma_f32_16x16x32_bf16 v[88:91], a[68:71], v[44:47], v[88:91]
    v_mfma_f32_16x16x32_bf16 v[92:95], a[76:79], v[44:47], v[92:95]
    v_mfma_f32_16x16x32_bf16 v[100:103], v[44:47], a[196:199], v[100:103]
    v_mfma_f32_16x16x32_bf16 v[108:111], v[44:47], a[204:207], v[108:111]
    s_waitcnt lgkmcnt(2)
    v_mfma_f32_16x16x32_bf16 v[64:67], v[208:211], v[32:35], v[64:67]
    v_mfma_f32_16x16x32_bf16 v[68:71], v[216:219], v[32:35], v[68:71]
    ds_read_b128 v[44:47], v13 offset:16896
    v_mfma_f32_16x16x32_bf16 v[80:83], a[80:83], v[32:35], v[80:83]
    v_mfma_f32_16x16x32_bf16 v[84:87], a[88:91], v[32:35], v[84:87]
    v_mfma_f32_16x16x32_bf16 v[96:99], v[32:35], a[208:211], v[96:99]
    v_mfma_f32_16x16x32_bf16 v[104:107], v[32:35], a[216:219], v[104:107]
    s_waitcnt lgkmcnt(2)
    v_mfma_f32_16x16x32_bf16 v[72:75], v[208:211], v[36:39], v[72:75]
    v_mfma_f32_16x16x32_bf16 v[76:79], v[216:219], v[36:39], v[76:79]
    ds_read_b128 v[32:35], v10 offset:768
    v_mfma_f32_16x16x32_bf16 v[88:91], a[80:83], v[36:39], v[88:91]
    v_mfma_f32_16x16x32_bf16 v[92:95], a[88:91], v[36:39], v[92:95]
    v_mfma_f32_16x16x32_bf16 v[100:103], v[36:39], a[208:211], v[100:103]
    v_mfma_f32_16x16x32_bf16 v[108:111], v[36:39], a[216:219], v[108:111]
    s_waitcnt lgkmcnt(2)
    v_mfma_f32_16x16x32_bf16 v[64:67], v[212:215], v[40:43], v[64:67]
    v_mfma_f32_16x16x32_bf16 v[68:71], v[220:223], v[40:43], v[68:71]
    ds_read_b128 v[36:39], v10 offset:17152
    v_mfma_f32_16x16x32_bf16 v[80:83], a[84:87], v[40:43], v[80:83]
    v_mfma_f32_16x16x32_bf16 v[84:87], a[92:95], v[40:43], v[84:87]
    v_mfma_f32_16x16x32_bf16 v[96:99], v[40:43], a[212:215], v[96:99]
    v_mfma_f32_16x16x32_bf16 v[104:107], v[40:43], a[220:223], v[104:107]
    s_waitcnt lgkmcnt(2)
    v_mfma_f32_16x16x32_bf16 v[72:75], v[212:215], v[44:47], v[72:75]
    v_mfma_f32_16x16x32_bf16 v[76:79], v[220:223], v[44:47], v[76:79]
    ds_read_b128 v[40:43], v11 offset:768
    v_mfma_f32_16x16x32_bf16 v[88:91], a[84:87], v[44:47], v[88:91]
    v_mfma_f32_16x16x32_bf16 v[92:95], a[92:95], v[44:47], v[92:95]
    v_mfma_f32_16x16x32_bf16 v[100:103], v[44:47], a[212:215], v[100:103]
    v_mfma_f32_16x16x32_bf16 v[108:111], v[44:47], a[220:223], v[108:111]
    s_waitcnt lgkmcnt(2)
    v_mfma_f32_16x16x32_bf16 v[64:67], v[224:227], v[32:35], v[64:67]
    v_mfma_f32_16x16x32_bf16 v[68:71], v[232:235], v[32:35], v[68:71]
    ds_read_b128 v[44:47], v11 offset:17152
    v_mfma_f32_16x16x32_bf16 v[80:83], a[96:99], v[32:35], v[80:83]
    v_mfma_f32_16x16x32_bf16 v[84:87], a[104:107], v[32:35], v[84:87]
    v_mfma_f32_16x16x32_bf16 v[96:99], v[32:35], a[224:227], v[96:99]
    v_mfma_f32_16x16x32_bf16 v[104:107], v[32:35], a[232:235], v[104:107]
    s_waitcnt lgkmcnt(2)
    v_mfma_f32_16x16x32_bf16 v[72:75], v[224:227], v[36:39], v[72:75]
    v_mfma_f32_16x16x32_bf16 v[76:79], v[232:235], v[36:39], v[76:79]
    ds_read_b128 v[32:35], v12 offset:768
    v_mfma_f32_16x16x32_bf16 v[88:91], a[96:99], v[36:39], v[88:91]
    v_mfma_f32_16x16x32_bf16 v[92:95], a[104:107], v[36:39], v[92:95]
    v_mfma_f32_16x16x32_bf16 v[100:103], v[36:39], a[224:227], v[100:103]
    v_mfma_f32_16x16x32_bf16 v[108:111], v[36:39], a[232:235], v[108:111]
    s_waitcnt lgkmcnt(2)
    v_mfma_f32_16x16x32_bf16 v[64:67], v[228:231], v[40:43], v[64:67]
    v_mfma_f32_16x16x32_bf16 v[68:71], v[236:239], v[40:43], v[68:71]
    ds_read_b128 v[36:39], v12 offset:17152
    v_mfma_f32_16x16x32_bf16 v[80:83], a[100:103], v[40:43], v[80:83]
    v_mfma_f32_16x16x32_bf16 v[84:87], a[108:111], v[40:43], v[84:87]
    v_mfma_f32_16x16x32_bf16 v[96:99], v[40:43], a[228:231], v[96:99]
    v_mfma_f32_16x16x32_bf16 v[104:107], v[40:43], a[236:239], v[104:107]
    s_waitcnt lgkmcnt(2)
    v_mfma_f32_16x16x32_bf16 v[72:75], v[228:231], v[44:47], v[72:75]
    v_mfma_f32_16x16x32_bf16 v[76:79], v[236:239], v[44:47], v[76:79]
    ds_read_b128 v[40:43], v13 offset:768
    v_mfma_f32_16x16x32_bf16 v[88:91], a[100:103], v[44:47], v[88:91]
    v_mfma_f32_16x16x32_bf16 v[92:95], a[108:111], v[44:47], v[92:95]
    v_mfma_f32_16x16x32_bf16 v[100:103], v[44:47], a[228:231], v[100:103]
    v_mfma_f32_16x16x32_bf16 v[108:111], v[44:47], a[236:239], v[108:111]
    s_waitcnt lgkmcnt(2)
    v_mfma_f32_16x16x32_bf16 v[64:67], v[240:243], v[32:35], v[64:67]
    v_mfma_f32_16x16x32_bf16 v[68:71], v[248:251], v[32:35], v[68:71]
    ds_read_b128 v[44:47], v13 offset:17152
    v_mfma_f32_16x16x32_bf16 v[80:83], a[112:115], v[32:35], v[80:83]
    v_mfma_f32_16x16x32_bf16 v[84:87], a[120:123], v[32:35], v[84:87]
    v_mfma_f32_16x16x32_bf16 v[96:99], v[32:35], a[240:243], v[96:99]
    v_mfma_f32_16x16x32_bf16 v[104:107], v[32:35], a[248:251], v[104:107]
    s_waitcnt lgkmcnt(2)
    v_mfma_f32_16x16x32_bf16 v[72:75], v[240:243], v[36:39], v[72:75]
    v_mfma_f32_16x16x32_bf16 v[76:79], v[248:251], v[36:39], v[76:79]
    v_mfma_f32_16x16x32_bf16 v[88:91], a[112:115], v[36:39], v[88:91]
    v_mfma_f32_16x16x32_bf16 v[92:95], a[120:123], v[36:39], v[92:95]
    v_mfma_f32_16x16x32_bf16 v[100:103], v[36:39], a[240:243], v[100:103]
    v_mfma_f32_16x16x32_bf16 v[108:111], v[36:39], a[248:251], v[108:111]
    s_waitcnt lgkmcnt(1)
    v_mfma_f32_16x16x32_bf16 v[64:67], v[244:247], v[40:43], v[64:67]
    v_mfma_f32_16x16x32_bf16 v[68:71], v[252:255], v[40:43], v[68:71]
    v_mfma_f32_16x16x32_bf16 v[80:83], a[116:119], v[40:43], v[80:83]
    v_mfma_f32_16x16x32_bf16 v[84:87], a[124:127], v[40:43], v[84:87]
    v_mfma_f32_16x16x32_bf16 v[96:99], v[40:43], a[244:247], v[96:99]
    v_mfma_f32_16x16x32_bf16 v[104:107], v[40:43], a[252:255], v[104:107]
    s_waitcnt lgkmcnt(0)
    v_mfma_f32_16x16x32_bf16 v[72:75], v[244:247], v[44:47], v[72:75]
    v_mfma_f32_16x16x32_bf16 v[76:79], v[252:255], v[44:47], v[76:79]
    v_mfma_f32_16x16x32_bf16 v[88:91], a[116:119], v[44:47], v[88:91]
    v_mfma_f32_16x16x32_bf16 v[92:95], a[124:127], v[44:47], v[92:95]
    v_mfma_f32_16x16x32_bf16 v[100:103], v[44:47], a[244:247], v[100:103]
    v_mfma_f32_16x16x32_bf16 v[108:111], v[44:47], a[252:255], v[108:111]
    s_mul_i32 s34, s37, 24576
    s_add_u32 s34, s34, s40
    s_add_u32 s35, s34, 8192
    v_cvt_pk_bf16_f32 v32, v80, v81
    v_cvt_pk_bf16_f32 v33, v82, v83
    v_cvt_pk_bf16_f32 v34, v84, v85
    v_cvt_pk_bf16_f32 v35, v86, v87
    buffer_store_dwordx4 v[32:35], v5, s[4:7], s35 offen offset:0 sc1
    v_cvt_pk_bf16_f32 v36, v88, v89
    v_cvt_pk_bf16_f32 v37, v90, v91
    v_cvt_pk_bf16_f32 v38, v92, v93
    v_cvt_pk_bf16_f32 v39, v94, v95
    buffer_store_dwordx4 v[36:39], v5, s[4:7], s35 offen offset:1024 sc1
    s_add_u32 s35, s34, 16384
    v_cvt_pk_bf16_f32 v40, v96, v97
    v_cvt_pk_bf16_f32 v41, v98, v99
    v_cvt_pk_bf16_f32 v42, v100, v101
    v_cvt_pk_bf16_f32 v43, v102, v103
    buffer_store_dwordx4 v[40:43], v5, s[4:7], s35 offen offset:0 sc1
    v_cvt_pk_bf16_f32 v44, v104, v105
    v_cvt_pk_bf16_f32 v45, v106, v107
    v_cvt_pk_bf16_f32 v46, v108, v109
    v_cvt_pk_bf16_f32 v47, v110, v111
    buffer_store_dwordx4 v[44:47], v5, s[4:7], s35 offen offset:1024 sc1
    s_add_u32 s35, s34, 0
    v_cvt_pk_bf16_f32 v32, v64, v65
    v_cvt_pk_bf16_f32 v33, v66, v67
    v_cvt_pk_bf16_f32 v34, v68, v69
    v_cvt_pk_bf16_f32 v35, v70, v71
    buffer_store_dwordx4 v[32:35], v5, s[4:7], s35 offen offset:0 sc1
    v_cvt_pk_bf16_f32 v36, v72, v73
    v_cvt_pk_bf16_f32 v37, v74, v75
    v_cvt_pk_bf16_f32 v38, v76, v77
    v_cvt_pk_bf16_f32 v39, v78, v79
    buffer_store_dwordx4 v[36:39], v5, s[4:7], s35 offen offset:1024 sc1
    s_add_u32 s37, s37, 6
    s_mov_b32 s34, s38
    s_mov_b32 s38, s39
    s_mov_b32 s39, s34
    s_branch L_wb_p1
L_wb_p1_done:
    s_lshl_b32 s34, s24, 20
    s_lshl_b32 s35, s32, 6
    s_add_u32 s36, s34, s35
    v_bfe_u32 v14, v0, 5, 1
    v_mul_u32_u24 v1, 8, v14
    v_bfe_u32 v14, v0, 4, 1
    v_mul_u32_u24 v14, 4, v14
    v_add_u32 v1, v1, v14
    v_bfe_u32 v14, v0, 3, 1
    v_mul_u32_u24 v14, 2, v14
    v_add_u32 v1, v1, v14
    v_bfe_u32 v14, v0, 2, 1
    v_mul_u32_u24 v14, 1, v14
    v_add_u32 v1, v1, v14
    s_mov_b32 s34, 1024
    v_mul_lo_u32 v1, v1, s34
    v_and_b32 v14, 3, v0
    v_lshlrev_b32 v14, 4, v14
    v_add3_u32 v1, v1, v14, s36
    v_lshrrev_b32 v14, 2, v0
    v_lshlrev_b32 v14, 6, v14
    v_add_u32 v14, s33, v14
    v_and_b32 v15, 3, v0
    v_lshlrev_b32 v15, 4, v15
    v_add_u32 v4, v14, v15
    v_add_u32 v2, s33, v5
    s_mov_b32 s12, s80
    s_and_b32 s13, s81, 0xffff
    s_mov_b32 s14, 4194304
    s_mov_b32 s15, 0x20000
    s_add_u32 m0, s33, 0
    s_mov_b32 s34, 0
    buffer_load_dwordx4 v1, s[12:15], s34 offen  lds
    s_add_u32 m0, s33, 1024
    s_mov_b32 s34, 16384
    buffer_load_dwordx4 v1, s[12:15], s34 offen  lds
    s_add_u32 m0, s33, 2048
    s_mov_b32 s34, 32768
    buffer_load_dwordx4 v1, s[12:15], s34 offen  lds
    s_add_u32 m0, s33, 3072
    s_mov_b32 s34, 49152
    buffer_load_dwordx4 v1, s[12:15], s34 offen  lds
    s_add_u32 m0, s33, 4096
    s_mov_b32 s34, 65536
    buffer_load_dwordx4 v1, s[12:15], s34 offen  lds
    s_add_u32 m0, s33, 5120
    s_mov_b32 s34, 81920
    buffer_load_dwordx4 v1, s[12:15], s34 offen  lds
    s_add_u32 m0, s33, 6144
    s_mov_b32 s34, 98304
    buffer_load_dwordx4 v1, s[12:15], s34 offen  lds
    s_add_u32 m0, s33, 7168
    s_mov_b32 s34, 114688
    buffer_load_dwordx4 v1, s[12:15], s34 offen  lds
    s_add_u32 m0, s33, 8192
    s_mov_b32 s34, 131072
    buffer_load_dwordx4 v1, s[12:15], s34 offen  lds
    s_add_u32 m0, s33, 9216
    s_mov_b32 s34, 147456
    buffer_load_dwordx4 v1, s[12:15], s34 offen  lds
    s_add_u32 m0, s33, 10240
    s_mov_b32 s34, 163840
    buffer_load_dwordx4 v1, s[12:15], s34 offen  lds
    s_add_u32 m0, s33, 11264
    s_mov_b32 s34, 180224
    buffer_load_dwordx4 v1, s[12:15], s34 offen  lds
    s_add_u32 m0, s33, 12288
    s_mov_b32 s34, 196608
    buffer_load_dwordx4 v1, s[12:15], s34 offen  lds
    s_add_u32 m0, s33, 13312
    s_mov_b32 s34, 212992
    buffer_load_dwordx4 v1, s[12:15], s34 offen  lds
    s_add_u32 m0, s33, 14336
    s_mov_b32 s34, 229376
    buffer_load_dwordx4 v1, s[12:15], s34 offen  lds
    s_add_u32 m0, s33, 15360
    s_mov_b32 s34, 245760
    buffer_load_dwordx4 v1, s[12:15], s34 offen  lds
    s_add_u32 m0, s33, 16384
    s_mov_b32 s34, 262144
    buffer_load_dwordx4 v1, s[12:15], s34 offen  lds
    s_add_u32 m0, s33, 17408
    s_mov_b32 s34, 278528
    buffer_load_dwordx4 v1, s[12:15], s34 offen  lds
    s_add_u32 m0, s33, 18432
    s_mov_b32 s34, 294912
    buffer_load_dwordx4 v1, s[12:15], s34 offen  lds
    s_add_u32 m0, s33, 19456
    s_mov_b32 s34, 311296
    buffer_load_dwordx4 v1, s[12:15], s34 offen  lds
    s_add_u32 m0, s33, 20480
    s_mov_b32 s34, 327680
    buffer_load_dwordx4 v1, s[12:15], s34 offen  lds
    s_add_u32 m0, s33, 21504
    s_mov_b32 s34, 344064
    buffer_load_dwordx4 v1, s[12:15], s34 offen  lds
    s_add_u32 m0, s33, 22528
    s_mov_b32 s34, 360448
    buffer_load_dwordx4 v1, s[12:15], s34 offen  lds
    s_add_u32 m0, s33, 23552
    s_mov_b32 s34, 376832
    buffer_load_dwordx4 v1, s[12:15], s34 offen  lds
    s_add_u32 m0, s33, 24576
    s_mov_b32 s34, 393216
    buffer_load_dwordx4 v1, s[12:15], s34 offen  lds
    s_add_u32 m0, s33, 25600
    s_mov_b32 s34, 409600
    buffer_load_dwordx4 v1, s[12:15], s34 offen  lds
    s_add_u32 m0, s33, 26624
    s_mov_b32 s34, 425984
    buffer_load_dwordx4 v1, s[12:15], s34 offen  lds
    s_add_u32 m0, s33, 27648
    s_mov_b32 s34, 442368
    buffer_load_dwordx4 v1, s[12:15], s34 offen  lds
    s_add_u32 m0, s33, 28672
    s_mov_b32 s34, 458752
    buffer_load_dwordx4 v1, s[12:15], s34 offen  lds
    s_add_u32 m0, s33, 29696
    s_mov_b32 s34, 475136
    buffer_load_dwordx4 v1, s[12:15], s34 offen  lds
    s_add_u32 m0, s33, 30720
    s_mov_b32 s34, 491520
    buffer_load_dwordx4 v1, s[12:15], s34 offen  lds
    s_add_u32 m0, s33, 31744
    s_mov_b32 s34, 507904
    buffer_load_dwordx4 v1, s[12:15], s34 offen  lds
    s_waitcnt vmcnt(28)
    ds_read_b64_tr_b16 v[128:129], v4 offset:0
    ds_read_b64_tr_b16 v[130:131], v4 offset:1024
    ds_read_b64_tr_b16 v[132:133], v4 offset:2048
    ds_read_b64_tr_b16 v[134:135], v4 offset:3072
    ds_read_b64_tr_b16 v[136:137], v4 offset:8
    ds_read_b64_tr_b16 v[138:139], v4 offset:1032
    ds_read_b64_tr_b16 v[140:141], v4 offset:2056
    ds_read_b64_tr_b16 v[142:143], v4 offset:3080
    s_waitcnt lgkmcnt(0)
    s_add_u32 m0, s33, 0
    s_mov_b32 s34, 524288
    buffer_load_dwordx4 v1, s[12:15], s34 offen  lds
    s_add_u32 m0, s33, 1024
    s_mov_b32 s34, 540672
    buffer_load_dwordx4 v1, s[12:15], s34 offen  lds
    s_add_u32 m0, s33, 2048
    s_mov_b32 s34, 557056
    buffer_load_dwordx4 v1, s[12:15], s34 offen  lds
    s_add_u32 m0, s33, 3072
    s_mov_b32 s34, 573440
    buffer_load_dwordx4 v1, s[12:15], s34 offen  lds
    s_waitcnt vmcnt(28)
    ds_read_b64_tr_b16 v[144:145], v4 offset:4096
    ds_read_b64_tr_b16 v[146:147], v4 offset:5120
    ds_read_b64_tr_b16 v[148:149], v4 offset:6144
    ds_read_b64_tr_b16 v[150:151], v4 offset:7168
    ds_read_b64_tr_b16 v[152:153], v4 offset:4104
    ds_read_b64_tr_b16 v[154:155], v4 offset:5128
    ds_read_b64_tr_b16 v[156:157], v4 offset:6152
    ds_read_b64_tr_b16 v[158:159], v4 offset:7176
    s_waitcnt lgkmcnt(0)
    s_add_u32 m0, s33, 4096
    s_mov_b32 s34, 589824
    buffer_load_dwordx4 v1, s[12:15], s34 offen  lds
    s_add_u32 m0, s33, 5120
    s_mov_b32 s34, 606208
    buffer_load_dwordx4 v1, s[12:15], s34 offen  lds
    s_add_u32 m0, s33, 6144
    s_mov_b32 s34, 622592
    buffer_load_dwordx4 v1, s[12:15], s34 offen  lds
    s_add_u32 m0, s33, 7168
    s_mov_b32 s34, 638976
    buffer_load_dwordx4 v1, s[12:15], s34 offen  lds
    s_waitcnt vmcnt(28)
    ds_read_b64_tr_b16 v[160:161], v4 offset:8192
    ds_read_b64_tr_b16 v[162:163], v4 offset:9216
    ds_read_b64_tr_b16 v[164:165], v4 offset:10240
    ds_read_b64_tr_b16 v[166:167], v4 offset:11264
    ds_read_b64_tr_b16 v[168:169], v4 offset:8200
    ds_read_b64_tr_b16 v[170:171], v4 offset:9224
    ds_read_b64_tr_b16 v[172:173], v4 offset:10248
    ds_read_b64_tr_b16 v[174:175], v4 offset:11272
    s_waitcnt lgkmcnt(0)
    s_add_u32 m0, s33, 8192
    s_mov_b32 s34, 655360
    buffer_load_dwordx4 v1, s[12:15], s34 offen  lds
    s_add_u32 m0, s33, 9216
    s_mov_b32 s34, 671744
    buffer_load_dwordx4 v1, s[12:15], s34 offen  lds
    s_add_u32 m0, s33, 10240
    s_mov_b32 s34, 688128
    buffer_load_dwordx4 v1, s[12:15], s34 offen  lds
    s_add_u32 m0, s33, 11264
    s_mov_b32 s34, 704512
    buffer_load_dwordx4 v1, s[12:15], s34 offen  lds
    s_waitcnt vmcnt(28)
    ds_read_b64_tr_b16 v[176:177], v4 offset:12288
    ds_read_b64_tr_b16 v[178:179], v4 offset:13312
    ds_read_b64_tr_b16 v[180:181], v4 offset:14336
    ds_read_b64_tr_b16 v[182:183], v4 offset:15360
    ds_read_b64_tr_b16 v[184:185], v4 offset:12296
    ds_read_b64_tr_b16 v[186:187], v4 offset:13320
    ds_read_b64_tr_b16 v[188:189], v4 offset:14344
    ds_read_b64_tr_b16 v[190:191], v4 offset:15368
    s_waitcnt lgkmcnt(0)
    s_add_u32 m0, s33, 12288
    s_mov_b32 s34, 720896
    buffer_load_dwordx4 v1, s[12:15], s34 offen  lds
    s_add_u32 m0, s33, 13312
    s_mov_b32 s34, 737280
    buffer_load_dwordx4 v1, s[12:15], s34 offen  lds
    s_add_u32 m0, s33, 14336
    s_mov_b32 s34, 753664
    buffer_load_dwordx4 v1, s[12:15], s34 offen  lds
    s_add_u32 m0, s33, 15360
    s_mov_b32 s34, 770048
    buffer_load_dwordx4 v1, s[12:15], s34 offen  lds
    s_waitcnt vmcnt(28)
    ds_read_b64_tr_b16 v[192:193], v4 offset:16384
    ds_read_b64_tr_b16 v[194:195], v4 offset:17408
    ds_read_b64_tr_b16 v[196:197], v4 offset:18432
    ds_read_b64_tr_b16 v[198:199], v4 offset:19456
    ds_read_b64_tr_b16 v[200:201], v4 offset:16392
    ds_read_b64_tr_b16 v[202:203], v4 offset:17416
    ds_read_b64_tr_b16 v[204:205], v4 offset:18440
    ds_read_b64_tr_b16 v[206:207], v4 offset:19464
    s_waitcnt lgkmcnt(0)
    s_add_u32 m0, s33, 16384
    s_mov_b32 s34, 786432
    buffer_load_dwordx4 v1, s[12:15], s34 offen  lds
    s_add_u32 m0, s33, 17408
    s_mov_b32 s34, 802816
    buffer_load_dwordx4 v1, s[12:15], s34 offen  lds
    s_add_u32 m0, s33, 18432
    s_mov_b32 s34, 819200
    buffer_load_dwordx4 v1, s[12:15], s34 offen  lds
    s_add_u32 m0, s33, 19456
    s_mov_b32 s34, 835584
    buffer_load_dwordx4 v1, s[12:15], s34 offen  lds
    s_waitcnt vmcnt(28)
    ds_read_b64_tr_b16 v[208:209], v4 offset:20480
    ds_read_b64_tr_b16 v[210:211], v4 offset:21504
    ds_read_b64_tr_b16 v[212:213], v4 offset:22528
    ds_read_b64_tr_b16 v[214:215], v4 offset:23552
    ds_read_b64_tr_b16 v[216:217], v4 offset:20488
    ds_read_b64_tr_b16 v[218:219], v4 offset:21512
    ds_read_b64_tr_b16 v[220:221], v4 offset:22536
    ds_read_b64_tr_b16 v[222:223], v4 offset:23560
    s_waitcnt lgkmcnt(0)
    s_add_u32 m0, s33, 20480
    s_mov_b32 s34, 851968
    buffer_load_dwordx4 v1, s[12:15], s34 offen  lds
    s_add_u32 m0, s33, 21504
    s_mov_b32 s34, 868352
    buffer_load_dwordx4 v1, s[12:15], s34 offen  lds
    s_add_u32 m0, s33, 22528
    s_mov_b32 s34, 884736
    buffer_load_dwordx4 v1, s[12:15], s34 offen  lds
    s_add_u32 m0, s33, 23552
    s_mov_b32 s34, 901120
    buffer_load_dwordx4 v1, s[12:15], s34 offen  lds
    s_waitcnt vmcnt(28)
    ds_read_b64_tr_b16 v[224:225], v4 offset:24576
    ds_read_b64_tr_b16 v[226:227], v4 offset:25600
    ds_read_b64_tr_b16 v[228:229], v4 offset:26624
    ds_read_b64_tr_b16 v[230:231], v4 offset:27648
    ds_read_b64_tr_b16 v[232:233], v4 offset:24584
    ds_read_b64_tr_b16 v[234:235], v4 offset:25608
    ds_read_b64_tr_b16 v[236:237], v4 offset:26632
    ds_read_b64_tr_b16 v[238:239], v4 offset:27656
    s_waitcnt lgkmcnt(0)
    s_add_u32 m0, s33, 24576
    s_mov_b32 s34, 917504
    buffer_load_dwordx4 v1, s[12:15], s34 offen  lds
    s_add_u32 m0, s33, 25600
    s_mov_b32 s34, 933888
    buffer_load_dwordx4 v1, s[12:15], s34 offen  lds
    s_add_u32 m0, s33, 26624
    s_mov_b32 s34, 950272
    buffer_load_dwordx4 v1, s[12:15], s34 offen  lds
    s_add_u32 m0, s33, 27648
    s_mov_b32 s34, 966656
    buffer_load_dwordx4 v1, s[12:15], s34 offen  lds
    s_waitcnt vmcnt(28)
    ds_read_b64_tr_b16 v[240:241], v4 offset:28672
    ds_read_b64_tr_b16 v[242:243], v4 offset:29696
    ds_read_b64_tr_b16 v[244:245], v4 offset:30720
    ds_read_b64_tr_b16 v[246:247], v4 offset:31744
    ds_read_b64_tr_b16 v[248:249], v4 offset:28680
    ds_read_b64_tr_b16 v[250:251], v4 offset:29704
    ds_read_b64_tr_b16 v[252:253], v4 offset:30728
    ds_read_b64_tr_b16 v[254:255], v4 offset:31752
    s_waitcnt lgkmcnt(0)
    s_add_u32 m0, s33, 28672
    s_mov_b32 s34, 983040
    buffer_load_dwordx4 v1, s[12:15], s34 offen  lds
    s_add_u32 m0, s33, 29696
    s_mov_b32 s34, 999424
    buffer_load_dwordx4 v1, s[12:15], s34 offen  lds
    s_add_u32 m0, s33, 30720
    s_mov_b32 s34, 1015808
    buffer_load_dwordx4 v1, s[12:15], s34 offen  lds
    s_add_u32 m0, s33, 31744
    s_mov_b32 s34, 1032192
    buffer_load_dwordx4 v1, s[12:15], s34 offen  lds
    s_waitcnt vmcnt(28)
    ds_read_b64_tr_b16 v[32:33], v4 offset:0
    ds_read_b64_tr_b16 v[34:35], v4 offset:1024
    ds_read_b64_tr_b16 v[36:37], v4 offset:2048
    ds_read_b64_tr_b16 v[38:39], v4 offset:3072
    ds_read_b64_tr_b16 v[40:41], v4 offset:8
    ds_read_b64_tr_b16 v[42:43], v4 offset:1032
    ds_read_b64_tr_b16 v[44:45], v4 offset:2056
    ds_read_b64_tr_b16 v[46:47], v4 offset:3080
    s_waitcnt lgkmcnt(0)
    ds_write_b128 v2, v[32:35] offset:0
    ds_write_b128 v2, v[36:39] offset:1024
    ds_write_b128 v2, v[40:43] offset:2048
    ds_write_b128 v2, v[44:47] offset:3072
    s_waitcnt vmcnt(24)
    ds_read_b64_tr_b16 v[32:33], v4 offset:4096
    ds_read_b64_tr_b16 v[34:35], v4 offset:5120
    ds_read_b64_tr_b16 v[36:37], v4 offset:6144
    ds_read_b64_tr_b16 v[38:39], v4 offset:7168
    ds_read_b64_tr_b16 v[40:41], v4 offset:4104
    ds_read_b64_tr_b16 v[42:43], v4 offset:5128
    ds_read_b64_tr_b16 v[44:45], v4 offset:6152
    ds_read_b64_tr_b16 v[46:47], v4 offset:7176
    s_waitcnt lgkmcnt(0)
    ds_write_b128 v2, v[32:35] offset:4096
    ds_write_b128 v2, v[36:39] offset:5120
    ds_write_b128 v2, v[40:43] offset:6144
    ds_write_b128 v2, v[44:47] offset:7168
    s_waitcnt vmcnt(20)
    ds_read_b64_tr_b16 v[32:33], v4 offset:8192
    ds_read_b64_tr_b16 v[34:35], v4 offset:9216
    ds_read_b64_tr_b16 v[36:37], v4 offset:10240
    ds_read_b64_tr_b16 v[38:39], v4 offset:11264
    ds_read_b64_tr_b16 v[40:41], v4 offset:8200
    ds_read_b64_tr_b16 v[42:43], v4 offset:9224
    ds_read_b64_tr_b16 v[44:45], v4 offset:10248
    ds_read_b64_tr_b16 v[46:47], v4 offset:11272
    s_waitcnt lgkmcnt(0)
    ds_write_b128 v2, v[32:35] offset:8192
    ds_write_b128 v2, v[36:39] offset:9216
    ds_write_b128 v2, v[40:43] offset:10240
    ds_write_b128 v2, v[44:47] offset:11264
    s_waitcnt vmcnt(16)
    ds_read_b64_tr_b16 v[32:33], v4 offset:12288
    ds_read_b64_tr_b16 v[34:35], v4 offset:13312
    ds_read_b64_tr_b16 v[36:37], v4 offset:14336
    ds_read_b64_tr_b16 v[38:39], v4 offset:15360
    ds_read_b64_tr_b16 v[40:41], v4 offset:12296
    ds_read_b64_tr_b16 v[42:43], v4 offset:13320
    ds_read_b64_tr_b16 v[44:45], v4 offset:14344
    ds_read_b64_tr_b16 v[46:47], v4 offset:15368
    s_waitcnt lgkmcnt(0)
    ds_write_b128 v2, v[32:35] offset:12288
    ds_write_b128 v2, v[36:39] offset:13312
    ds_write_b128 v2, v[40:43] offset:14336
    ds_write_b128 v2, v[44:47] offset:15360
    s_waitcnt vmcnt(12)
    ds_read_b64_tr_b16 v[32:33], v4 offset:16384
    ds_read_b64_tr_b16 v[34:35], v4 offset:17408
    ds_read_b64_tr_b16 v[36:37], v4 offset:18432
    ds_read_b64_tr_b16 v[38:39], v4 offset:19456
    ds_read_b64_tr_b16 v[40:41], v4 offset:16392
    ds_read_b64_tr_b16 v[42:43], v4 offset:17416
    ds_read_b64_tr_b16 v[44:45], v4 offset:18440
    ds_read_b64_tr_b16 v[46:47], v4 offset:19464
    s_waitcnt lgkmcnt(0)
    ds_write_b128 v2, v[32:35] offset:16384
    ds_write_b128 v2, v[36:39] offset:17408
    ds_write_b128 v2, v[40:43] offset:18432
    ds_write_b128 v2, v[44:47] offset:19456
    s_waitcnt vmcnt(8)
    ds_read_b64_tr_b16 v[32:33], v4 offset:20480
    ds_read_b64_tr_b16 v[34:35], v4 offset:21504
    ds_read_b64_tr_b16 v[36:37], v4 offset:22528
    ds_read_b64_tr_b16 v[38:39], v4 offset:23552
    ds_read_b64_tr_b16 v[40:41], v4 offset:20488
    ds_read_b64_tr_b16 v[42:43], v4 offset:21512
    ds_read_b64_tr_b16 v[44:45], v4 offset:22536
    ds_read_b64_tr_b16 v[46:47], v4 offset:23560
    s_waitcnt lgkmcnt(0)
    ds_write_b128 v2, v[32:35] offset:20480
    ds_write_b128 v2, v[36:39] offset:21504
    ds_write_b128 v2, v[40:43] offset:22528
    ds_write_b128 v2, v[44:47] offset:23552
    s_waitcnt vmcnt(4)
    ds_read_b64_tr_b16 v[32:33], v4 offset:24576
    ds_read_b64_tr_b16 v[34:35], v4 offset:25600
    ds_read_b64_tr_b16 v[36:37], v4 offset:26624
    ds_read_b64_tr_b16 v[38:39], v4 offset:27648
    ds_read_b64_tr_b16 v[40:41], v4 offset:24584
    ds_read_b64_tr_b16 v[42:43], v4 offset:25608
    ds_read_b64_tr_b16 v[44:45], v4 offset:26632
    ds_read_b64_tr_b16 v[46:47], v4 offset:27656
    s_waitcnt lgkmcnt(0)
    ds_write_b128 v2, v[32:35] offset:24576
    ds_write_b128 v2, v[36:39] offset:25600
    ds_write_b128 v2, v[40:43] offset:26624
    ds_write_b128 v2, v[44:47] offset:27648
    s_waitcnt vmcnt(0)
    ds_read_b64_tr_b16 v[32:33], v4 offset:28672
    ds_read_b64_tr_b16 v[34:35], v4 offset:29696
    ds_read_b64_tr_b16 v[36:37], v4 offset:30720
    ds_read_b64_tr_b16 v[38:39], v4 offset:31744
    ds_read_b64_tr_b16 v[40:41], v4 offset:28680
    ds_read_b64_tr_b16 v[42:43], v4 offset:29704
    ds_read_b64_tr_b16 v[44:45], v4 offset:30728
    ds_read_b64_tr_b16 v[46:47], v4 offset:31752
    s_waitcnt lgkmcnt(0)
    ds_write_b128 v2, v[32:35] offset:28672
    ds_write_b128 v2, v[36:39] offset:29696
    ds_write_b128 v2, v[40:43] offset:30720
    ds_write_b128 v2, v[44:47] offset:31744
    s_and_b32 s44, s24, 1
    s_lshr_b32 s45, s24, 1
    v_and_b32 v14, 15, v0
    v_lshrrev_b32 v15, 4, v0
    s_lshl_b32 s34, s44, 4
    v_add_u32 v16, s34, v14
    v_lshlrev_b32 v21, 2, v15
    v_sub_u32 v16, v16, v21
    v_mov_b32 v21, 0
    v_mov_b32 v22, 0xf149f2ca
    v_cmp_le_i32 vcc, 0, v16
    s_nop 1
    v_cndmask_b32 v112, v22, v21, vcc
    v_cmp_le_i32 vcc, 1, v16
    s_nop 1
    v_cndmask_b32 v113, v22, v21, vcc
    v_cmp_le_i32 vcc, 2, v16
    s_nop 1
    v_cndmask_b32 v114, v22, v21, vcc
    v_cmp_le_i32 vcc, 3, v16
    s_nop 1
    v_cndmask_b32 v115, v22, v21, vcc
    v_cmp_le_i32 vcc, 16, v16
    s_nop 1
    v_cndmask_b32 v116, v22, v21, vcc
    v_cmp_le_i32 vcc, 17, v16
    s_nop 1
    v_cndmask_b32 v117, v22, v21, vcc
    v_cmp_le_i32 vcc, 18, v16
    s_nop 1
    v_cndmask_b32 v118, v22, v21, vcc
    v_cmp_le_i32 vcc, 19, v16
    s_nop 1
    v_cndmask_b32 v119, v22, v21, vcc
    v_lshrrev_b32 v21, 2, v14
    v_and_b32 v22, 1, v14
    v_lshl_add_u32 v21, v21, 1, v22
    v_lshlrev_b32 v17, 4, v21
    v_lshl_add_u32 v17, v15, 7, v17
    v_bfe_u32 v21, v0, 2, 3
    v_and_b32 v22, 3, v0
    v_lshlrev_b32 v20, 10, v21
    v_lshl_add_u32 v20, v22, 5, v20
    v_lshrrev_b32 v21, 5, v0
    v_mul_u32_u24 v21, 920, v21
    v_add_u32 v20, v20, v21
    v_lshlrev_b32 v18, 11, v14
    v_lshl_add_u32 v18, v15, 4, v18
    s_lshl_b32 s34, s32, 6
    s_add_u32 s34, s34, 1024
    v_add_u32 v18, s34, v18
    v_and_b32 v19, 7, v0
    s_lshl_b32 s34, s24, 3
    v_add_u32 v19, s34, v19
    v_lshlrev_b32 v19, 2, v19
    v_add_u32 v4, 131072, v5
    s_lshl_b32 s34, s24, 10
    v_add_u32 v3, s34, v4
    v_mov_b32 v121, 0
    v_mov_b32 v122, 0
    s_mov_b32 s41, 0
    s_mov_b32 s43, 0
    s_waitcnt lgkmcnt(0)
    s_barrier
L_wb_round:
    s_add_u32 s37, s41, s30
    s_cmp_ge_u32 s37, 64
    s_cbranch_scc1 L_wb_att_done
    s_mul_i32 s34, s29, 1572864
    s_mul_i32 s35, s37, 24576
    s_add_u32 s34, s34, s35
    s_add_u32 s40, s34, 41943040
    s_lshl_b32 s35, s44, 10
    s_add_u32 s35, s35, s40
    buffer_load_dwordx4 v[24:27], v5, s[4:7], s35 offen offset:0 sc1
    buffer_load_dwordx4 v[28:31], v5, s[4:7], s35 offen offset:2048 sc1
    s_add_u32 s35, s35, 4096
    buffer_load_dwordx4 v[32:35], v5, s[4:7], s35 offen offset:0 sc1
    buffer_load_dwordx4 v[36:39], v5, s[4:7], s35 offen offset:2048 sc1
    s_add_u32 s35, s40, 8192
    buffer_load_dwordx4 v[40:43], v5, s[4:7], s35 offen offset:0 sc1
    buffer_load_dwordx4 v[44:47], v5, s[4:7], s35 offen offset:1024 sc1
    buffer_load_dwordx4 v[48:51], v5, s[4:7], s35 offen offset:2048 sc1
    buffer_load_dwordx4 v[52:55], v5, s[4:7], s35 offen offset:3072 sc1
    s_add_u32 s35, s35, 4096
    buffer_load_dwordx4 v[56:59], v5, s[4:7], s35 offen offset:0 sc1
    buffer_load_dwordx4 v[60:63], v5, s[4:7], s35 offen offset:1024 sc1
    buffer_load_dwordx4 v[64:67], v5, s[4:7], s35 offen offset:2048 sc1
    buffer_load_dwordx4 v[68:71], v5, s[4:7], s35 offen offset:3072 sc1
    s_waitcnt vmcnt(0)
    v_mfma_f32_16x16x32_bf16 v[96:99], v[40:43], v[24:27], v[112:115]
    v_mfma_f32_16x16x32_bf16 v[100:103], v[44:47], v[24:27], v[116:119]
    v_mfma_f32_16x16x32_bf16 v[96:99], v[48:51], v[28:31], v[96:99]
    v_mfma_f32_16x16x32_bf16 v[100:103], v[52:55], v[28:31], v[100:103]
    v_mfma_f32_16x16x32_bf16 v[96:99], v[56:59], v[32:35], v[96:99]
    v_mfma_f32_16x16x32_bf16 v[100:103], v[60:63], v[32:35], v[100:103]
    v_mfma_f32_16x16x32_bf16 v[96:99], v[64:67], v[36:39], v[96:99]
    v_mfma_f32_16x16x32_bf16 v[100:103], v[68:71], v[36:39], v[100:103]
    s_lshl_b32 s46, s37, 13
    s_add_u32 s46, s46, 8388608
L_wb_mem:
L_poll_9:
    buffer_load_dword v15, v20, s[4:7], s46 offen offset:0 sc1
    s_waitcnt vmcnt(0)
    v_cmp_eq_u32 vcc, -1, v15
    s_cbranch_vccz L_polld_10
    s_sub_u32 s27, s27, 1
    s_cbranch_scc1 L_exit
    s_sleep 2
    s_branch L_poll_9
L_polld_10:
    s_add_u32 s35, s46, 4096
    buffer_load_dwordx4 v[40:43], v17, s[4:7], s46 offen offset:0 sc1
    buffer_load_dwordx4 v[44:47], v17, s[4:7], s46 offen offset:512 sc1
    buffer_load_dwordx4 v[48:51], v17, s[4:7], s46 offen offset:1024 sc1
    buffer_load_dwordx4 v[52:55], v17, s[4:7], s46 offen offset:1536 sc1
    buffer_load_dwordx4 v[56:59], v17, s[4:7], s46 offen offset:2048 sc1
    buffer_load_dwordx4 v[60:63], v17, s[4:7], s46 offen offset:2560 sc1
    buffer_load_dwordx4 v[64:67], v17, s[4:7], s46 offen offset:3072 sc1
    buffer_load_dwordx4 v[68:71], v17, s[4:7], s46 offen offset:3584 sc1
    v_mov_b32 v16, 0
    s_waitcnt vmcnt(7)
    v_mfma_f32_16x16x32_bf16 v[72:75], a[0:3], v[40:43], 0
    v_mfma_f32_16x16x32_bf16 v[76:79], a[8:11], v[40:43], 0
    v_max3_u32 v16, v16, v40, v42
    v_mfma_f32_16x16x32_bf16 v[80:83], v[40:43], a[128:131], 0
    v_mfma_f32_16x16x32_bf16 v[84:87], v[40:43], a[136:139], 0
    buffer_load_dwordx4 v[40:43], v17, s[4:7], s35 offen offset:0 sc1
    s_waitcnt vmcnt(7)
    v_mfma_f32_16x16x32_bf16 v[72:75], a[4:7], v[44:47], v[72:75]
    v_mfma_f32_16x16x32_bf16 v[76:79], a[12:15], v[44:47], v[76:79]
    v_max3_u32 v16, v16, v44, v46
    v_mfma_f32_16x16x32_bf16 v[80:83], v[44:47], a[132:135], v[80:83]
    v_mfma_f32_16x16x32_bf16 v[84:87], v[44:47], a[140:143], v[84:87]
    buffer_load_dwordx4 v[44:47], v17, s[4:7], s35 offen offset:512 sc1
    s_waitcnt vmcnt(7)
    v_mfma_f32_16x16x32_bf16 v[72:75], a[16:19], v[48:51], v[72:75]
    v_mfma_f32_16x16x32_bf16 v[76:79], a[24:27], v[48:51], v[76:79]
    v_max3_u32 v16, v16, v48, v50
    v_mfma_f32_16x16x32_bf16 v[80:83], v[48:51], a[144:147], v[80:83]
    v_mfma_f32_16x16x32_bf16 v[84:87], v[48:51], a[152:155], v[84:87]
    buffer_load_dwordx4 v[48:51], v17, s[4:7], s35 offen offset:1024 sc1
    s_waitcnt vmcnt(7)
    v_mfma_f32_16x16x32_bf16 v[72:75], a[20:23], v[52:55], v[72:75]
    v_mfma_f32_16x16x32_bf16 v[76:79], a[28:31], v[52:55], v[76:79]
    v_max3_u32 v16, v16, v52, v54
    v_mfma_f32_16x16x32_bf16 v[80:83], v[52:55], a[148:151], v[80:83]
    v_mfma_f32_16x16x32_bf16 v[84:87], v[52:55], a[156:159], v[84:87]
    buffer_load_dwordx4 v[52:55], v17, s[4:7], s35 offen offset:1536 sc1
    s_waitcnt vmcnt(7)
    v_mfma_f32_16x16x32_bf16 v[72:75], a[32:35], v[56:59], v[72:75]
    v_mfma_f32_16x16x32_bf16 v[76:79], a[40:43], v[56:59], v[76:79]
    v_max3_u32 v16, v16, v56, v58
    v_mfma_f32_16x16x32_bf16 v[80:83], v[56:59], a[160:163], v[80:83]
    v_mfma_f32_16x16x32_bf16 v[84:87], v[56:59], a[168:171], v[84:87]
    buffer_load_dwordx4 v[56:59], v17, s[4:7], s35 offen offset:2048 sc1
    s_waitcnt vmcnt(7)
    v_mfma_f32_16x16x32_bf16 v[72:75], a[36:39], v[60:63], v[72:75]
    v_mfma_f32_16x16x32_bf16 v[76:79], a[44:47], v[60:63], v[76:79]
    v_max3_u32 v16, v16, v60, v62
    v_mfma_f32_16x16x32_bf16 v[80:83], v[60:63], a[164:167], v[80:83]
    v_mfma_f32_16x16x32_bf16 v[84:87], v[60:63], a[172:175], v[84:87]
    buffer_load_dwordx4 v[60:63], v17, s[4:7], s35 offen offset:2560 sc1
    s_waitcnt vmcnt(7)
    v_mfma_f32_16x16x32_bf16 v[72:75], a[48:51], v[64:67], v[72:75]
    v_mfma_f32_16x16x32_bf16 v[76:79], a[56:59], v[64:67], v[76:79]
    v_max3_u32 v16, v16, v64, v66
    v_mfma_f32_16x16x32_bf16 v[80:83], v[64:67], a[176:179], v[80:83]
    v_mfma_f32_16x16x32_bf16 v[84:87], v[64:67], a[184:187], v[84:87]
    buffer_load_dwordx4 v[64:67], v17, s[4:7], s35 offen offset:3072 sc1
    s_waitcnt vmcnt(7)
    v_mfma_f32_16x16x32_bf16 v[72:75], a[52:55], v[68:71], v[72:75]
    v_mfma_f32_16x16x32_bf16 v[76:79], a[60:63], v[68:71], v[76:79]
    v_max3_u32 v16, v16, v68, v70
    v_mfma_f32_16x16x32_bf16 v[80:83], v[68:71], a[180:183], v[80:83]
    v_mfma_f32_16x16x32_bf16 v[84:87], v[68:71], a[188:191], v[84:87]
    buffer_load_dwordx4 v[68:71], v17, s[4:7], s35 offen offset:3584 sc1
    s_waitcnt vmcnt(7)
    v_mfma_f32_16x16x32_bf16 v[72:75], a[64:67], v[40:43], v[72:75]
    v_mfma_f32_16x16x32_bf16 v[76:79], a[72:75], v[40:43], v[76:79]
    v_max3_u32 v16, v16, v40, v42
    v_mfma_f32_16x16x32_bf16 v[80:83], v[40:43], a[192:195], v[80:83]
    v_mfma_f32_16x16x32_bf16 v[84:87], v[40:43], a[200:203], v[84:87]
    s_waitcnt vmcnt(6)
    v_mfma_f32_16x16x32_bf16 v[72:75], a[68:71], v[44:47], v[72:75]
    v_mfma_f32_16x16x32_bf16 v[76:79], a[76:79], v[44:47], v[76:79]
    v_max3_u32 v16, v16, v44, v46
    v_mfma_f32_16x16x32_bf16 v[80:83], v[44:47], a[196:199], v[80:83]
    v_mfma_f32_16x16x32_bf16 v[84:87], v[44:47], a[204:207], v[84:87]
    s_waitcnt vmcnt(5)
    v_mfma_f32_16x16x32_bf16 v[72:75], a[80:83], v[48:51], v[72:75]
    v_mfma_f32_16x16x32_bf16 v[76:79], a[88:91], v[48:51], v[76:79]
    v_max3_u32 v16, v16, v48, v50
    v_mfma_f32_16x16x32_bf16 v[80:83], v[48:51], a[208:211], v[80:83]
    v_mfma_f32_16x16x32_bf16 v[84:87], v[48:51], a[216:219], v[84:87]
    s_waitcnt vmcnt(4)
    v_mfma_f32_16x16x32_bf16 v[72:75], a[84:87], v[52:55], v[72:75]
    v_mfma_f32_16x16x32_bf16 v[76:79], a[92:95], v[52:55], v[76:79]
    v_max3_u32 v16, v16, v52, v54
    v_mfma_f32_16x16x32_bf16 v[80:83], v[52:55], a[212:215], v[80:83]
    v_mfma_f32_16x16x32_bf16 v[84:87], v[52:55], a[220:223], v[84:87]
    s_waitcnt vmcnt(3)
    v_mfma_f32_16x16x32_bf16 v[72:75], a[96:99], v[56:59], v[72:75]
    v_mfma_f32_16x16x32_bf16 v[76:79], a[104:107], v[56:59], v[76:79]
    v_max3_u32 v16, v16, v56, v58
    v_mfma_f32_16x16x32_bf16 v[80:83], v[56:59], a[224:227], v[80:83]
    v_mfma_f32_16x16x32_bf16 v[84:87], v[56:59], a[232:235], v[84:87]
    s_waitcnt vmcnt(2)
    v_mfma_f32_16x16x32_bf16 v[72:75], a[100:103], v[60:63], v[72:75]
    v_mfma_f32_16x16x32_bf16 v[76:79], a[108:111], v[60:63], v[76:79]
    v_max3_u32 v16, v16, v60, v62
    v_mfma_f32_16x16x32_bf16 v[80:83], v[60:63], a[228:231], v[80:83]
    v_mfma_f32_16x16x32_bf16 v[84:87], v[60:63], a[236:239], v[84:87]
    s_waitcnt vmcnt(1)
    v_mfma_f32_16x16x32_bf16 v[72:75], a[112:115], v[64:67], v[72:75]
    v_mfma_f32_16x16x32_bf16 v[76:79], a[120:123], v[64:67], v[76:79]
    v_max3_u32 v16, v16, v64, v66
    v_mfma_f32_16x16x32_bf16 v[80:83], v[64:67], a[240:243], v[80:83]
    v_mfma_f32_16x16x32_bf16 v[84:87], v[64:67], a[248:251], v[84:87]
    s_waitcnt vmcnt(0)
    v_mfma_f32_16x16x32_bf16 v[72:75], a[116:119], v[68:71], v[72:75]
    v_mfma_f32_16x16x32_bf16 v[76:79], a[124:127], v[68:71], v[76:79]
    v_max3_u32 v16, v16, v68, v70
    v_mfma_f32_16x16x32_bf16 v[80:83], v[68:71], a[244:247], v[80:83]
    v_mfma_f32_16x16x32_bf16 v[84:87], v[68:71], a[252:255], v[84:87]
    v_cmp_eq_u32 vcc, -1, v16
    s_sub_u32 s27, s27, 1
    s_cbranch_scc1 L_exit
    s_cbranch_vccnz L_wb_mem
    s_lshl_b32 s35, s45, 12
    s_add_u32 s35, s35, s40
    s_add_u32 s35, s35, 16384
    buffer_load_dwordx4 v[40:43], v5, s[4:7], s35 offen offset:0 sc1
    buffer_load_dwordx4 v[44:47], v5, s[4:7], s35 offen offset:1024 sc1
    buffer_load_dwordx4 v[48:51], v5, s[4:7], s35 offen offset:2048 sc1
    buffer_load_dwordx4 v[52:55], v5, s[4:7], s35 offen offset:3072 sc1
    v_cvt_pk_bf16_f32 v88, v72, v73
    v_cvt_pk_bf16_f32 v89, v74, v75
    v_cvt_pk_bf16_f32 v90, v76, v77
    v_cvt_pk_bf16_f32 v91, v78, v79
    v_cvt_pk_bf16_f32 v92, v80, v81
    v_cvt_pk_bf16_f32 v93, v84, v85
    ds_write_b128 v3, v[88:91]
    ds_write_b64 v3, v[92:93] offset:4096
    s_waitcnt lgkmcnt(0)
    s_barrier
    ds_read_b128 v[56:59], v4 offset:0
    ds_read_b128 v[60:63], v4 offset:1024
    ds_read_b128 v[64:67], v4 offset:2048
    ds_read_b128 v[68:71], v4 offset:3072
    s_lshl_b32 s35, s45, 11
    v_add_u32 v14, s35, v4
    ds_read_b64 v[88:89], v14 offset:4096
    ds_read_b64 v[90:91], v14 offset:5120
    s_waitcnt lgkmcnt(5)
    v_mfma_f32_16x16x32_bf16 v[104:107], v[56:59], v[24:27], 0
    s_waitcnt lgkmcnt(4)
    v_mfma_f32_16x16x32_bf16 v[104:107], v[60:63], v[28:31], v[104:107]
    s_waitcnt lgkmcnt(3)
    v_mfma_f32_16x16x32_bf16 v[104:107], v[64:67], v[32:35], v[104:107]
    s_waitcnt lgkmcnt(2)
    v_mfma_f32_16x16x32_bf16 v[104:107], v[68:71], v[36:39], v[104:107]
    v_max3_f32 v108, v96, v97, v98
    v_max3_f32 v108, v108, v99, v100
    v_max3_f32 v108, v108, v101, v102
    s_nop 4
    v_max3_f32 v108, v108, v103, v104
    v_max_f32 v108, v108, v105
    v_mov_b32 v109, v108
    s_nop 1
    v_permlane16_swap_b32 v108, v109
    v_max_f32 v108, v108, v109
    v_mov_b32 v109, v108
    s_nop 1
    v_permlane32_swap_b32 v108, v109
    v_max_f32 v108, v108, v109
    s_mov_b32 s35, 1040356334
    v_mul_f32 v111, s35, v108
    v_fma_f32 v96, v96, s35, -v111
    v_fma_f32 v97, v97, s35, -v111
    v_fma_f32 v98, v98, s35, -v111
    v_fma_f32 v99, v99, s35, -v111
    v_fma_f32 v100, v100, s35, -v111
    v_fma_f32 v101, v101, s35, -v111
    v_fma_f32 v102, v102, s35, -v111
    v_fma_f32 v103, v103, s35, -v111
    v_fma_f32 v104, v104, s35, -v111
    v_fma_f32 v105, v105, s35, -v111
    v_exp_f32 v96, v96
    v_exp_f32 v97, v97
    v_exp_f32 v98, v98
    v_exp_f32 v99, v99
    v_exp_f32 v100, v100
    v_exp_f32 v101, v101
    v_exp_f32 v102, v102
    v_exp_f32 v103, v103
    v_exp_f32 v104, v104
    v_exp_f32 v105, v105
    v_cvt_pk_bf16_f32 v92, v96, v97
    v_cvt_pk_bf16_f32 v93, v98, v99
    v_cvt_pk_bf16_f32 v94, v100, v101
    v_cvt_pk_bf16_f32 v95, v102, v103
    v_cvt_pk_bf16_f32 v120, v104, v105
    v_cvt_pk_bf16_f32 v123, v104, v105
    s_waitcnt vmcnt(0) lgkmcnt(0)
    v_mfma_f32_16x16x32_bf16 v[72:75], v[40:43], v[92:95], 0
    v_mfma_f32_16x16x32_bf16 v[76:79], v[44:47], v[92:95], 0
    v_mfma_f32_16x16x32_bf16 v[80:83], v[48:51], v[92:95], 0
    v_mfma_f32_16x16x32_bf16 v[84:87], v[52:55], v[92:95], 0
    v_mfma_f32_16x16x16_bf16 v[72:75], v[88:89], v[120:121], v[72:75]
    v_mfma_f32_16x16x16_bf16 v[76:79], v[88:89], v[122:123], v[76:79]
    v_mfma_f32_16x16x16_bf16 v[80:83], v[90:91], v[120:121], v[80:83]
    v_mfma_f32_16x16x16_bf16 v[84:87], v[90:91], v[122:123], v[84:87]
    v_add_f32 v110, v104, v105
    v_add_f32 v110, v110, v96
    v_add_f32 v110, v110, v97
    v_add_f32 v110, v110, v98
    v_add_f32 v110, v110, v99
    v_add_f32 v110, v110, v100
    v_add_f32 v110, v110, v101
    v_add_f32 v110, v110, v102
    v_add_f32 v110, v110, v103
    v_mov_b32 v109, v110
    s_nop 1
    v_permlane16_swap_b32 v110, v109
    v_add_f32 v110, v110, v109
    v_mov_b32 v109, v110
    s_nop 1
    v_permlane32_swap_b32 v110, v109
    v_add_f32 v110, v110, v109
    v_rcp_f32 v110, v110
    s_nop 0
    v_mul_f32 v72, v72, v110
    v_mul_f32 v73, v73, v110
    v_mul_f32 v74, v74, v110
    v_mul_f32 v75, v75, v110
    v_mul_f32 v76, v76, v110
    v_mul_f32 v77, v77, v110
    v_mul_f32 v78, v78, v110
    v_mul_f32 v79, v79, v110
    v_mul_f32 v80, v80, v110
    v_mul_f32 v81, v81, v110
    v_mul_f32 v82, v82, v110
    v_mul_f32 v83, v83, v110
    v_mul_f32 v84, v84, v110
    v_mul_f32 v85, v85, v110
    v_mul_f32 v86, v86, v110
    v_mul_f32 v87, v87, v110
    v_cvt_pk_bf16_f32 v56, v72, v73
    v_cvt_pk_bf16_f32 v57, v74, v75
    v_cvt_pk_bf16_f32 v58, v76, v77
    v_cvt_pk_bf16_f32 v59, v78, v79
    v_cvt_pk_bf16_f32 v60, v80, v81
    v_cvt_pk_bf16_f32 v61, v82, v83
    v_cvt_pk_bf16_f32 v62, v84, v85
    v_cvt_pk_bf16_f32 v63, v86, v87
    s_lshl_b32 s34, s37, 1
    s_add_u32 s34, s34, s44
    s_lshl_b32 s34, s34, 17
    s_lshl_b32 s35, s29, 12
    s_add_u32 s34, s34, s35
    s_lshl_b32 s35, s45, 11
    s_add_u32 s34, s34, s35
    s_add_u32 s34, s34, 25165824
    buffer_store_dwordx4 v[56:59], v5, s[4:7], s34 offen sc1
    buffer_store_dwordx4 v[60:63], v5, s[4:7], s34 offen offset:1024 sc1
    s_waitcnt vmcnt(0)
    s_barrier
    s_cmp_lg_u32 s24, 0
    s_cbranch_scc1 L_wb_att_done
    s_lshl_b32 s34, s37, 5
    s_add_u32 s34, s34, s29
    s_lshl_b32 s34, s34, 2
    s_add_u32 s34, s34, 8192
    v_mov_b32 v14, s34
    v_mov_b32 v15, 1
    s_mov_b64 exec, 1
    buffer_store_dword v15, v14, s[4:7], 0 offen offset:0 sc1
    s_mov_b64 exec, -1
L_wb_att_done:
    s_lshr_b32 s34, s31, 1
    s_add_u32 s42, s41, s34
    s_cmp_ge_u32 s42, 64
    s_cbranch_scc1 L_wb_out_done
    s_lshl_b32 s34, s42, 7
    s_add_u32 s34, s34, 8192
L_poll_11:
    buffer_load_dword v15, v19, s[4:7], s34 offen offset:0 sc1
    s_waitcnt vmcnt(0)
    v_cmp_ne_u32 vcc, 1, v15
    s_cbranch_vccz L_polld_12
    s_sub_u32 s27, s27, 1
    s_cbranch_scc1 L_exit
    s_sleep 2
    s_branch L_poll_11
L_polld_12:
    s_and_b32 s36, s31, 1
    s_lshl_b32 s34, s42, 1
    s_add_u32 s36, s34, s36
    s_lshl_b32 s34, s36, 17
    s_lshl_b32 s35, s24, 15
    s_add_u32 s34, s34, s35
    s_add_u32 s34, s34, 25165824
    buffer_load_dwordx4 v[24:27], v5, s[4:7], s34 offen offset:0 sc1
    buffer_load_dwordx4 v[28:31], v5, s[4:7], s34 offen offset:1024 sc1
    buffer_load_dwordx4 v[32:35], v5, s[4:7], s34 offen offset:2048 sc1
    buffer_load_dwordx4 v[36:39], v5, s[4:7], s34 offen offset:3072 sc1
    s_add_u32 s34, s34, 4096
    buffer_load_dwordx4 v[40:43], v5, s[4:7], s34 offen offset:0 sc1
    buffer_load_dwordx4 v[44:47], v5, s[4:7], s34 offen offset:1024 sc1
    buffer_load_dwordx4 v[48:51], v5, s[4:7], s34 offen offset:2048 sc1
    buffer_load_dwordx4 v[52:55], v5, s[4:7], s34 offen offset:3072 sc1
    s_add_u32 s34, s34, 4096
    buffer_load_dwordx4 v[56:59], v5, s[4:7], s34 offen offset:0 sc1
    buffer_load_dwordx4 v[60:63], v5, s[4:7], s34 offen offset:1024 sc1
    buffer_load_dwordx4 v[64:67], v5, s[4:7], s34 offen offset:2048 sc1
    buffer_load_dwordx4 v[68:71], v5, s[4:7], s34 offen offset:3072 sc1
    s_add_u32 s34, s34, 4096
    buffer_load_dwordx4 v[72:75], v5, s[4:7], s34 offen offset:0 sc1
    buffer_load_dwordx4 v[76:79], v5, s[4:7], s34 offen offset:1024 sc1
    buffer_load_dwordx4 v[80:83], v5, s[4:7], s34 offen offset:2048 sc1
    buffer_load_dwordx4 v[84:87], v5, s[4:7], s34 offen offset:3072 sc1
    ds_read_b128 v[88:91], v2 offset:0
    ds_read_b128 v[92:95], v2 offset:2048
    ds_read_b128 v[96:99], v2 offset:1024
    ds_read_b128 v[100:103], v2 offset:3072
    s_waitcnt vmcnt(15)
    v_mfma_f32_16x16x32_bf16 v[104:107], v[128:131], v[24:27], 0
    v_mfma_f32_16x16x32_bf16 v[108:111], v[136:139], v[24:27], 0
    s_add_u32 s34, s34, 4096
    buffer_load_dwordx4 v[24:27], v5, s[4:7], s34 offen offset:0 sc1
    s_waitcnt vmcnt(15)
    v_mfma_f32_16x16x32_bf16 v[104:107], v[132:135], v[28:31], v[104:107]
    v_mfma_f32_16x16x32_bf16 v[108:111], v[140:143], v[28:31], v[108:111]
    buffer_load_dwordx4 v[28:31], v5, s[4:7], s34 offen offset:1024 sc1
    s_waitcnt vmcnt(15)
    v_mfma_f32_16x16x32_bf16 v[104:107], v[144:147], v[32:35], v[104:107]
    v_mfma_f32_16x16x32_bf16 v[108:111], v[152:155], v[32:35], v[108:111]
    buffer_load_dwordx4 v[32:35], v5, s[4:7], s34 offen offset:2048 sc1
    s_waitcnt vmcnt(15)
    v_mfma_f32_16x16x32_bf16 v[104:107], v[148:151], v[36:39], v[104:107]
    v_mfma_f32_16x16x32_bf16 v[108:111], v[156:159], v[36:39], v[108:111]
    buffer_load_dwordx4 v[36:39], v5, s[4:7], s34 offen offset:3072 sc1
    s_waitcnt vmcnt(15)
    v_mfma_f32_16x16x32_bf16 v[104:107], v[160:163], v[40:43], v[104:107]
    v_mfma_f32_16x16x32_bf16 v[108:111], v[168:171], v[40:43], v[108:111]
    s_add_u32 s34, s34, 4096
    buffer_load_dwordx4 v[40:43], v5, s[4:7], s34 offen offset:0 sc1
    s_waitcnt vmcnt(15)
    v_mfma_f32_16x16x32_bf16 v[104:107], v[164:167], v[44:47], v[104:107]
    v_mfma_f32_16x16x32_bf16 v[108:111], v[172:175], v[44:47], v[108:111]
    buffer_load_dwordx4 v[44:47], v5, s[4:7], s34 offen offset:1024 sc1
    s_waitcnt vmcnt(15)
    v_mfma_f32_16x16x32_bf16 v[104:107], v[176:179], v[48:51], v[104:107]
    v_mfma_f32_16x16x32_bf16 v[108:111], v[184:187], v[48:51], v[108:111]
    buffer_load_dwordx4 v[48:51], v5, s[4:7], s34 offen offset:2048 sc1
    s_waitcnt vmcnt(15)
    v_mfma_f32_16x16x32_bf16 v[104:107], v[180:183], v[52:55], v[104:107]
    v_mfma_f32_16x16x32_bf16 v[108:111], v[188:191], v[52:55], v[108:111]
    buffer_load_dwordx4 v[52:55], v5, s[4:7], s34 offen offset:3072 sc1
    s_waitcnt vmcnt(15)
    v_mfma_f32_16x16x32_bf16 v[104:107], v[192:195], v[56:59], v[104:107]
    v_mfma_f32_16x16x32_bf16 v[108:111], v[200:203], v[56:59], v[108:111]
    s_add_u32 s34, s34, 4096
    buffer_load_dwordx4 v[56:59], v5, s[4:7], s34 offen offset:0 sc1
    s_waitcnt vmcnt(15)
    v_mfma_f32_16x16x32_bf16 v[104:107], v[196:199], v[60:63], v[104:107]
    v_mfma_f32_16x16x32_bf16 v[108:111], v[204:207], v[60:63], v[108:111]
    buffer_load_dwordx4 v[60:63], v5, s[4:7], s34 offen offset:1024 sc1
    s_waitcnt vmcnt(15)
    v_mfma_f32_16x16x32_bf16 v[104:107], v[208:211], v[64:67], v[104:107]
    v_mfma_f32_16x16x32_bf16 v[108:111], v[216:219], v[64:67], v[108:111]
    buffer_load_dwordx4 v[64:67], v5, s[4:7], s34 offen offset:2048 sc1
    s_waitcnt vmcnt(15)
    v_mfma_f32_16x16x32_bf16 v[104:107], v[212:215], v[68:71], v[104:107]
    v_mfma_f32_16x16x32_bf16 v[108:111], v[220:223], v[68:71], v[108:111]
    buffer_load_dwordx4 v[68:71], v5, s[4:7], s34 offen offset:3072 sc1
    s_waitcnt vmcnt(15)
    v_mfma_f32_16x16x32_bf16 v[104:107], v[224:227], v[72:75], v[104:107]
    v_mfma_f32_16x16x32_bf16 v[108:111], v[232:235], v[72:75], v[108:111]
    s_add_u32 s34, s34, 4096
    buffer_load_dwordx4 v[72:75], v5, s[4:7], s34 offen offset:0 sc1
    s_waitcnt vmcnt(15)
    v_mfma_f32_16x16x32_bf16 v[104:107], v[228:231], v[76:79], v[104:107]
    v_mfma_f32_16x16x32_bf16 v[108:111], v[236:239], v[76:79], v[108:111]
    buffer_load_dwordx4 v[76:79], v5, s[4:7], s34 offen offset:1024 sc1
    s_waitcnt vmcnt(15)
    v_mfma_f32_16x16x32_bf16 v[104:107], v[240:243], v[80:83], v[104:107]
    v_mfma_f32_16x16x32_bf16 v[108:111], v[248:251], v[80:83], v[108:111]
    buffer_load_dwordx4 v[80:83], v5, s[4:7], s34 offen offset:2048 sc1
    s_waitcnt vmcnt(15)
    v_mfma_f32_16x16x32_bf16 v[104:107], v[244:247], v[84:87], v[104:107]
    v_mfma_f32_16x16x32_bf16 v[108:111], v[252:255], v[84:87], v[108:111]
    buffer_load_dwordx4 v[84:87], v5, s[4:7], s34 offen offset:3072 sc1
    s_waitcnt vmcnt(15) lgkmcnt(2)
    v_mfma_f32_16x16x32_bf16 v[104:107], v[88:91], v[24:27], v[104:107]
    v_mfma_f32_16x16x32_bf16 v[108:111], v[92:95], v[24:27], v[108:111]
    ds_read_b128 v[88:91], v2 offset:4096
    ds_read_b128 v[92:95], v2 offset:6144
    s_waitcnt vmcnt(14) lgkmcnt(2)
    v_mfma_f32_16x16x32_bf16 v[104:107], v[96:99], v[28:31], v[104:107]
    v_mfma_f32_16x16x32_bf16 v[108:111], v[100:103], v[28:31], v[108:111]
    ds_read_b128 v[96:99], v2 offset:5120
    ds_read_b128 v[100:103], v2 offset:7168
    s_waitcnt vmcnt(13) lgkmcnt(2)
    v_mfma_f32_16x16x32_bf16 v[104:107], v[88:91], v[32:35], v[104:107]
    v_mfma_f32_16x16x32_bf16 v[108:111], v[92:95], v[32:35], v[108:111]
    ds_read_b128 v[88:91], v2 offset:8192
    ds_read_b128 v[92:95], v2 offset:10240
    s_waitcnt vmcnt(12) lgkmcnt(2)
    v_mfma_f32_16x16x32_bf16 v[104:107], v[96:99], v[36:39], v[104:107]
    v_mfma_f32_16x16x32_bf16 v[108:111], v[100:103], v[36:39], v[108:111]
    ds_read_b128 v[96:99], v2 offset:9216
    ds_read_b128 v[100:103], v2 offset:11264
    s_waitcnt vmcnt(11) lgkmcnt(2)
    v_mfma_f32_16x16x32_bf16 v[104:107], v[88:91], v[40:43], v[104:107]
    v_mfma_f32_16x16x32_bf16 v[108:111], v[92:95], v[40:43], v[108:111]
    ds_read_b128 v[88:91], v2 offset:12288
    ds_read_b128 v[92:95], v2 offset:14336
    s_waitcnt vmcnt(10) lgkmcnt(2)
    v_mfma_f32_16x16x32_bf16 v[104:107], v[96:99], v[44:47], v[104:107]
    v_mfma_f32_16x16x32_bf16 v[108:111], v[100:103], v[44:47], v[108:111]
    ds_read_b128 v[96:99], v2 offset:13312
    ds_read_b128 v[100:103], v2 offset:15360
    s_waitcnt vmcnt(9) lgkmcnt(2)
    v_mfma_f32_16x16x32_bf16 v[104:107], v[88:91], v[48:51], v[104:107]
    v_mfma_f32_16x16x32_bf16 v[108:111], v[92:95], v[48:51], v[108:111]
    ds_read_b128 v[88:91], v2 offset:16384
    ds_read_b128 v[92:95], v2 offset:18432
    s_waitcnt vmcnt(8) lgkmcnt(2)
    v_mfma_f32_16x16x32_bf16 v[104:107], v[96:99], v[52:55], v[104:107]
    v_mfma_f32_16x16x32_bf16 v[108:111], v[100:103], v[52:55], v[108:111]
    ds_read_b128 v[96:99], v2 offset:17408
    ds_read_b128 v[100:103], v2 offset:19456
    s_waitcnt vmcnt(7) lgkmcnt(2)
    v_mfma_f32_16x16x32_bf16 v[104:107], v[88:91], v[56:59], v[104:107]
    v_mfma_f32_16x16x32_bf16 v[108:111], v[92:95], v[56:59], v[108:111]
    ds_read_b128 v[88:91], v2 offset:20480
    ds_read_b128 v[92:95], v2 offset:22528
    s_waitcnt vmcnt(6) lgkmcnt(2)
    v_mfma_f32_16x16x32_bf16 v[104:107], v[96:99], v[60:63], v[104:107]
    v_mfma_f32_16x16x32_bf16 v[108:111], v[100:103], v[60:63], v[108:111]
    ds_read_b128 v[96:99], v2 offset:21504
    ds_read_b128 v[100:103], v2 offset:23552
    s_waitcnt vmcnt(5) lgkmcnt(2)
    v_mfma_f32_16x16x32_bf16 v[104:107], v[88:91], v[64:67], v[104:107]
    v_mfma_f32_16x16x32_bf16 v[108:111], v[92:95], v[64:67], v[108:111]
    ds_read_b128 v[88:91], v2 offset:24576
    ds_read_b128 v[92:95], v2 offset:26624
    s_waitcnt vmcnt(4) lgkmcnt(2)
    v_mfma_f32_16x16x32_bf16 v[104:107], v[96:99], v[68:71], v[104:107]
    v_mfma_f32_16x16x32_bf16 v[108:111], v[100:103], v[68:71], v[108:111]
    ds_read_b128 v[96:99], v2 offset:25600
    ds_read_b128 v[100:103], v2 offset:27648
    s_waitcnt vmcnt(3) lgkmcnt(2)
    v_mfma_f32_16x16x32_bf16 v[104:107], v[88:91], v[72:75], v[104:107]
    v_mfma_f32_16x16x32_bf16 v[108:111], v[92:95], v[72:75], v[108:111]
    ds_read_b128 v[88:91], v2 offset:28672
    ds_read_b128 v[92:95], v2 offset:30720
    s_waitcnt vmcnt(2) lgkmcnt(2)
    v_mfma_f32_16x16x32_bf16 v[104:107], v[96:99], v[76:79], v[104:107]
    v_mfma_f32_16x16x32_bf16 v[108:111], v[100:103], v[76:79], v[108:111]
    ds_read_b128 v[96:99], v2 offset:29696
    ds_read_b128 v[100:103], v2 offset:31744
    s_waitcnt vmcnt(1) lgkmcnt(2)
    v_mfma_f32_16x16x32_bf16 v[104:107], v[88:91], v[80:83], v[104:107]
    v_mfma_f32_16x16x32_bf16 v[108:111], v[92:95], v[80:83], v[108:111]
    s_waitcnt vmcnt(0) lgkmcnt(0)
    v_mfma_f32_16x16x32_bf16 v[104:107], v[96:99], v[84:87], v[104:107]
    v_mfma_f32_16x16x32_bf16 v[108:111], v[100:103], v[84:87], v[108:111]
    s_lshl_b32 s34, s24, 11
    s_add_u32 s34, s34, s43
    v_add_u32 v14, s34, v4
    s_nop 0
    ds_write_b128 v14, v[104:107] offset:8192
    s_nop 2
    ds_write_b128 v14, v[108:111] offset:9216
    s_waitcnt lgkmcnt(0)
    s_barrier
    s_cmp_lg_u32 s24, 0
    s_cbranch_scc1 L_wb_out_skip
    ds_read_b128 v[24:27], v14 offset:10240
    ds_read_b128 v[28:31], v14 offset:11264
    ds_read_b128 v[32:35], v14 offset:12288
    ds_read_b128 v[36:39], v14 offset:13312
    ds_read_b128 v[40:43], v14 offset:14336
    ds_read_b128 v[44:47], v14 offset:15360
    s_waitcnt lgkmcnt(0)
    v_add_f32 v104, v104, v24
    v_add_f32 v105, v105, v25
    v_add_f32 v106, v106, v26
    v_add_f32 v107, v107, v27
    v_add_f32 v108, v108, v28
    v_add_f32 v109, v109, v29
    v_add_f32 v110, v110, v30
    v_add_f32 v111, v111, v31
    v_add_f32 v104, v104, v32
    v_add_f32 v105, v105, v33
    v_add_f32 v106, v106, v34
    v_add_f32 v107, v107, v35
    v_add_f32 v108, v108, v36
    v_add_f32 v109, v109, v37
    v_add_f32 v110, v110, v38
    v_add_f32 v111, v111, v39
    v_add_f32 v104, v104, v40
    v_add_f32 v105, v105, v41
    v_add_f32 v106, v106, v42
    v_add_f32 v107, v107, v43
    v_add_f32 v108, v108, v44
    v_add_f32 v109, v109, v45
    v_add_f32 v110, v110, v46
    v_add_f32 v111, v111, v47
    v_cvt_pk_bf16_f32 v124, v104, v105
    v_cvt_pk_bf16_f32 v125, v106, v107
    v_cvt_pk_bf16_f32 v126, v108, v109
    v_cvt_pk_bf16_f32 v127, v110, v111
    s_lshl_b32 s36, s36, 15
    buffer_store_dwordx4 v[124:127], v18, s[20:23], s36 offen sc1
L_wb_out_skip:
    s_xor_b32 s43, s43, 8192
L_wb_out_done:
    s_add_u32 s41, s41, 6
    s_cmp_lt_u32 s41, 64
    s_cbranch_scc1 L_wb_round
    s_waitcnt vmcnt(0)
    s_endpgm
L_role_wa:
    v_lshlrev_b32 v5, 4, v0
    v_mov_b32 v20, 0
    v_mov_b32 v21, 0
    v_mov_b32 v22, 0
    v_mov_b32 v23, 0
    v_mov_b32 v28, -1
    v_mov_b32 v29, -1
    v_mov_b32 v30, -1
    v_mov_b32 v31, -1
    s_lshl_b32 s34, s25, 14
    s_lshl_b32 s35, s24, 12
    s_add_u32 s34, s34, s35
    s_add_u32 s34, s34, 8388608
    buffer_store_dwordx4 v[28:31], v5, s[4:7], s34 offen offset:0 sc1
    buffer_store_dwordx4 v[28:31], v5, s[4:7], s34 offen offset:1024 sc1
    buffer_store_dwordx4 v[28:31], v5, s[4:7], s34 offen offset:2048 sc1
    buffer_store_dwordx4 v[28:31], v5, s[4:7], s34 offen offset:3072 sc1
    s_lshl_b32 s34, s25, 1
    s_lshr_b32 s35, s24, 1
    s_add_u32 s34, s34, s35
    s_mul_i32 s34, s34, 24576
    s_and_b32 s35, s24, 1
    s_mul_i32 s35, s35, 6144
    s_add_u32 s34, s34, s35
    s_add_u32 s34, s34, 93323264
    buffer_store_dwordx4 v[28:31], v5, s[4:7], s34 offen offset:0 sc1
    buffer_store_dwordx4 v[28:31], v5, s[4:7], s34 offen offset:1024 sc1
    buffer_store_dwordx4 v[28:31], v5, s[4:7], s34 offen offset:2048 sc1
    s_add_u32 s34, s34, 3072
    buffer_store_dwordx4 v[28:31], v5, s[4:7], s34 offen offset:0 sc1
    buffer_store_dwordx4 v[28:31], v5, s[4:7], s34 offen offset:1024 sc1
    buffer_store_dwordx4 v[28:31], v5, s[4:7], s34 offen offset:2048 sc1
    s_lshl_b32 s34, s25, 13
    s_lshl_b32 s35, s24, 11
    s_add_u32 s34, s34, s35
    s_add_u32 s34, s34, 262144
    buffer_store_dwordx4 v[20:23], v5, s[4:7], s34 offen offset:0 sc1
    buffer_store_dwordx4 v[20:23], v5, s[4:7], s34 offen offset:1024 sc1
    s_lshl_b32 s34, s25, 10
    buffer_store_dwordx4 v[20:23], v5, s[4:7], s34 offen sc1
    v_mov_b32 v24, 4
    v_mov_b32 v25, 1
    s_waitcnt vmcnt(0)
    s_barrier
    s_cmp_lg_u32 s24, 0
    s_cbranch_scc1 L_wa_z
    s_mov_b64 exec, 1
    buffer_atomic_add v25, v24, s[8:11], 0 offen
    s_mov_b64 exec, -1
L_wa_z:
    s_and_b32 s28, s25, 3
    s_lshr_b32 s29, s25, 2
    s_lshl_b32 s33, s24, 15
    s_mov_b32 s16, s64
    s_and_b32 s17, s65, 0xffff
    s_mov_b32 s18, 2097152
    s_mov_b32 s19, 0x20000
    s_lshl_b32 s37, s29, 3
    s_mov_b32 s38, 131072
    s_mov_b32 s39, 0
    s_lshl_b32 s36, s37, 15
    s_and_b32 s34, s24, 1
    s_lshl_b32 s34, s34, 3
    v_xor_b32 v14, s34, v0
    s_lshl_b32 s34, s24, 13
    s_add_u32 s35, s34, s36
    s_add_u32 s34, s34, s38
    v_xor_b32 v15, 0, v14
    v_lshlrev_b32 v15, 4, v15
    s_add_u32 m0, s34, 0
    s_nop 0
    buffer_load_dwordx4 v15, s[16:19], s35 offen lds
    v_xor_b32 v15, 1, v14
    v_lshlrev_b32 v15, 4, v15
    s_add_u32 m0, s34, 1024
    s_add_u32 s35, s35, 1024
    buffer_load_dwordx4 v15, s[16:19], s35 offen lds
    v_xor_b32 v15, 2, v14
    v_lshlrev_b32 v15, 4, v15
    s_add_u32 m0, s34, 2048
    s_add_u32 s35, s35, 1024
    buffer_load_dwordx4 v15, s[16:19], s35 offen lds
    v_xor_b32 v15, 3, v14
    v_lshlrev_b32 v15, 4, v15
    s_add_u32 m0, s34, 3072
    s_add_u32 s35, s35, 1024
    buffer_load_dwordx4 v15, s[16:19], s35 offen lds
    v_xor_b32 v15, 4, v14
    v_lshlrev_b32 v15, 4, v15
    s_add_u32 m0, s34, 4096
    s_add_u32 s35, s35, 1024
    buffer_load_dwordx4 v15, s[16:19], s35 offen lds
    v_xor_b32 v15, 5, v14
    v_lshlrev_b32 v15, 4, v15
    s_add_u32 m0, s34, 5120
    s_add_u32 s35, s35, 1024
    buffer_load_dwordx4 v15, s[16:19], s35 offen lds
    v_xor_b32 v15, 6, v14
    v_lshlrev_b32 v15, 4, v15
    s_add_u32 m0, s34, 6144
    s_add_u32 s35, s35, 1024
    buffer_load_dwordx4 v15, s[16:19], s35 offen lds
    v_xor_b32 v15, 7, v14
    v_lshlrev_b32 v15, 4, v15
    s_add_u32 m0, s34, 7168
    s_add_u32 s35, s35, 1024
    buffer_load_dwordx4 v15, s[16:19], s35 offen lds
    s_lshl_b32 s36, s28, 8
    v_bfe_u32 v14, v0, 5, 1
    v_mul_u32_u24 v19, 2, v14
    v_bfe_u32 v14, v0, 4, 1
    v_mul_u32_u24 v14, 1, v14
    v_add_u32 v19, v19, v14
    s_and_b32 s34, s24, 1
    s_mul_i32 s34, s34, 4
    s_lshr_b32 s35, s24, 1
    s_mul_i32 s35, s35, 32
    s_add_u32 s34, s34, s35
    v_add_u32 v19, s34, v19
    s_mov_b32 s34, 3072
    v_mul_lo_u32 v19, v19, s34
    v_lshrrev_b32 v14, 3, v0
    v_and_b32 v14, 6, v14
    v_xor_b32 v14, v14, v0
    v_and_b32 v14, 15, v14
    v_lshlrev_b32 v14, 4, v14
    v_add3_u32 v19, v19, v14, s36
    v_add_u32 v17, 1024, v19
    v_add_u32 v18, 2048, v19
    v_lshrrev_b32 v14, 2, v0
    v_lshlrev_b32 v2, 8, v14
    v_and_b32 v14, 7, v14
    v_lshl_add_u32 v2, v14, 5, v2
    v_and_b32 v14, 3, v0
    v_lshl_add_u32 v2, v14, 3, v2
    v_and_b32 v14, 15, v0
    v_lshrrev_b32 v15, 4, v0
    v_add_u32 v6, 0, v15
    v_xor_b32 v6, v6, v14
    v_lshlrev_b32 v6, 4, v6
    v_lshl_add_u32 v6, v14, 10, v6
    v_add_u32 v7, 4, v15
    v_xor_b32 v7, v7, v14
    v_lshlrev_b32 v7, 4, v7
    v_lshl_add_u32 v7, v14, 10, v7
    v_add_u32 v8, 8, v15
    v_xor_b32 v8, v8, v14
    v_lshlrev_b32 v8, 4, v8
    v_lshl_add_u32 v8, v14, 10, v8
    v_add_u32 v9, 12, v15
    v_xor_b32 v9, v9, v14
    v_lshlrev_b32 v9, 4, v9
    v_lshl_add_u32 v9, v14, 10, v9
    s_lshl_b32 s36, s24, 12
    s_add_u32 s36, s36, 0
    s_mov_b32 s12, s66
    s_and_b32 s13, s67, 0xffff
    s_mov_b32 s14, 1572864
    s_mov_b32 s15, 0x20000
    v_xor_b32 v3, 0x80, v17
    s_add_u32 m0, s36, 0
    s_mov_b32 s34, 0
    buffer_load_dwordx4 v17, s[12:15], s34 offen  lds
    s_add_u32 m0, s36, 1024
    s_mov_b32 s34, 24576
    buffer_load_dwordx4 v3, s[12:15], s34 offen  lds
    s_add_u32 m0, s36, 2048
    s_mov_b32 s34, 49152
    buffer_load_dwordx4 v17, s[12:15], s34 offen  lds
    s_add_u32 m0, s36, 3072
    s_mov_b32 s34, 73728
    buffer_load_dwordx4 v3, s[12:15], s34 offen  lds
    s_add_u32 m0, s36, 16384
    s_mov_b32 s34, 196608
    buffer_load_dwordx4 v17, s[12:15], s34 offen  lds
    s_add_u32 m0, s36, 17408
    s_mov_b32 s34, 221184
    buffer_load_dwordx4 v3, s[12:15], s34 offen  lds
    s_add_u32 m0, s36, 18432
    s_mov_b32 s34, 245760
    buffer_load_dwordx4 v17, s[12:15], s34 offen  lds
    s_add_u32 m0, s36, 19456
    s_mov_b32 s34, 270336
    buffer_load_dwordx4 v3, s[12:15], s34 offen  lds
    s_add_u32 m0, s36, 32768
    s_mov_b32 s34, 393216
    buffer_load_dwordx4 v17, s[12:15], s34 offen  lds
    s_add_u32 m0, s36, 33792
    s_mov_b32 s34, 417792
    buffer_load_dwordx4 v3, s[12:15], s34 offen  lds
    s_add_u32 m0, s36, 34816
    s_mov_b32 s34, 442368
    buffer_load_dwordx4 v17, s[12:15], s34 offen  lds
    s_add_u32 m0, s36, 35840
    s_mov_b32 s34, 466944
    buffer_load_dwordx4 v3, s[12:15], s34 offen  lds
    s_add_u32 m0, s36, 49152
    s_mov_b32 s34, 589824
    buffer_load_dwordx4 v17, s[12:15], s34 offen  lds
    s_add_u32 m0, s36, 50176
    s_mov_b32 s34, 614400
    buffer_load_dwordx4 v3, s[12:15], s34 offen  lds
    s_add_u32 m0, s36, 51200
    s_mov_b32 s34, 638976
    buffer_load_dwordx4 v17, s[12:15], s34 offen  lds
    s_add_u32 m0, s36, 52224
    s_mov_b32 s34, 663552
    buffer_load_dwordx4 v3, s[12:15], s34 offen  lds
    s_add_u32 m0, s36, 65536
    s_mov_b32 s34, 786432
    buffer_load_dwordx4 v17, s[12:15], s34 offen  lds
    s_add_u32 m0, s36, 66560
    s_mov_b32 s34, 811008
    buffer_load_dwordx4 v3, s[12:15], s34 offen  lds
    s_add_u32 m0, s36, 67584
    s_mov_b32 s34, 835584
    buffer_load_dwordx4 v17, s[12:15], s34 offen  lds
    s_add_u32 m0, s36, 68608
    s_mov_b32 s34, 860160
    buffer_load_dwordx4 v3, s[12:15], s34 offen  lds
    s_add_u32 m0, s36, 81920
    s_mov_b32 s34, 983040
    buffer_load_dwordx4 v17, s[12:15], s34 offen  lds
    s_add_u32 m0, s36, 82944
    s_mov_b32 s34, 1007616
    buffer_load_dwordx4 v3, s[12:15], s34 offen  lds
    s_add_u32 m0, s36, 83968
    s_mov_b32 s34, 1032192
    buffer_load_dwordx4 v17, s[12:15], s34 offen  lds
    s_add_u32 m0, s36, 84992
    s_mov_b32 s34, 1056768
    buffer_load_dwordx4 v3, s[12:15], s34 offen  lds
    s_add_u32 m0, s36, 98304
    s_mov_b32 s34, 1179648
    buffer_load_dwordx4 v17, s[12:15], s34 offen  lds
    s_add_u32 m0, s36, 99328
    s_mov_b32 s34, 1204224
    buffer_load_dwordx4 v3, s[12:15], s34 offen  lds
    s_add_u32 m0, s36, 100352
    s_mov_b32 s34, 1228800
    buffer_load_dwordx4 v17, s[12:15], s34 offen  lds
    s_add_u32 m0, s36, 101376
    s_mov_b32 s34, 1253376
    buffer_load_dwordx4 v3, s[12:15], s34 offen  lds
    s_add_u32 m0, s36, 114688
    s_mov_b32 s34, 1376256
    buffer_load_dwordx4 v17, s[12:15], s34 offen  lds
    s_add_u32 m0, s36, 115712
    s_mov_b32 s34, 1400832
    buffer_load_dwordx4 v3, s[12:15], s34 offen  lds
    s_add_u32 m0, s36, 116736
    s_mov_b32 s34, 1425408
    buffer_load_dwordx4 v17, s[12:15], s34 offen  lds
    s_add_u32 m0, s36, 117760
    s_mov_b32 s34, 1449984
    buffer_load_dwordx4 v3, s[12:15], s34 offen  lds
    s_waitcnt vmcnt(28)
    s_barrier
    s_lshl_b32 s34, s24, 6
    v_xor_b32 v14, s34, v2
    v_add_u32 v14, 0, v14
    v_xor_b32 v15, 32, v14
    ds_read_b64_tr_b16 a[0:1], v14 offset:0
    ds_read_b64_tr_b16 a[2:3], v14 offset:4096
    ds_read_b64_tr_b16 a[4:5], v14 offset:8192
    ds_read_b64_tr_b16 a[6:7], v14 offset:12288
    ds_read_b64_tr_b16 a[8:9], v15 offset:0
    ds_read_b64_tr_b16 a[10:11], v15 offset:4096
    ds_read_b64_tr_b16 a[12:13], v15 offset:8192
    ds_read_b64_tr_b16 a[14:15], v15 offset:12288
    s_waitcnt lgkmcnt(0)
    s_waitcnt vmcnt(24)
    s_barrier
    v_xor_b32 v3, 0x80, v18
    s_add_u32 m0, s36, 0
    s_mov_b32 s34, 0
    buffer_load_dwordx4 v18, s[12:15], s34 offen  lds
    s_add_u32 m0, s36, 1024
    s_mov_b32 s34, 24576
    buffer_load_dwordx4 v3, s[12:15], s34 offen  lds
    s_add_u32 m0, s36, 2048
    s_mov_b32 s34, 49152
    buffer_load_dwordx4 v18, s[12:15], s34 offen  lds
    s_add_u32 m0, s36, 3072
    s_mov_b32 s34, 73728
    buffer_load_dwordx4 v3, s[12:15], s34 offen  lds
    s_lshl_b32 s34, s24, 6
    v_xor_b32 v14, s34, v2
    v_add_u32 v14, 16384, v14
    v_xor_b32 v15, 32, v14
    ds_read_b64_tr_b16 a[16:17], v14 offset:0
    ds_read_b64_tr_b16 a[18:19], v14 offset:4096
    ds_read_b64_tr_b16 a[20:21], v14 offset:8192
    ds_read_b64_tr_b16 a[22:23], v14 offset:12288
    ds_read_b64_tr_b16 a[24:25], v15 offset:0
    ds_read_b64_tr_b16 a[26:27], v15 offset:4096
    ds_read_b64_tr_b16 a[28:29], v15 offset:8192
    ds_read_b64_tr_b16 a[30:31], v15 offset:12288
    s_waitcnt lgkmcnt(0)
    s_waitcnt vmcnt(24)
    s_barrier
    s_add_u32 m0, s36, 16384
    s_mov_b32 s34, 196608
    buffer_load_dwordx4 v18, s[12:15], s34 offen  lds
    s_add_u32 m0, s36, 17408
    s_mov_b32 s34, 221184
    buffer_load_dwordx4 v3, s[12:15], s34 offen  lds
    s_add_u32 m0, s36, 18432
    s_mov_b32 s34, 245760
    buffer_load_dwordx4 v18, s[12:15], s34 offen  lds
    s_add_u32 m0, s36, 19456
    s_mov_b32 s34, 270336
    buffer_load_dwordx4 v3, s[12:15], s34 offen  lds
    s_lshl_b32 s34, s24, 6
    v_xor_b32 v14, s34, v2
    v_add_u32 v14, 32768, v14
    v_xor_b32 v15, 32, v14
    ds_read_b64_tr_b16 a[32:33], v14 offset:0
    ds_read_b64_tr_b16 a[34:35], v14 offset:4096
    ds_read_b64_tr_b16 a[36:37], v14 offset:8192
    ds_read_b64_tr_b16 a[38:39], v14 offset:12288
    ds_read_b64_tr_b16 a[40:41], v15 offset:0
    ds_read_b64_tr_b16 a[42:43], v15 offset:4096
    ds_read_b64_tr_b16 a[44:45], v15 offset:8192
    ds_read_b64_tr_b16 a[46:47], v15 offset:12288
    s_waitcnt lgkmcnt(0)
    s_waitcnt vmcnt(24)
    s_barrier
    s_add_u32 m0, s36, 32768
    s_mov_b32 s34, 393216
    buffer_load_dwordx4 v18, s[12:15], s34 offen  lds
    s_add_u32 m0, s36, 33792
    s_mov_b32 s34, 417792
    buffer_load_dwordx4 v3, s[12:15], s34 offen  lds
    s_add_u32 m0, s36, 34816
    s_mov_b32 s34, 442368
    buffer_load_dwordx4 v18, s[12:15], s34 offen  lds
    s_add_u32 m0, s36, 35840
    s_mov_b32 s34, 466944
    buffer_load_dwordx4 v3, s[12:15], s34 offen  lds
    s_lshl_b32 s34, s24, 6
    v_xor_b32 v14, s34, v2
    v_add_u32 v14, 49152, v14
    v_xor_b32 v15, 32, v14
    ds_read_b64_tr_b16 a[48:49], v14 offset:0
    ds_read_b64_tr_b16 a[50:51], v14 offset:4096
    ds_read_b64_tr_b16 a[52:53], v14 offset:8192
    ds_read_b64_tr_b16 a[54:55], v14 offset:12288
    ds_read_b64_tr_b16 a[56:57], v15 offset:0
    ds_read_b64_tr_b16 a[58:59], v15 offset:4096
    ds_read_b64_tr_b16 a[60:61], v15 offset:8192
    ds_read_b64_tr_b16 a[62:63], v15 offset:12288
    s_waitcnt lgkmcnt(0)
    s_waitcnt vmcnt(24)
    s_barrier
    s_add_u32 m0, s36, 49152
    s_mov_b32 s34, 589824
    buffer_load_dwordx4 v18, s[12:15], s34 offen  lds
    s_add_u32 m0, s36, 50176
    s_mov_b32 s34, 614400
    buffer_load_dwordx4 v3, s[12:15], s34 offen  lds
    s_add_u32 m0, s36, 51200
    s_mov_b32 s34, 638976
    buffer_load_dwordx4 v18, s[12:15], s34 offen  lds
    s_add_u32 m0, s36, 52224
    s_mov_b32 s34, 663552
    buffer_load_dwordx4 v3, s[12:15], s34 offen  lds
    s_lshl_b32 s34, s24, 6
    v_xor_b32 v14, s34, v2
    v_add_u32 v14, 65536, v14
    v_xor_b32 v15, 32, v14
    ds_read_b64_tr_b16 a[64:65], v14 offset:0
    ds_read_b64_tr_b16 a[66:67], v14 offset:4096
    ds_read_b64_tr_b16 a[68:69], v14 offset:8192
    ds_read_b64_tr_b16 a[70:71], v14 offset:12288
    ds_read_b64_tr_b16 a[72:73], v15 offset:0
    ds_read_b64_tr_b16 a[74:75], v15 offset:4096
    ds_read_b64_tr_b16 a[76:77], v15 offset:8192
    ds_read_b64_tr_b16 a[78:79], v15 offset:12288
    s_waitcnt lgkmcnt(0)
    s_waitcnt vmcnt(24)
    s_barrier
    s_add_u32 m0, s36, 65536
    s_mov_b32 s34, 786432
    buffer_load_dwordx4 v18, s[12:15], s34 offen  lds
    s_add_u32 m0, s36, 66560
    s_mov_b32 s34, 811008
    buffer_load_dwordx4 v3, s[12:15], s34 offen  lds
    s_add_u32 m0, s36, 67584
    s_mov_b32 s34, 835584
    buffer_load_dwordx4 v18, s[12:15], s34 offen  lds
    s_add_u32 m0, s36, 68608
    s_mov_b32 s34, 860160
    buffer_load_dwordx4 v3, s[12:15], s34 offen  lds
    s_lshl_b32 s34, s24, 6
    v_xor_b32 v14, s34, v2
    v_add_u32 v14, 81920, v14
    v_xor_b32 v15, 32, v14
    ds_read_b64_tr_b16 a[80:81], v14 offset:0
    ds_read_b64_tr_b16 a[82:83], v14 offset:4096
    ds_read_b64_tr_b16 a[84:85], v14 offset:8192
    ds_read_b64_tr_b16 a[86:87], v14 offset:12288
    ds_read_b64_tr_b16 a[88:89], v15 offset:0
    ds_read_b64_tr_b16 a[90:91], v15 offset:4096
    ds_read_b64_tr_b16 a[92:93], v15 offset:8192
    ds_read_b64_tr_b16 a[94:95], v15 offset:12288
    s_waitcnt lgkmcnt(0)
    s_waitcnt vmcnt(24)
    s_barrier
    s_add_u32 m0, s36, 81920
    s_mov_b32 s34, 983040
    buffer_load_dwordx4 v18, s[12:15], s34 offen  lds
    s_add_u32 m0, s36, 82944
    s_mov_b32 s34, 1007616
    buffer_load_dwordx4 v3, s[12:15], s34 offen  lds
    s_add_u32 m0, s36, 83968
    s_mov_b32 s34, 1032192
    buffer_load_dwordx4 v18, s[12:15], s34 offen  lds
    s_add_u32 m0, s36, 84992
    s_mov_b32 s34, 1056768
    buffer_load_dwordx4 v3, s[12:15], s34 offen  lds
    s_lshl_b32 s34, s24, 6
    v_xor_b32 v14, s34, v2
    v_add_u32 v14, 98304, v14
    v_xor_b32 v15, 32, v14
    ds_read_b64_tr_b16 a[96:97], v14 offset:0
    ds_read_b64_tr_b16 a[98:99], v14 offset:4096
    ds_read_b64_tr_b16 a[100:101], v14 offset:8192
    ds_read_b64_tr_b16 a[102:103], v14 offset:12288
    ds_read_b64_tr_b16 a[104:105], v15 offset:0
    ds_read_b64_tr_b16 a[106:107], v15 offset:4096
    ds_read_b64_tr_b16 a[108:109], v15 offset:8192
    ds_read_b64_tr_b16 a[110:111], v15 offset:12288
    s_waitcnt lgkmcnt(0)
    s_waitcnt vmcnt(24)
    s_barrier
    s_add_u32 m0, s36, 98304
    s_mov_b32 s34, 1179648
    buffer_load_dwordx4 v18, s[12:15], s34 offen  lds
    s_add_u32 m0, s36, 99328
    s_mov_b32 s34, 1204224
    buffer_load_dwordx4 v3, s[12:15], s34 offen  lds
    s_add_u32 m0, s36, 100352
    s_mov_b32 s34, 1228800
    buffer_load_dwordx4 v18, s[12:15], s34 offen  lds
    s_add_u32 m0, s36, 101376
    s_mov_b32 s34, 1253376
    buffer_load_dwordx4 v3, s[12:15], s34 offen  lds
    s_lshl_b32 s34, s24, 6
    v_xor_b32 v14, s34, v2
    v_add_u32 v14, 114688, v14
    v_xor_b32 v15, 32, v14
    ds_read_b64_tr_b16 a[112:113], v14 offset:0
    ds_read_b64_tr_b16 a[114:115], v14 offset:4096
    ds_read_b64_tr_b16 a[116:117], v14 offset:8192
    ds_read_b64_tr_b16 a[118:119], v14 offset:12288
    ds_read_b64_tr_b16 a[120:121], v15 offset:0
    ds_read_b64_tr_b16 a[122:123], v15 offset:4096
    ds_read_b64_tr_b16 a[124:125], v15 offset:8192
    ds_read_b64_tr_b16 a[126:127], v15 offset:12288
    s_waitcnt lgkmcnt(0)
    s_waitcnt vmcnt(24)
    s_barrier
    s_add_u32 m0, s36, 114688
    s_mov_b32 s34, 1376256
    buffer_load_dwordx4 v18, s[12:15], s34 offen  lds
    s_add_u32 m0, s36, 115712
    s_mov_b32 s34, 1400832
    buffer_load_dwordx4 v3, s[12:15], s34 offen  lds
    s_add_u32 m0, s36, 116736
    s_mov_b32 s34, 1425408
    buffer_load_dwordx4 v18, s[12:15], s34 offen  lds
    s_add_u32 m0, s36, 117760
    s_mov_b32 s34, 1449984
    buffer_load_dwordx4 v3, s[12:15], s34 offen  lds
    s_lshl_b32 s34, s24, 6
    v_xor_b32 v14, s34, v2
    v_add_u32 v14, 0, v14
    v_xor_b32 v15, 32, v14
    ds_read_b64_tr_b16 a[128:129], v14 offset:0
    ds_read_b64_tr_b16 a[130:131], v14 offset:4096
    ds_read_b64_tr_b16 a[132:133], v14 offset:8192
    ds_read_b64_tr_b16 a[134:135], v14 offset:12288
    ds_read_b64_tr_b16 a[136:137], v15 offset:0
    ds_read_b64_tr_b16 a[138:139], v15 offset:4096
    ds_read_b64_tr_b16 a[140:141], v15 offset:8192
    ds_read_b64_tr_b16 a[142:143], v15 offset:12288
    s_waitcnt lgkmcnt(0)
    s_waitcnt vmcnt(24)
    s_barrier
    v_xor_b32 v3, 0x80, v19
    s_add_u32 m0, s36, 0
    s_mov_b32 s34, 0
    buffer_load_dwordx4 v19, s[12:15], s34 offen  lds
    s_add_u32 m0, s36, 1024
    s_mov_b32 s34, 24576
    buffer_load_dwordx4 v3, s[12:15], s34 offen  lds
    s_add_u32 m0, s36, 2048
    s_mov_b32 s34, 49152
    buffer_load_dwordx4 v19, s[12:15], s34 offen  lds
    s_add_u32 m0, s36, 3072
    s_mov_b32 s34, 73728
    buffer_load_dwordx4 v3, s[12:15], s34 offen  lds
    s_lshl_b32 s34, s24, 6
    v_xor_b32 v14, s34, v2
    v_add_u32 v14, 16384, v14
    v_xor_b32 v15, 32, v14
    ds_read_b64_tr_b16 a[144:145], v14 offset:0
    ds_read_b64_tr_b16 a[146:147], v14 offset:4096
    ds_read_b64_tr_b16 a[148:149], v14 offset:8192
    ds_read_b64_tr_b16 a[150:151], v14 offset:12288
    ds_read_b64_tr_b16 a[152:153], v15 offset:0
    ds_read_b64_tr_b16 a[154:155], v15 offset:4096
    ds_read_b64_tr_b16 a[156:157], v15 offset:8192
    ds_read_b64_tr_b16 a[158:159], v15 offset:12288
    s_waitcnt lgkmcnt(0)
    s_waitcnt vmcnt(24)
    s_barrier
    s_add_u32 m0, s36, 16384
    s_mov_b32 s34, 196608
    buffer_load_dwordx4 v19, s[12:15], s34 offen  lds
    s_add_u32 m0, s36, 17408
    s_mov_b32 s34, 221184
    buffer_load_dwordx4 v3, s[12:15], s34 offen  lds
    s_add_u32 m0, s36, 18432
    s_mov_b32 s34, 245760
    buffer_load_dwordx4 v19, s[12:15], s34 offen  lds
    s_add_u32 m0, s36, 19456
    s_mov_b32 s34, 270336
    buffer_load_dwordx4 v3, s[12:15], s34 offen  lds
    s_lshl_b32 s34, s24, 6
    v_xor_b32 v14, s34, v2
    v_add_u32 v14, 32768, v14
    v_xor_b32 v15, 32, v14
    ds_read_b64_tr_b16 a[160:161], v14 offset:0
    ds_read_b64_tr_b16 a[162:163], v14 offset:4096
    ds_read_b64_tr_b16 a[164:165], v14 offset:8192
    ds_read_b64_tr_b16 a[166:167], v14 offset:12288
    ds_read_b64_tr_b16 a[168:169], v15 offset:0
    ds_read_b64_tr_b16 a[170:171], v15 offset:4096
    ds_read_b64_tr_b16 a[172:173], v15 offset:8192
    ds_read_b64_tr_b16 a[174:175], v15 offset:12288
    s_waitcnt lgkmcnt(0)
    s_waitcnt vmcnt(24)
    s_barrier
    s_add_u32 m0, s36, 32768
    s_mov_b32 s34, 393216
    buffer_load_dwordx4 v19, s[12:15], s34 offen  lds
    s_add_u32 m0, s36, 33792
    s_mov_b32 s34, 417792
    buffer_load_dwordx4 v3, s[12:15], s34 offen  lds
    s_add_u32 m0, s36, 34816
    s_mov_b32 s34, 442368
    buffer_load_dwordx4 v19, s[12:15], s34 offen  lds
    s_add_u32 m0, s36, 35840
    s_mov_b32 s34, 466944
    buffer_load_dwordx4 v3, s[12:15], s34 offen  lds
    s_lshl_b32 s34, s24, 6
    v_xor_b32 v14, s34, v2
    v_add_u32 v14, 49152, v14
    v_xor_b32 v15, 32, v14
    ds_read_b64_tr_b16 a[176:177], v14 offset:0
    ds_read_b64_tr_b16 a[178:179], v14 offset:4096
    ds_read_b64_tr_b16 a[180:181], v14 offset:8192
    ds_read_b64_tr_b16 a[182:183], v14 offset:12288
    ds_read_b64_tr_b16 a[184:185], v15 offset:0
    ds_read_b64_tr_b16 a[186:187], v15 offset:4096
    ds_read_b64_tr_b16 a[188:189], v15 offset:8192
    ds_read_b64_tr_b16 a[190:191], v15 offset:12288
    s_waitcnt lgkmcnt(0)
    s_waitcnt vmcnt(24)
    s_barrier
    s_add_u32 m0, s36, 49152
    s_mov_b32 s34, 589824
    buffer_load_dwordx4 v19, s[12:15], s34 offen  lds
    s_add_u32 m0, s36, 50176
    s_mov_b32 s34, 614400
    buffer_load_dwordx4 v3, s[12:15], s34 offen  lds
    s_add_u32 m0, s36, 51200
    s_mov_b32 s34, 638976
    buffer_load_dwordx4 v19, s[12:15], s34 offen  lds
    s_add_u32 m0, s36, 52224
    s_mov_b32 s34, 663552
    buffer_load_dwordx4 v3, s[12:15], s34 offen  lds
    s_lshl_b32 s34, s24, 6
    v_xor_b32 v14, s34, v2
    v_add_u32 v14, 65536, v14
    v_xor_b32 v15, 32, v14
    ds_read_b64_tr_b16 a[192:193], v14 offset:0
    ds_read_b64_tr_b16 a[194:195], v14 offset:4096
    ds_read_b64_tr_b16 a[196:197], v14 offset:8192
    ds_read_b64_tr_b16 a[198:199], v14 offset:12288
    ds_read_b64_tr_b16 a[200:201], v15 offset:0
    ds_read_b64_tr_b16 a[202:203], v15 offset:4096
    ds_read_b64_tr_b16 a[204:205], v15 offset:8192
    ds_read_b64_tr_b16 a[206:207], v15 offset:12288
    s_waitcnt lgkmcnt(0)
    s_waitcnt vmcnt(24)
    s_barrier
    s_add_u32 m0, s36, 65536
    s_mov_b32 s34, 786432
    buffer_load_dwordx4 v19, s[12:15], s34 offen  lds
    s_add_u32 m0, s36, 66560
    s_mov_b32 s34, 811008
    buffer_load_dwordx4 v3, s[12:15], s34 offen  lds
    s_add_u32 m0, s36, 67584
    s_mov_b32 s34, 835584
    buffer_load_dwordx4 v19, s[12:15], s34 offen  lds
    s_add_u32 m0, s36, 68608
    s_mov_b32 s34, 860160
    buffer_load_dwordx4 v3, s[12:15], s34 offen  lds
    s_lshl_b32 s34, s24, 6
    v_xor_b32 v14, s34, v2
    v_add_u32 v14, 81920, v14
    v_xor_b32 v15, 32, v14
    ds_read_b64_tr_b16 a[208:209], v14 offset:0
    ds_read_b64_tr_b16 a[210:211], v14 offset:4096
    ds_read_b64_tr_b16 a[212:213], v14 offset:8192
    ds_read_b64_tr_b16 a[214:215], v14 offset:12288
    ds_read_b64_tr_b16 a[216:217], v15 offset:0
    ds_read_b64_tr_b16 a[218:219], v15 offset:4096
    ds_read_b64_tr_b16 a[220:221], v15 offset:8192
    ds_read_b64_tr_b16 a[222:223], v15 offset:12288
    s_waitcnt lgkmcnt(0)
    s_waitcnt vmcnt(24)
    s_barrier
    s_add_u32 m0, s36, 81920
    s_mov_b32 s34, 983040
    buffer_load_dwordx4 v19, s[12:15], s34 offen  lds
    s_add_u32 m0, s36, 82944
    s_mov_b32 s34, 1007616
    buffer_load_dwordx4 v3, s[12:15], s34 offen  lds
    s_add_u32 m0, s36, 83968
    s_mov_b32 s34, 1032192
    buffer_load_dwordx4 v19, s[12:15], s34 offen  lds
    s_add_u32 m0, s36, 84992
    s_mov_b32 s34, 1056768
    buffer_load_dwordx4 v3, s[12:15], s34 offen  lds
    s_lshl_b32 s34, s24, 6
    v_xor_b32 v14, s34, v2
    v_add_u32 v14, 98304, v14
    v_xor_b32 v15, 32, v14
    ds_read_b64_tr_b16 a[224:225], v14 offset:0
    ds_read_b64_tr_b16 a[226:227], v14 offset:4096
    ds_read_b64_tr_b16 a[228:229], v14 offset:8192
    ds_read_b64_tr_b16 a[230:231], v14 offset:12288
    ds_read_b64_tr_b16 a[232:233], v15 offset:0
    ds_read_b64_tr_b16 a[234:235], v15 offset:4096
    ds_read_b64_tr_b16 a[236:237], v15 offset:8192
    ds_read_b64_tr_b16 a[238:239], v15 offset:12288
    s_waitcnt lgkmcnt(0)
    s_waitcnt vmcnt(24)
    s_barrier
    s_add_u32 m0, s36, 98304
    s_mov_b32 s34, 1179648
    buffer_load_dwordx4 v19, s[12:15], s34 offen  lds
    s_add_u32 m0, s36, 99328
    s_mov_b32 s34, 1204224
    buffer_load_dwordx4 v3, s[12:15], s34 offen  lds
    s_add_u32 m0, s36, 100352
    s_mov_b32 s34, 1228800
    buffer_load_dwordx4 v19, s[12:15], s34 offen  lds
    s_add_u32 m0, s36, 101376
    s_mov_b32 s34, 1253376
    buffer_load_dwordx4 v3, s[12:15], s34 offen  lds
    s_lshl_b32 s34, s24, 6
    v_xor_b32 v14, s34, v2
    v_add_u32 v14, 114688, v14
    v_xor_b32 v15, 32, v14
    ds_read_b64_tr_b16 a[240:241], v14 offset:0
    ds_read_b64_tr_b16 a[242:243], v14 offset:4096
    ds_read_b64_tr_b16 a[244:245], v14 offset:8192
    ds_read_b64_tr_b16 a[246:247], v14 offset:12288
    ds_read_b64_tr_b16 a[248:249], v15 offset:0
    ds_read_b64_tr_b16 a[250:251], v15 offset:4096
    ds_read_b64_tr_b16 a[252:253], v15 offset:8192
    ds_read_b64_tr_b16 a[254:255], v15 offset:12288
    s_waitcnt lgkmcnt(0)
    s_waitcnt vmcnt(24)
    s_barrier
    s_add_u32 m0, s36, 114688
    s_mov_b32 s34, 1376256
    buffer_load_dwordx4 v19, s[12:15], s34 offen  lds
    s_add_u32 m0, s36, 115712
    s_mov_b32 s34, 1400832
    buffer_load_dwordx4 v3, s[12:15], s34 offen  lds
    s_add_u32 m0, s36, 116736
    s_mov_b32 s34, 1425408
    buffer_load_dwordx4 v19, s[12:15], s34 offen  lds
    s_add_u32 m0, s36, 117760
    s_mov_b32 s34, 1449984
    buffer_load_dwordx4 v3, s[12:15], s34 offen  lds
    s_lshl_b32 s34, s24, 6
    v_xor_b32 v14, s34, v2
    v_add_u32 v14, 0, v14
    v_xor_b32 v15, 32, v14
    ds_read_b64_tr_b16 v[128:129], v14 offset:0
    ds_read_b64_tr_b16 v[130:131], v14 offset:4096
    ds_read_b64_tr_b16 v[132:133], v14 offset:8192
    ds_read_b64_tr_b16 v[134:135], v14 offset:12288
    ds_read_b64_tr_b16 v[136:137], v15 offset:0
    ds_read_b64_tr_b16 v[138:139], v15 offset:4096
    ds_read_b64_tr_b16 v[140:141], v15 offset:8192
    ds_read_b64_tr_b16 v[142:143], v15 offset:12288
    s_waitcnt lgkmcnt(0)
    s_waitcnt vmcnt(24)
    s_barrier
    s_lshl_b32 s34, s24, 6
    v_xor_b32 v14, s34, v2
    v_add_u32 v14, 16384, v14
    v_xor_b32 v15, 32, v14
    ds_read_b64_tr_b16 v[144:145], v14 offset:0
    ds_read_b64_tr_b16 v[146:147], v14 offset:4096
    ds_read_b64_tr_b16 v[148:149], v14 offset:8192
    ds_read_b64_tr_b16 v[150:151], v14 offset:12288
    ds_read_b64_tr_b16 v[152:153], v15 offset:0
    ds_read_b64_tr_b16 v[154:155], v15 offset:4096
    ds_read_b64_tr_b16 v[156:157], v15 offset:8192
    ds_read_b64_tr_b16 v[158:159], v15 offset:12288
    s_waitcnt lgkmcnt(0)
    s_waitcnt vmcnt(20)
    s_barrier
    s_lshl_b32 s34, s24, 6
    v_xor_b32 v14, s34, v2
    v_add_u32 v14, 32768, v14
    v_xor_b32 v15, 32, v14
    ds_read_b64_tr_b16 v[160:161], v14 offset:0
    ds_read_b64_tr_b16 v[162:163], v14 offset:4096
    ds_read_b64_tr_b16 v[164:165], v14 offset:8192
    ds_read_b64_tr_b16 v[166:167], v14 offset:12288
    ds_read_b64_tr_b16 v[168:169], v15 offset:0
    ds_read_b64_tr_b16 v[170:171], v15 offset:4096
    ds_read_b64_tr_b16 v[172:173], v15 offset:8192
    ds_read_b64_tr_b16 v[174:175], v15 offset:12288
    s_waitcnt lgkmcnt(0)
    s_waitcnt vmcnt(16)
    s_barrier
    s_lshl_b32 s34, s24, 6
    v_xor_b32 v14, s34, v2
    v_add_u32 v14, 49152, v14
    v_xor_b32 v15, 32, v14
    ds_read_b64_tr_b16 v[176:177], v14 offset:0
    ds_read_b64_tr_b16 v[178:179], v14 offset:4096
    ds_read_b64_tr_b16 v[180:181], v14 offset:8192
    ds_read_b64_tr_b16 v[182:183], v14 offset:12288
    ds_read_b64_tr_b16 v[184:185], v15 offset:0
    ds_read_b64_tr_b16 v[186:187], v15 offset:4096
    ds_read_b64_tr_b16 v[188:189], v15 offset:8192
    ds_read_b64_tr_b16 v[190:191], v15 offset:12288
    s_waitcnt lgkmcnt(0)
    s_waitcnt vmcnt(12)
    s_barrier
    s_lshl_b32 s34, s24, 6
    v_xor_b32 v14, s34, v2
    v_add_u32 v14, 65536, v14
    v_xor_b32 v15, 32, v14
    ds_read_b64_tr_b16 v[192:193], v14 offset:0
    ds_read_b64_tr_b16 v[194:195], v14 offset:4096
    ds_read_b64_tr_b16 v[196:197], v14 offset:8192
    ds_read_b64_tr_b16 v[198:199], v14 offset:12288
    ds_read_b64_tr_b16 v[200:201], v15 offset:0
    ds_read_b64_tr_b16 v[202:203], v15 offset:4096
    ds_read_b64_tr_b16 v[204:205], v15 offset:8192
    ds_read_b64_tr_b16 v[206:207], v15 offset:12288
    s_waitcnt lgkmcnt(0)
    s_waitcnt vmcnt(8)
    s_barrier
    s_lshl_b32 s34, s24, 6
    v_xor_b32 v14, s34, v2
    v_add_u32 v14, 81920, v14
    v_xor_b32 v15, 32, v14
    ds_read_b64_tr_b16 v[208:209], v14 offset:0
    ds_read_b64_tr_b16 v[210:211], v14 offset:4096
    ds_read_b64_tr_b16 v[212:213], v14 offset:8192
    ds_read_b64_tr_b16 v[214:215], v14 offset:12288
    ds_read_b64_tr_b16 v[216:217], v15 offset:0
    ds_read_b64_tr_b16 v[218:219], v15 offset:4096
    ds_read_b64_tr_b16 v[220:221], v15 offset:8192
    ds_read_b64_tr_b16 v[222:223], v15 offset:12288
    s_waitcnt lgkmcnt(0)
    s_waitcnt vmcnt(4)
    s_barrier
    s_lshl_b32 s34, s24, 6
    v_xor_b32 v14, s34, v2
    v_add_u32 v14, 98304, v14
    v_xor_b32 v15, 32, v14
    ds_read_b64_tr_b16 v[224:225], v14 offset:0
    ds_read_b64_tr_b16 v[226:227], v14 offset:4096
    ds_read_b64_tr_b16 v[228:229], v14 offset:8192
    ds_read_b64_tr_b16 v[230:231], v14 offset:12288
    ds_read_b64_tr_b16 v[232:233], v15 offset:0
    ds_read_b64_tr_b16 v[234:235], v15 offset:4096
    ds_read_b64_tr_b16 v[236:237], v15 offset:8192
    ds_read_b64_tr_b16 v[238:239], v15 offset:12288
    s_waitcnt lgkmcnt(0)
    s_waitcnt vmcnt(0)
    s_barrier
    s_lshl_b32 s34, s24, 6
    v_xor_b32 v14, s34, v2
    v_add_u32 v14, 114688, v14
    v_xor_b32 v15, 32, v14
    ds_read_b64_tr_b16 v[240:241], v14 offset:0
    ds_read_b64_tr_b16 v[242:243], v14 offset:4096
    ds_read_b64_tr_b16 v[244:245], v14 offset:8192
    ds_read_b64_tr_b16 v[246:247], v14 offset:12288
    ds_read_b64_tr_b16 v[248:249], v15 offset:0
    ds_read_b64_tr_b16 v[250:251], v15 offset:4096
    ds_read_b64_tr_b16 v[252:253], v15 offset:8192
    ds_read_b64_tr_b16 v[254:255], v15 offset:12288
    s_waitcnt lgkmcnt(0)
    s_lshl_b32 s40, s25, 16
    s_lshl_b32 s34, s24, 11
    s_add_u32 s40, s40, s34
    s_add_u32 s40, s40, 2097152
    s_mov_b32 s42, 1069066811
    s_mov_b32 s43, 897988541
    v_mov_b32 v112, 0
    v_mov_b32 v113, 0
    v_mov_b32 v114, 0
    v_mov_b32 v115, 0
    v_mov_b32 v116, 0
    v_mov_b32 v117, 0
    v_mov_b32 v118, 0
    v_mov_b32 v119, 0
    v_mov_b32 v120, 0
    v_mov_b32 v121, 0
    v_mov_b32 v122, 0
    v_mov_b32 v123, 0
    v_mov_b32 v124, 0
    v_mov_b32 v125, 0
    v_mov_b32 v126, 0
    v_mov_b32 v127, 0
    v_mov_b32 v20, 0x3f803f80
    v_mov_b32 v21, 0x3f803f80
    v_mov_b32 v22, 0x3f803f80
    v_mov_b32 v23, 0x3f803f80
    s_mov_b32 s41, 0
L_wa_p1:
    s_waitcnt vmcnt(0)
    s_barrier
    s_cmp_ge_u32 s41, 7
    s_cbranch_scc1 L_wa_nopf
    s_add_u32 s36, s37, 1
    s_lshl_b32 s36, s36, 15
    s_and_b32 s34, s24, 1
    s_lshl_b32 s34, s34, 3
    v_xor_b32 v14, s34, v0
    s_lshl_b32 s34, s24, 13
    s_add_u32 s35, s34, s36
    s_add_u32 s34, s34, s39
    v_xor_b32 v15, 0, v14
    v_lshlrev_b32 v15, 4, v15
    s_add_u32 m0, s34, 0
    s_nop 0
    buffer_load_dwordx4 v15, s[16:19], s35 offen lds
    v_xor_b32 v15, 1, v14
    v_lshlrev_b32 v15, 4, v15
    s_add_u32 m0, s34, 1024
    s_add_u32 s35, s35, 1024
    buffer_load_dwordx4 v15, s[16:19], s35 offen lds
    v_xor_b32 v15, 2, v14
    v_lshlrev_b32 v15, 4, v15
    s_add_u32 m0, s34, 2048
    s_add_u32 s35, s35, 1024
    buffer_load_dwordx4 v15, s[16:19], s35 offen lds
    v_xor_b32 v15, 3, v14
    v_lshlrev_b32 v15, 4, v15
    s_add_u32 m0, s34, 3072
    s_add_u32 s35, s35, 1024
    buffer_load_dwordx4 v15, s[16:19], s35 offen lds
    v_xor_b32 v15, 4, v14
    v_lshlrev_b32 v15, 4, v15
    s_add_u32 m0, s34, 4096
    s_add_u32 s35, s35, 1024
    buffer_load_dwordx4 v15, s[16:19], s35 offen lds
    v_xor_b32 v15, 5, v14
    v_lshlrev_b32 v15, 4, v15
    s_add_u32 m0, s34, 5120
    s_add_u32 s35, s35, 1024
    buffer_load_dwordx4 v15, s[16:19], s35 offen lds
    v_xor_b32 v15, 6, v14
    v_lshlrev_b32 v15, 4, v15
    s_add_u32 m0, s34, 6144
    s_add_u32 s35, s35, 1024
    buffer_load_dwordx4 v15, s[16:19], s35 offen lds
    v_xor_b32 v15, 7, v14
    v_lshlrev_b32 v15, 4, v15
    s_add_u32 m0, s34, 7168
    s_add_u32 s35, s35, 1024
    buffer_load_dwordx4 v15, s[16:19], s35 offen lds
L_wa_nopf:
    v_add_u32 v10, s38, v6
    v_add_u32 v11, s38, v7
    v_add_u32 v12, s38, v8
    v_add_u32 v13, s38, v9
    ds_read_b128 v[32:35], v10 offset:0
    ds_read_b128 v[36:39], v10 offset:16384
    ds_read_b128 v[40:43], v11 offset:0
    s_waitcnt lgkmcnt(2)
    v_mfma_f32_16x16x32_bf16 v[64:67], v[128:131], v[32:35], 0
    v_mfma_f32_16x16x32_bf16 v[68:71], v[136:139], v[32:35], 0
    ds_read_b128 v[44:47], v11 offset:16384
    v_mfma_f32_16x16x32_bf16 v[80:83], v[32:35], a[0:3], 0
    v_mfma_f32_16x16x32_bf16 v[88:91], v[32:35], a[8:11], 0
    v_mfma_f32_16x16x32_bf16 v[96:99], v[32:35], a[128:131], 0
    v_mfma_f32_16x16x32_bf16 v[104:107], v[32:35], a[136:139], 0
    s_waitcnt lgkmcnt(2)
    v_mfma_f32_16x16x32_bf16 v[72:75], v[128:131], v[36:39], 0
    v_mfma_f32_16x16x32_bf16 v[76:79], v[136:139], v[36:39], 0
    ds_read_b128 v[32:35], v12 offset:0
    v_mfma_f32_16x16x32_bf16 v[84:87], v[36:39], a[0:3], 0
    v_mfma_f32_16x16x32_bf16 v[92:95], v[36:39], a[8:11], 0
    v_mfma_f32_16x16x32_bf16 v[100:103], v[36:39], a[128:131], 0
    v_mfma_f32_16x16x32_bf16 v[108:111], v[36:39], a[136:139], 0
    s_waitcnt lgkmcnt(2)
    v_mfma_f32_16x16x32_bf16 v[64:67], v[132:135], v[40:43], v[64:67]
    v_mfma_f32_16x16x32_bf16 v[68:71], v[140:143], v[40:43], v[68:71]
    ds_read_b128 v[36:39], v12 offset:16384
    v_mfma_f32_16x16x32_bf16 v[80:83], v[40:43], a[4:7], v[80:83]
    v_mfma_f32_16x16x32_bf16 v[88:91], v[40:43], a[12:15], v[88:91]
    v_mfma_f32_16x16x32_bf16 v[96:99], v[40:43], a[132:135], v[96:99]
    v_mfma_f32_16x16x32_bf16 v[104:107], v[40:43], a[140:143], v[104:107]
    s_waitcnt lgkmcnt(2)
    v_mfma_f32_16x16x32_bf16 v[72:75], v[132:135], v[44:47], v[72:75]
    v_mfma_f32_16x16x32_bf16 v[76:79], v[140:143], v[44:47], v[76:79]
    ds_read_b128 v[40:43], v13 offset:0
    v_mfma_f32_16x16x32_bf16 v[84:87], v[44:47], a[4:7], v[84:87]
    v_mfma_f32_16x16x32_bf16 v[92:95], v[44:47], a[12:15], v[92:95]
    v_mfma_f32_16x16x32_bf16 v[100:103], v[44:47], a[132:135], v[100:103]
    v_mfma_f32_16x16x32_bf16 v[108:111], v[44:47], a[140:143], v[108:111]
    s_waitcnt lgkmcnt(2)
    v_mfma_f32_16x16x32_bf16 v[64:67], v[144:147], v[32:35], v[64:67]
    v_mfma_f32_16x16x32_bf16 v[68:71], v[152:155], v[32:35], v[68:71]
    ds_read_b128 v[44:47], v13 offset:16384
    v_mfma_f32_16x16x32_bf16 v[80:83], v[32:35], a[16:19], v[80:83]
    v_mfma_f32_16x16x32_bf16 v[88:91], v[32:35], a[24:27], v[88:91]
    v_mfma_f32_16x16x32_bf16 v[96:99], v[32:35], a[144:147], v[96:99]
    v_mfma_f32_16x16x32_bf16 v[104:107], v[32:35], a[152:155], v[104:107]
    s_waitcnt lgkmcnt(2)
    v_mfma_f32_16x16x32_bf16 v[72:75], v[144:147], v[36:39], v[72:75]
    v_mfma_f32_16x16x32_bf16 v[76:79], v[152:155], v[36:39], v[76:79]
    ds_read_b128 v[32:35], v10 offset:256
    v_mfma_f32_16x16x32_bf16 v[84:87], v[36:39], a[16:19], v[84:87]
    v_mfma_f32_16x16x32_bf16 v[92:95], v[36:39], a[24:27], v[92:95]
    v_mfma_f32_16x16x32_bf16 v[100:103], v[36:39], a[144:147], v[100:103]
    v_mfma_f32_16x16x32_bf16 v[108:111], v[36:39], a[152:155], v[108:111]
    s_waitcnt lgkmcnt(2)
    v_mfma_f32_16x16x32_bf16 v[64:67], v[148:151], v[40:43], v[64:67]
    v_mfma_f32_16x16x32_bf16 v[68:71], v[156:159], v[40:43], v[68:71]
    ds_read_b128 v[36:39], v10 offset:16640
    v_mfma_f32_16x16x32_bf16 v[80:83], v[40:43], a[20:23], v[80:83]
    v_mfma_f32_16x16x32_bf16 v[88:91], v[40:43], a[28:31], v[88:91]
    v_mfma_f32_16x16x32_bf16 v[96:99], v[40:43], a[148:151], v[96:99]
    v_mfma_f32_16x16x32_bf16 v[104:107], v[40:43], a[156:159], v[104:107]
    s_waitcnt lgkmcnt(2)
    v_mfma_f32_16x16x32_bf16 v[72:75], v[148:151], v[44:47], v[72:75]
    v_mfma_f32_16x16x32_bf16 v[76:79], v[156:159], v[44:47], v[76:79]
    ds_read_b128 v[40:43], v11 offset:256
    v_mfma_f32_16x16x32_bf16 v[84:87], v[44:47], a[20:23], v[84:87]
    v_mfma_f32_16x16x32_bf16 v[92:95], v[44:47], a[28:31], v[92:95]
    v_mfma_f32_16x16x32_bf16 v[100:103], v[44:47], a[148:151], v[100:103]
    v_mfma_f32_16x16x32_bf16 v[108:111], v[44:47], a[156:159], v[108:111]
    s_waitcnt lgkmcnt(2)
    v_mfma_f32_16x16x32_bf16 v[64:67], v[160:163], v[32:35], v[64:67]
    v_mfma_f32_16x16x32_bf16 v[68:71], v[168:171], v[32:35], v[68:71]
    ds_read_b128 v[44:47], v11 offset:16640
    v_mfma_f32_16x16x32_bf16 v[80:83], v[32:35], a[32:35], v[80:83]
    v_mfma_f32_16x16x32_bf16 v[88:91], v[32:35], a[40:43], v[88:91]
    v_mfma_f32_16x16x32_bf16 v[96:99], v[32:35], a[160:163], v[96:99]
    v_mfma_f32_16x16x32_bf16 v[104:107], v[32:35], a[168:171], v[104:107]
    s_waitcnt lgkmcnt(2)
    v_mfma_f32_16x16x32_bf16 v[72:75], v[160:163], v[36:39], v[72:75]
    v_mfma_f32_16x16x32_bf16 v[76:79], v[168:171], v[36:39], v[76:79]
    ds_read_b128 v[32:35], v12 offset:256
    v_mfma_f32_16x16x32_bf16 v[84:87], v[36:39], a[32:35], v[84:87]
    v_mfma_f32_16x16x32_bf16 v[92:95], v[36:39], a[40:43], v[92:95]
    v_mfma_f32_16x16x32_bf16 v[100:103], v[36:39], a[160:163], v[100:103]
    v_mfma_f32_16x16x32_bf16 v[108:111], v[36:39], a[168:171], v[108:111]
    s_waitcnt lgkmcnt(2)
    v_mfma_f32_16x16x32_bf16 v[64:67], v[164:167], v[40:43], v[64:67]
    v_mfma_f32_16x16x32_bf16 v[68:71], v[172:175], v[40:43], v[68:71]
    ds_read_b128 v[36:39], v12 offset:16640
    v_mfma_f32_16x16x32_bf16 v[80:83], v[40:43], a[36:39], v[80:83]
    v_mfma_f32_16x16x32_bf16 v[88:91], v[40:43], a[44:47], v[88:91]
    v_mfma_f32_16x16x32_bf16 v[96:99], v[40:43], a[164:167], v[96:99]
    v_mfma_f32_16x16x32_bf16 v[104:107], v[40:43], a[172:175], v[104:107]
    s_waitcnt lgkmcnt(2)
    v_mfma_f32_16x16x32_bf16 v[72:75], v[164:167], v[44:47], v[72:75]
    v_mfma_f32_16x16x32_bf16 v[76:79], v[172:175], v[44:47], v[76:79]
    ds_read_b128 v[40:43], v13 offset:256
    v_mfma_f32_16x16x32_bf16 v[84:87], v[44:47], a[36:39], v[84:87]
    v_mfma_f32_16x16x32_bf16 v[92:95], v[44:47], a[44:47], v[92:95]
    v_mfma_f32_16x16x32_bf16 v[100:103], v[44:47], a[164:167], v[100:103]
    v_mfma_f32_16x16x32_bf16 v[108:111], v[44:47], a[172:175], v[108:111]
    s_waitcnt lgkmcnt(2)
    v_mfma_f32_16x16x32_bf16 v[64:67], v[176:179], v[32:35], v[64:67]
    v_mfma_f32_16x16x32_bf16 v[68:71], v[184:187], v[32:35], v[68:71]
    ds_read_b128 v[44:47], v13 offset:16640
    v_mfma_f32_16x16x32_bf16 v[80:83], v[32:35], a[48:51], v[80:83]
    v_mfma_f32_16x16x32_bf16 v[88:91], v[32:35], a[56:59], v[88:91]
    v_mfma_f32_16x16x32_bf16 v[96:99], v[32:35], a[176:179], v[96:99]
    v_mfma_f32_16x16x32_bf16 v[104:107], v[32:35], a[184:187], v[104:107]
    s_waitcnt lgkmcnt(2)
    v_mfma_f32_16x16x32_bf16 v[72:75], v[176:179], v[36:39], v[72:75]
    v_mfma_f32_16x16x32_bf16 v[76:79], v[184:187], v[36:39], v[76:79]
    ds_read_b128 v[32:35], v10 offset:512
    v_mfma_f32_16x16x32_bf16 v[84:87], v[36:39], a[48:51], v[84:87]
    v_mfma_f32_16x16x32_bf16 v[92:95], v[36:39], a[56:59], v[92:95]
    v_mfma_f32_16x16x32_bf16 v[100:103], v[36:39], a[176:179], v[100:103]
    v_mfma_f32_16x16x32_bf16 v[108:111], v[36:39], a[184:187], v[108:111]
    s_waitcnt lgkmcnt(2)
    v_mfma_f32_16x16x32_bf16 v[64:67], v[180:183], v[40:43], v[64:67]
    v_mfma_f32_16x16x32_bf16 v[68:71], v[188:191], v[40:43], v[68:71]
    ds_read_b128 v[36:39], v10 offset:16896
    v_mfma_f32_16x16x32_bf16 v[80:83], v[40:43], a[52:55], v[80:83]
    v_mfma_f32_16x16x32_bf16 v[88:91], v[40:43], a[60:63], v[88:91]
    v_mfma_f32_16x16x32_bf16 v[96:99], v[40:43], a[180:183], v[96:99]
    v_mfma_f32_16x16x32_bf16 v[104:107], v[40:43], a[188:191], v[104:107]
    s_waitcnt lgkmcnt(2)
    v_mfma_f32_16x16x32_bf16 v[72:75], v[180:183], v[44:47], v[72:75]
    v_mfma_f32_16x16x32_bf16 v[76:79], v[188:191], v[44:47], v[76:79]
    ds_read_b128 v[40:43], v11 offset:512
    v_mfma_f32_16x16x32_bf16 v[84:87], v[44:47], a[52:55], v[84:87]
    v_mfma_f32_16x16x32_bf16 v[92:95], v[44:47], a[60:63], v[92:95]
    v_mfma_f32_16x16x32_bf16 v[100:103], v[44:47], a[180:183], v[100:103]
    v_mfma_f32_16x16x32_bf16 v[108:111], v[44:47], a[188:191], v[108:111]
    s_waitcnt lgkmcnt(2)
    v_mfma_f32_16x16x32_bf16 v[64:67], v[192:195], v[32:35], v[64:67]
    v_mfma_f32_16x16x32_bf16 v[68:71], v[200:203], v[32:35], v[68:71]
    ds_read_b128 v[44:47], v11 offset:16896
    v_mfma_f32_16x16x32_bf16 v[80:83], v[32:35], a[64:67], v[80:83]
    v_mfma_f32_16x16x32_bf16 v[88:91], v[32:35], a[72:75], v[88:91]
    v_mfma_f32_16x16x32_bf16 v[96:99], v[32:35], a[192:195], v[96:99]
    v_mfma_f32_16x16x32_bf16 v[104:107], v[32:35], a[200:203], v[104:107]
    s_waitcnt lgkmcnt(2)
    v_mfma_f32_16x16x32_bf16 v[72:75], v[192:195], v[36:39], v[72:75]
    v_mfma_f32_16x16x32_bf16 v[76:79], v[200:203], v[36:39], v[76:79]
    ds_read_b128 v[32:35], v12 offset:512
    v_mfma_f32_16x16x32_bf16 v[84:87], v[36:39], a[64:67], v[84:87]
    v_mfma_f32_16x16x32_bf16 v[92:95], v[36:39], a[72:75], v[92:95]
    v_mfma_f32_16x16x32_bf16 v[100:103], v[36:39], a[192:195], v[100:103]
    v_mfma_f32_16x16x32_bf16 v[108:111], v[36:39], a[200:203], v[108:111]
    s_waitcnt lgkmcnt(2)
    v_mfma_f32_16x16x32_bf16 v[64:67], v[196:199], v[40:43], v[64:67]
    v_mfma_f32_16x16x32_bf16 v[68:71], v[204:207], v[40:43], v[68:71]
    ds_read_b128 v[36:39], v12 offset:16896
    v_mfma_f32_16x16x32_bf16 v[80:83], v[40:43], a[68:71], v[80:83]
    v_mfma_f32_16x16x32_bf16 v[88:91], v[40:43], a[76:79], v[88:91]
    v_mfma_f32_16x16x32_bf16 v[96:99], v[40:43], a[196:199], v[96:99]
    v_mfma_f32_16x16x32_bf16 v[104:107], v[40:43], a[204:207], v[104:107]
    s_waitcnt lgkmcnt(2)
    v_mfma_f32_16x16x32_bf16 v[72:75], v[196:199], v[44:47], v[72:75]
    v_mfma_f32_16x16x32_bf16 v[76:79], v[204:207], v[44:47], v[76:79]
    ds_read_b128 v[40:43], v13 offset:512
    v_mfma_f32_16x16x32_bf16 v[84:87], v[44:47], a[68:71], v[84:87]
    v_mfma_f32_16x16x32_bf16 v[92:95], v[44:47], a[76:79], v[92:95]
    v_mfma_f32_16x16x32_bf16 v[100:103], v[44:47], a[196:199], v[100:103]
    v_mfma_f32_16x16x32_bf16 v[108:111], v[44:47], a[204:207], v[108:111]
    s_waitcnt lgkmcnt(2)
    v_mfma_f32_16x16x32_bf16 v[64:67], v[208:211], v[32:35], v[64:67]
    v_mfma_f32_16x16x32_bf16 v[68:71], v[216:219], v[32:35], v[68:71]
    ds_read_b128 v[44:47], v13 offset:16896
    v_mfma_f32_16x16x32_bf16 v[80:83], v[32:35], a[80:83], v[80:83]
    v_mfma_f32_16x16x32_bf16 v[88:91], v[32:35], a[88:91], v[88:91]
    v_mfma_f32_16x16x32_bf16 v[96:99], v[32:35], a[208:211], v[96:99]
    v_mfma_f32_16x16x32_bf16 v[104:107], v[32:35], a[216:219], v[104:107]
    s_waitcnt lgkmcnt(2)
    v_mfma_f32_16x16x32_bf16 v[72:75], v[208:211], v[36:39], v[72:75]
    v_mfma_f32_16x16x32_bf16 v[76:79], v[216:219], v[36:39], v[76:79]
    ds_read_b128 v[32:35], v10 offset:768
    v_mfma_f32_16x16x32_bf16 v[84:87], v[36:39], a[80:83], v[84:87]
    v_mfma_f32_16x16x32_bf16 v[92:95], v[36:39], a[88:91], v[92:95]
    v_mfma_f32_16x16x32_bf16 v[100:103], v[36:39], a[208:211], v[100:103]
    v_mfma_f32_16x16x32_bf16 v[108:111], v[36:39], a[216:219], v[108:111]
    s_waitcnt lgkmcnt(2)
    v_mfma_f32_16x16x32_bf16 v[64:67], v[212:215], v[40:43], v[64:67]
    v_mfma_f32_16x16x32_bf16 v[68:71], v[220:223], v[40:43], v[68:71]
    ds_read_b128 v[36:39], v10 offset:17152
    v_mfma_f32_16x16x32_bf16 v[80:83], v[40:43], a[84:87], v[80:83]
    v_mfma_f32_16x16x32_bf16 v[88:91], v[40:43], a[92:95], v[88:91]
    v_mfma_f32_16x16x32_bf16 v[96:99], v[40:43], a[212:215], v[96:99]
    v_mfma_f32_16x16x32_bf16 v[104:107], v[40:43], a[220:223], v[104:107]
    s_waitcnt lgkmcnt(2)
    v_mfma_f32_16x16x32_bf16 v[72:75], v[212:215], v[44:47], v[72:75]
    v_mfma_f32_16x16x32_bf16 v[76:79], v[220:223], v[44:47], v[76:79]
    ds_read_b128 v[40:43], v11 offset:768
    v_mfma_f32_16x16x32_bf16 v[84:87], v[44:47], a[84:87], v[84:87]
    v_mfma_f32_16x16x32_bf16 v[92:95], v[44:47], a[92:95], v[92:95]
    v_mfma_f32_16x16x32_bf16 v[100:103], v[44:47], a[212:215], v[100:103]
    v_mfma_f32_16x16x32_bf16 v[108:111], v[44:47], a[220:223], v[108:111]
    s_waitcnt lgkmcnt(2)
    v_mfma_f32_16x16x32_bf16 v[64:67], v[224:227], v[32:35], v[64:67]
    v_mfma_f32_16x16x32_bf16 v[68:71], v[232:235], v[32:35], v[68:71]
    ds_read_b128 v[44:47], v11 offset:17152
    v_mfma_f32_16x16x32_bf16 v[80:83], v[32:35], a[96:99], v[80:83]
    v_mfma_f32_16x16x32_bf16 v[88:91], v[32:35], a[104:107], v[88:91]
    v_mfma_f32_16x16x32_bf16 v[96:99], v[32:35], a[224:227], v[96:99]
    v_mfma_f32_16x16x32_bf16 v[104:107], v[32:35], a[232:235], v[104:107]
    s_waitcnt lgkmcnt(2)
    v_mfma_f32_16x16x32_bf16 v[72:75], v[224:227], v[36:39], v[72:75]
    v_mfma_f32_16x16x32_bf16 v[76:79], v[232:235], v[36:39], v[76:79]
    ds_read_b128 v[32:35], v12 offset:768
    v_mfma_f32_16x16x32_bf16 v[84:87], v[36:39], a[96:99], v[84:87]
    v_mfma_f32_16x16x32_bf16 v[92:95], v[36:39], a[104:107], v[92:95]
    v_mfma_f32_16x16x32_bf16 v[100:103], v[36:39], a[224:227], v[100:103]
    v_mfma_f32_16x16x32_bf16 v[108:111], v[36:39], a[232:235], v[108:111]
    s_waitcnt lgkmcnt(2)
    v_mfma_f32_16x16x32_bf16 v[64:67], v[228:231], v[40:43], v[64:67]
    v_mfma_f32_16x16x32_bf16 v[68:71], v[236:239], v[40:43], v[68:71]
    ds_read_b128 v[36:39], v12 offset:17152
    v_mfma_f32_16x16x32_bf16 v[80:83], v[40:43], a[100:103], v[80:83]
    v_mfma_f32_16x16x32_bf16 v[88:91], v[40:43], a[108:111], v[88:91]
    v_mfma_f32_16x16x32_bf16 v[96:99], v[40:43], a[228:231], v[96:99]
    v_mfma_f32_16x16x32_bf16 v[104:107], v[40:43], a[236:239], v[104:107]
    s_waitcnt lgkmcnt(2)
    v_mfma_f32_16x16x32_bf16 v[72:75], v[228:231], v[44:47], v[72:75]
    v_mfma_f32_16x16x32_bf16 v[76:79], v[236:239], v[44:47], v[76:79]
    ds_read_b128 v[40:43], v13 offset:768
    v_mfma_f32_16x16x32_bf16 v[84:87], v[44:47], a[100:103], v[84:87]
    v_mfma_f32_16x16x32_bf16 v[92:95], v[44:47], a[108:111], v[92:95]
    v_mfma_f32_16x16x32_bf16 v[100:103], v[44:47], a[228:231], v[100:103]
    v_mfma_f32_16x16x32_bf16 v[108:111], v[44:47], a[236:239], v[108:111]
    s_waitcnt lgkmcnt(2)
    v_mfma_f32_16x16x32_bf16 v[64:67], v[240:243], v[32:35], v[64:67]
    v_mfma_f32_16x16x32_bf16 v[68:71], v[248:251], v[32:35], v[68:71]
    ds_read_b128 v[44:47], v13 offset:17152
    v_mfma_f32_16x16x32_bf16 v[80:83], v[32:35], a[112:115], v[80:83]
    v_mfma_f32_16x16x32_bf16 v[88:91], v[32:35], a[120:123], v[88:91]
    v_mfma_f32_16x16x32_bf16 v[96:99], v[32:35], a[240:243], v[96:99]
    v_mfma_f32_16x16x32_bf16 v[104:107], v[32:35], a[248:251], v[104:107]
    s_waitcnt lgkmcnt(2)
    v_mfma_f32_16x16x32_bf16 v[72:75], v[240:243], v[36:39], v[72:75]
    v_mfma_f32_16x16x32_bf16 v[76:79], v[248:251], v[36:39], v[76:79]
    v_mfma_f32_16x16x32_bf16 v[84:87], v[36:39], a[112:115], v[84:87]
    v_mfma_f32_16x16x32_bf16 v[92:95], v[36:39], a[120:123], v[92:95]
    v_mfma_f32_16x16x32_bf16 v[100:103], v[36:39], a[240:243], v[100:103]
    v_mfma_f32_16x16x32_bf16 v[108:111], v[36:39], a[248:251], v[108:111]
    s_waitcnt lgkmcnt(1)
    v_mfma_f32_16x16x32_bf16 v[64:67], v[244:247], v[40:43], v[64:67]
    v_mfma_f32_16x16x32_bf16 v[68:71], v[252:255], v[40:43], v[68:71]
    v_mfma_f32_16x16x32_bf16 v[80:83], v[40:43], a[116:119], v[80:83]
    v_mfma_f32_16x16x32_bf16 v[88:91], v[40:43], a[124:127], v[88:91]
    v_mfma_f32_16x16x32_bf16 v[96:99], v[40:43], a[244:247], v[96:99]
    v_mfma_f32_16x16x32_bf16 v[104:107], v[40:43], a[252:255], v[104:107]
    s_waitcnt lgkmcnt(0)
    v_mfma_f32_16x16x32_bf16 v[72:75], v[244:247], v[44:47], v[72:75]
    v_mfma_f32_16x16x32_bf16 v[76:79], v[252:255], v[44:47], v[76:79]
    v_mfma_f32_16x16x32_bf16 v[84:87], v[44:47], a[116:119], v[84:87]
    v_mfma_f32_16x16x32_bf16 v[92:95], v[44:47], a[124:127], v[92:95]
    v_mfma_f32_16x16x32_bf16 v[100:103], v[44:47], a[244:247], v[100:103]
    v_mfma_f32_16x16x32_bf16 v[108:111], v[44:47], a[252:255], v[108:111]
    v_mul_f32 v24, s42, v64
    v_mul_f32 v25, s42, v65
    v_mul_f32 v26, s42, v66
    v_mul_f32 v27, s42, v67
    v_mul_f32 v28, s42, v68
    v_mul_f32 v29, s42, v69
    v_mul_f32 v30, s42, v70
    v_mul_f32 v31, s42, v71
    v_min_f32 v24, 0, v24
    v_min_f32 v25, 0, v25
    v_min_f32 v26, 0, v26
    v_min_f32 v27, 0, v27
    v_min_f32 v28, 0, v28
    v_min_f32 v29, 0, v29
    v_min_f32 v30, 0, v30
    v_min_f32 v31, 0, v31
    v_exp_f32 v24, v24
    v_exp_f32 v25, v25
    v_exp_f32 v26, v26
    v_exp_f32 v27, v27
    v_exp_f32 v28, v28
    v_exp_f32 v29, v29
    v_exp_f32 v30, v30
    v_exp_f32 v31, v31
    v_max_f32 v64, 0, v64
    v_max_f32 v65, 0, v65
    v_max_f32 v66, 0, v66
    v_max_f32 v67, 0, v67
    v_max_f32 v68, 0, v68
    v_max_f32 v69, 0, v69
    v_max_f32 v70, 0, v70
    v_max_f32 v71, 0, v71
    v_add_f32 v24, s43, v24
    v_add_f32 v25, s43, v25
    v_add_f32 v26, s43, v26
    v_add_f32 v27, s43, v27
    v_add_f32 v28, s43, v28
    v_add_f32 v29, s43, v29
    v_add_f32 v30, s43, v30
    v_add_f32 v31, s43, v31
    v_add_f32 v64, v64, v24
    v_add_f32 v65, v65, v25
    v_add_f32 v66, v66, v26
    v_add_f32 v67, v67, v27
    v_add_f32 v68, v68, v28
    v_add_f32 v69, v69, v29
    v_add_f32 v70, v70, v30
    v_add_f32 v71, v71, v31
    v_mul_f32 v24, s42, v72
    v_mul_f32 v25, s42, v73
    v_mul_f32 v26, s42, v74
    v_mul_f32 v27, s42, v75
    v_mul_f32 v28, s42, v76
    v_mul_f32 v29, s42, v77
    v_mul_f32 v30, s42, v78
    v_mul_f32 v31, s42, v79
    v_min_f32 v24, 0, v24
    v_min_f32 v25, 0, v25
    v_min_f32 v26, 0, v26
    v_min_f32 v27, 0, v27
    v_min_f32 v28, 0, v28
    v_min_f32 v29, 0, v29
    v_min_f32 v30, 0, v30
    v_min_f32 v31, 0, v31
    v_exp_f32 v24, v24
    v_exp_f32 v25, v25
    v_exp_f32 v26, v26
    v_exp_f32 v27, v27
    v_exp_f32 v28, v28
    v_exp_f32 v29, v29
    v_exp_f32 v30, v30
    v_exp_f32 v31, v31
    v_max_f32 v72, 0, v72
    v_max_f32 v73, 0, v73
    v_max_f32 v74, 0, v74
    v_max_f32 v75, 0, v75
    v_max_f32 v76, 0, v76
    v_max_f32 v77, 0, v77
    v_max_f32 v78, 0, v78
    v_max_f32 v79, 0, v79
    v_add_f32 v24, s43, v24
    v_add_f32 v25, s43, v25
    v_add_f32 v26, s43, v26
    v_add_f32 v27, s43, v27
    v_add_f32 v28, s43, v28
    v_add_f32 v29, s43, v29
    v_add_f32 v30, s43, v30
    v_add_f32 v31, s43, v31
    v_add_f32 v72, v72, v24
    v_add_f32 v73, v73, v25
    v_add_f32 v74, v74, v26
    v_add_f32 v75, v75, v27
    v_add_f32 v76, v76, v28
    v_add_f32 v77, v77, v29
    v_add_f32 v78, v78, v30
    v_add_f32 v79, v79, v31
    v_mul_f32 v24, s42, v80
    v_mul_f32 v25, s42, v81
    v_mul_f32 v26, s42, v82
    v_mul_f32 v27, s42, v83
    v_mul_f32 v28, s42, v84
    v_mul_f32 v29, s42, v85
    v_mul_f32 v30, s42, v86
    v_mul_f32 v31, s42, v87
    v_min_f32 v24, 0, v24
    v_min_f32 v25, 0, v25
    v_min_f32 v26, 0, v26
    v_min_f32 v27, 0, v27
    v_min_f32 v28, 0, v28
    v_min_f32 v29, 0, v29
    v_min_f32 v30, 0, v30
    v_min_f32 v31, 0, v31
    v_exp_f32 v24, v24
    v_exp_f32 v25, v25
    v_exp_f32 v26, v26
    v_exp_f32 v27, v27
    v_exp_f32 v28, v28
    v_exp_f32 v29, v29
    v_exp_f32 v30, v30
    v_exp_f32 v31, v31
    v_max_f32 v80, 0, v80
    v_max_f32 v81, 0, v81
    v_max_f32 v82, 0, v82
    v_max_f32 v83, 0, v83
    v_max_f32 v84, 0, v84
    v_max_f32 v85, 0, v85
    v_max_f32 v86, 0, v86
    v_max_f32 v87, 0, v87
    v_add_f32 v24, s43, v24
    v_add_f32 v25, s43, v25
    v_add_f32 v26, s43, v26
    v_add_f32 v27, s43, v27
    v_add_f32 v28, s43, v28
    v_add_f32 v29, s43, v29
    v_add_f32 v30, s43, v30
    v_add_f32 v31, s43, v31
    v_add_f32 v80, v80, v24
    v_add_f32 v81, v81, v25
    v_add_f32 v82, v82, v26
    v_add_f32 v83, v83, v27
    v_add_f32 v84, v84, v28
    v_add_f32 v85, v85, v29
    v_add_f32 v86, v86, v30
    v_add_f32 v87, v87, v31
    v_mul_f32 v24, s42, v88
    v_mul_f32 v25, s42, v89
    v_mul_f32 v26, s42, v90
    v_mul_f32 v27, s42, v91
    v_mul_f32 v28, s42, v92
    v_mul_f32 v29, s42, v93
    v_mul_f32 v30, s42, v94
    v_mul_f32 v31, s42, v95
    v_min_f32 v24, 0, v24
    v_min_f32 v25, 0, v25
    v_min_f32 v26, 0, v26
    v_min_f32 v27, 0, v27
    v_min_f32 v28, 0, v28
    v_min_f32 v29, 0, v29
    v_min_f32 v30, 0, v30
    v_min_f32 v31, 0, v31
    v_exp_f32 v24, v24
    v_exp_f32 v25, v25
    v_exp_f32 v26, v26
    v_exp_f32 v27, v27
    v_exp_f32 v28, v28
    v_exp_f32 v29, v29
    v_exp_f32 v30, v30
    v_exp_f32 v31, v31
    v_max_f32 v88, 0, v88
    v_max_f32 v89, 0, v89
    v_max_f32 v90, 0, v90
    v_max_f32 v91, 0, v91
    v_max_f32 v92, 0, v92
    v_max_f32 v93, 0, v93
    v_max_f32 v94, 0, v94
    v_max_f32 v95, 0, v95
    v_add_f32 v24, s43, v24
    v_add_f32 v25, s43, v25
    v_add_f32 v26, s43, v26
    v_add_f32 v27, s43, v27
    v_add_f32 v28, s43, v28
    v_add_f32 v29, s43, v29
    v_add_f32 v30, s43, v30
    v_add_f32 v31, s43, v31
    v_add_f32 v88, v88, v24
    v_add_f32 v89, v89, v25
    v_add_f32 v90, v90, v26
    v_add_f32 v91, v91, v27
    v_add_f32 v92, v92, v28
    v_add_f32 v93, v93, v29
    v_add_f32 v94, v94, v30
    v_add_f32 v95, v95, v31
    s_lshl_b32 s34, s41, 13
    s_add_u32 s34, s34, s40
    v_cvt_pk_bf16_f32 v32, v64, v65
    v_cvt_pk_bf16_f32 v33, v66, v67
    v_cvt_pk_bf16_f32 v34, v68, v69
    v_cvt_pk_bf16_f32 v35, v70, v71
    buffer_store_dwordx4 v[32:35], v5, s[4:7], s34 offen offset:0 sc1
    v_cvt_pk_bf16_f32 v36, v72, v73
    v_cvt_pk_bf16_f32 v37, v74, v75
    v_cvt_pk_bf16_f32 v38, v76, v77
    v_cvt_pk_bf16_f32 v39, v78, v79
    buffer_store_dwordx4 v[36:39], v5, s[4:7], s34 offen offset:1024 sc1
    v_cvt_pk_bf16_f32 v40, v80, v81
    v_cvt_pk_bf16_f32 v41, v82, v83
    v_cvt_pk_bf16_f32 v42, v84, v85
    v_cvt_pk_bf16_f32 v43, v86, v87
    v_cvt_pk_bf16_f32 v48, v96, v97
    v_cvt_pk_bf16_f32 v49, v98, v99
    v_cvt_pk_bf16_f32 v50, v100, v101
    v_cvt_pk_bf16_f32 v51, v102, v103
    v_cvt_pk_bf16_f32 v44, v88, v89
    v_cvt_pk_bf16_f32 v45, v90, v91
    v_cvt_pk_bf16_f32 v46, v92, v93
    v_cvt_pk_bf16_f32 v47, v94, v95
    v_cvt_pk_bf16_f32 v52, v104, v105
    v_cvt_pk_bf16_f32 v53, v106, v107
    v_cvt_pk_bf16_f32 v54, v108, v109
    v_cvt_pk_bf16_f32 v55, v110, v111
    v_mfma_f32_16x16x32_bf16 v[112:115], v[40:43], v[48:51], v[112:115]
    v_mfma_f32_16x16x32_bf16 v[120:123], v[40:43], v[20:23], v[120:123]
    v_mfma_f32_16x16x32_bf16 v[116:119], v[44:47], v[52:55], v[116:119]
    v_mfma_f32_16x16x32_bf16 v[124:127], v[44:47], v[20:23], v[124:127]
    s_add_u32 s37, s37, 1
    s_add_u32 s41, s41, 1
    s_mov_b32 s34, s38
    s_mov_b32 s38, s39
    s_mov_b32 s39, s34
    s_cmp_lt_u32 s41, 8
    s_cbranch_scc1 L_wa_p1
    s_nop 7
    s_lshl_b32 s34, s28, 3
    s_add_u32 s34, s34, s29
    s_lshl_b32 s34, s34, 14
    s_lshl_b32 s35, s24, 12
    s_add_u32 s34, s34, s35
    s_add_u32 s34, s34, 1048576
    buffer_store_dwordx4 v[112:115], v5, s[4:7], s34 offen offset:0 sc1
    buffer_store_dwordx4 v[116:119], v5, s[4:7], s34 offen offset:1024 sc1
    buffer_store_dwordx4 v[120:123], v5, s[4:7], s34 offen offset:2048 sc1
    buffer_store_dwordx4 v[124:127], v5, s[4:7], s34 offen offset:3072 sc1
    v_mov_b32 v14, 4
L_poll_13:
    buffer_load_dword v15, v14, s[8:11], 0 offen offset:0 sc1
    s_waitcnt vmcnt(0)
    v_cmp_gt_u32 vcc, 32, v15
    s_cbranch_vccz L_polld_14
    s_sub_u32 s27, s27, 1
    s_cbranch_scc1 L_exit
    s_sleep 2
    s_branch L_poll_13
L_polld_14:
    s_barrier
    s_cmp_lg_u32 s24, 0
    s_cbranch_scc1 L_wa_f1
    s_lshl_b32 s34, s28, 7
    s_lshl_b32 s35, s29, 2
    s_add_u32 s34, s34, s35
    s_add_u32 s34, s34, 20480
    v_mov_b32 v14, s34
    v_mov_b32 v15, 1
    s_mov_b64 exec, 1
    buffer_store_dword v15, v14, s[4:7], 0 offen offset:0 sc1
    s_mov_b64 exec, -1
L_wa_f1:
    s_lshl_b32 s34, s28, 8
    s_lshl_b32 s35, s24, 6
    s_add_u32 s36, s34, s35
    v_bfe_u32 v14, v0, 5, 1
    v_mul_u32_u24 v1, 8, v14
    v_bfe_u32 v14, v0, 4, 1
    v_mul_u32_u24 v14, 4, v14
    v_add_u32 v1, v1, v14
    v_bfe_u32 v14, v0, 3, 1
    v_mul_u32_u24 v14, 2, v14
    v_add_u32 v1, v1, v14
    v_bfe_u32 v14, v0, 2, 1
    v_mul_u32_u24 v14, 1, v14
    v_add_u32 v1, v1, v14
    s_mov_b32 s34, 1024
    v_mul_lo_u32 v1, v1, s34
    v_and_b32 v14, 3, v0
    v_lshlrev_b32 v14, 4, v14
    v_add3_u32 v1, v1, v14, s36
    v_lshrrev_b32 v14, 2, v0
    v_lshlrev_b32 v14, 6, v14
    v_add_u32 v14, s33, v14
    v_and_b32 v15, 3, v0
    v_lshlrev_b32 v15, 4, v15
    v_add_u32 v4, v14, v15
    s_mov_b32 s12, s68
    s_and_b32 s13, s69, 0xffff
    s_mov_b32 s14, 524288
    s_mov_b32 s15, 0x20000
    s_add_u32 m0, s33, 0
    s_mov_b32 s34, 0
    buffer_load_dwordx4 v1, s[12:15], s34 offen  lds
    s_add_u32 m0, s33, 1024
    s_mov_b32 s34, 16384
    buffer_load_dwordx4 v1, s[12:15], s34 offen  lds
    s_add_u32 m0, s33, 2048
    s_mov_b32 s34, 32768
    buffer_load_dwordx4 v1, s[12:15], s34 offen  lds
    s_add_u32 m0, s33, 3072
    s_mov_b32 s34, 49152
    buffer_load_dwordx4 v1, s[12:15], s34 offen  lds
    s_add_u32 m0, s33, 4096
    s_mov_b32 s34, 65536
    buffer_load_dwordx4 v1, s[12:15], s34 offen  lds
    s_add_u32 m0, s33, 5120
    s_mov_b32 s34, 81920
    buffer_load_dwordx4 v1, s[12:15], s34 offen  lds
    s_add_u32 m0, s33, 6144
    s_mov_b32 s34, 98304
    buffer_load_dwordx4 v1, s[12:15], s34 offen  lds
    s_add_u32 m0, s33, 7168
    s_mov_b32 s34, 114688
    buffer_load_dwordx4 v1, s[12:15], s34 offen  lds
    s_add_u32 m0, s33, 8192
    s_mov_b32 s34, 131072
    buffer_load_dwordx4 v1, s[12:15], s34 offen  lds
    s_add_u32 m0, s33, 9216
    s_mov_b32 s34, 147456
    buffer_load_dwordx4 v1, s[12:15], s34 offen  lds
    s_add_u32 m0, s33, 10240
    s_mov_b32 s34, 163840
    buffer_load_dwordx4 v1, s[12:15], s34 offen  lds
    s_add_u32 m0, s33, 11264
    s_mov_b32 s34, 180224
    buffer_load_dwordx4 v1, s[12:15], s34 offen  lds
    s_add_u32 m0, s33, 12288
    s_mov_b32 s34, 196608
    buffer_load_dwordx4 v1, s[12:15], s34 offen  lds
    s_add_u32 m0, s33, 13312
    s_mov_b32 s34, 212992
    buffer_load_dwordx4 v1, s[12:15], s34 offen  lds
    s_add_u32 m0, s33, 14336
    s_mov_b32 s34, 229376
    buffer_load_dwordx4 v1, s[12:15], s34 offen  lds
    s_add_u32 m0, s33, 15360
    s_mov_b32 s34, 245760
    buffer_load_dwordx4 v1, s[12:15], s34 offen  lds
    s_add_u32 m0, s33, 16384
    s_mov_b32 s34, 262144
    buffer_load_dwordx4 v1, s[12:15], s34 offen  lds
    s_add_u32 m0, s33, 17408
    s_mov_b32 s34, 278528
    buffer_load_dwordx4 v1, s[12:15], s34 offen  lds
    s_add_u32 m0, s33, 18432
    s_mov_b32 s34, 294912
    buffer_load_dwordx4 v1, s[12:15], s34 offen  lds
    s_add_u32 m0, s33, 19456
    s_mov_b32 s34, 311296
    buffer_load_dwordx4 v1, s[12:15], s34 offen  lds
    s_add_u32 m0, s33, 20480
    s_mov_b32 s34, 327680
    buffer_load_dwordx4 v1, s[12:15], s34 offen  lds
    s_add_u32 m0, s33, 21504
    s_mov_b32 s34, 344064
    buffer_load_dwordx4 v1, s[12:15], s34 offen  lds
    s_add_u32 m0, s33, 22528
    s_mov_b32 s34, 360448
    buffer_load_dwordx4 v1, s[12:15], s34 offen  lds
    s_add_u32 m0, s33, 23552
    s_mov_b32 s34, 376832
    buffer_load_dwordx4 v1, s[12:15], s34 offen  lds
    s_add_u32 m0, s33, 24576
    s_mov_b32 s34, 393216
    buffer_load_dwordx4 v1, s[12:15], s34 offen  lds
    s_add_u32 m0, s33, 25600
    s_mov_b32 s34, 409600
    buffer_load_dwordx4 v1, s[12:15], s34 offen  lds
    s_add_u32 m0, s33, 26624
    s_mov_b32 s34, 425984
    buffer_load_dwordx4 v1, s[12:15], s34 offen  lds
    s_add_u32 m0, s33, 27648
    s_mov_b32 s34, 442368
    buffer_load_dwordx4 v1, s[12:15], s34 offen  lds
    s_add_u32 m0, s33, 28672
    s_mov_b32 s34, 458752
    buffer_load_dwordx4 v1, s[12:15], s34 offen  lds
    s_add_u32 m0, s33, 29696
    s_mov_b32 s34, 475136
    buffer_load_dwordx4 v1, s[12:15], s34 offen  lds
    s_add_u32 m0, s33, 30720
    s_mov_b32 s34, 491520
    buffer_load_dwordx4 v1, s[12:15], s34 offen  lds
    s_add_u32 m0, s33, 31744
    s_mov_b32 s34, 507904
    buffer_load_dwordx4 v1, s[12:15], s34 offen  lds
    s_waitcnt vmcnt(28)
    ds_read_b64_tr_b16 a[0:1], v4 offset:0
    ds_read_b64_tr_b16 a[2:3], v4 offset:1024
    ds_read_b64_tr_b16 a[4:5], v4 offset:2048
    ds_read_b64_tr_b16 a[6:7], v4 offset:3072
    ds_read_b64_tr_b16 a[8:9], v4 offset:8
    ds_read_b64_tr_b16 a[10:11], v4 offset:1032
    ds_read_b64_tr_b16 a[12:13], v4 offset:2056
    ds_read_b64_tr_b16 a[14:15], v4 offset:3080
    s_waitcnt lgkmcnt(0)
    s_waitcnt vmcnt(24)
    ds_read_b64_tr_b16 a[16:17], v4 offset:4096
    ds_read_b64_tr_b16 a[18:19], v4 offset:5120
    ds_read_b64_tr_b16 a[20:21], v4 offset:6144
    ds_read_b64_tr_b16 a[22:23], v4 offset:7168
    ds_read_b64_tr_b16 a[24:25], v4 offset:4104
    ds_read_b64_tr_b16 a[26:27], v4 offset:5128
    ds_read_b64_tr_b16 a[28:29], v4 offset:6152
    ds_read_b64_tr_b16 a[30:31], v4 offset:7176
    s_waitcnt lgkmcnt(0)
    s_waitcnt vmcnt(20)
    ds_read_b64_tr_b16 a[32:33], v4 offset:8192
    ds_read_b64_tr_b16 a[34:35], v4 offset:9216
    ds_read_b64_tr_b16 a[36:37], v4 offset:10240
    ds_read_b64_tr_b16 a[38:39], v4 offset:11264
    ds_read_b64_tr_b16 a[40:41], v4 offset:8200
    ds_read_b64_tr_b16 a[42:43], v4 offset:9224
    ds_read_b64_tr_b16 a[44:45], v4 offset:10248
    ds_read_b64_tr_b16 a[46:47], v4 offset:11272
    s_waitcnt lgkmcnt(0)
    s_waitcnt vmcnt(16)
    ds_read_b64_tr_b16 a[48:49], v4 offset:12288
    ds_read_b64_tr_b16 a[50:51], v4 offset:13312
    ds_read_b64_tr_b16 a[52:53], v4 offset:14336
    ds_read_b64_tr_b16 a[54:55], v4 offset:15360
    ds_read_b64_tr_b16 a[56:57], v4 offset:12296
    ds_read_b64_tr_b16 a[58:59], v4 offset:13320
    ds_read_b64_tr_b16 a[60:61], v4 offset:14344
    ds_read_b64_tr_b16 a[62:63], v4 offset:15368
    s_waitcnt lgkmcnt(0)
    s_waitcnt vmcnt(12)
    ds_read_b64_tr_b16 a[64:65], v4 offset:16384
    ds_read_b64_tr_b16 a[66:67], v4 offset:17408
    ds_read_b64_tr_b16 a[68:69], v4 offset:18432
    ds_read_b64_tr_b16 a[70:71], v4 offset:19456
    ds_read_b64_tr_b16 a[72:73], v4 offset:16392
    ds_read_b64_tr_b16 a[74:75], v4 offset:17416
    ds_read_b64_tr_b16 a[76:77], v4 offset:18440
    ds_read_b64_tr_b16 a[78:79], v4 offset:19464
    s_waitcnt lgkmcnt(0)
    s_waitcnt vmcnt(8)
    ds_read_b64_tr_b16 a[80:81], v4 offset:20480
    ds_read_b64_tr_b16 a[82:83], v4 offset:21504
    ds_read_b64_tr_b16 a[84:85], v4 offset:22528
    ds_read_b64_tr_b16 a[86:87], v4 offset:23552
    ds_read_b64_tr_b16 a[88:89], v4 offset:20488
    ds_read_b64_tr_b16 a[90:91], v4 offset:21512
    ds_read_b64_tr_b16 a[92:93], v4 offset:22536
    ds_read_b64_tr_b16 a[94:95], v4 offset:23560
    s_waitcnt lgkmcnt(0)
    s_waitcnt vmcnt(4)
    ds_read_b64_tr_b16 a[96:97], v4 offset:24576
    ds_read_b64_tr_b16 a[98:99], v4 offset:25600
    ds_read_b64_tr_b16 a[100:101], v4 offset:26624
    ds_read_b64_tr_b16 a[102:103], v4 offset:27648
    ds_read_b64_tr_b16 a[104:105], v4 offset:24584
    ds_read_b64_tr_b16 a[106:107], v4 offset:25608
    ds_read_b64_tr_b16 a[108:109], v4 offset:26632
    ds_read_b64_tr_b16 a[110:111], v4 offset:27656
    s_waitcnt lgkmcnt(0)
    s_waitcnt vmcnt(0)
    ds_read_b64_tr_b16 a[112:113], v4 offset:28672
    ds_read_b64_tr_b16 a[114:115], v4 offset:29696
    ds_read_b64_tr_b16 a[116:117], v4 offset:30720
    ds_read_b64_tr_b16 a[118:119], v4 offset:31744
    ds_read_b64_tr_b16 a[120:121], v4 offset:28680
    ds_read_b64_tr_b16 a[122:123], v4 offset:29704
    ds_read_b64_tr_b16 a[124:125], v4 offset:30728
    ds_read_b64_tr_b16 a[126:127], v4 offset:31752
    s_waitcnt lgkmcnt(0)
    v_and_b32 v14, 7, v0
    v_lshlrev_b32 v14, 2, v14
    s_lshl_b32 s34, s28, 7
    s_add_u32 s34, s34, 20480
L_poll_15:
    buffer_load_dword v15, v14, s[4:7], s34 offen offset:0 sc1
    s_waitcnt vmcnt(0)
    v_cmp_ne_u32 vcc, 1, v15
    s_cbranch_vccz L_polld_16
    s_sub_u32 s27, s27, 1
    s_cbranch_scc1 L_exit
    s_sleep 4
    s_branch L_poll_15
L_polld_16:
    s_lshl_b32 s34, s28, 17
    s_lshl_b32 s35, s24, 12
    s_add_u32 s34, s34, s35
    s_add_u32 s34, s34, 1048576
    buffer_load_dwordx4 v[128:131], v5, s[4:7], s34 offen offset:0 sc1
    buffer_load_dwordx4 v[132:135], v5, s[4:7], s34 offen offset:1024 sc1
    buffer_load_dwordx4 v[136:139], v5, s[4:7], s34 offen offset:2048 sc1
    buffer_load_dwordx4 v[140:143], v5, s[4:7], s34 offen offset:3072 sc1
    s_add_u32 s34, s34, 16384
    buffer_load_dwordx4 v[144:147], v5, s[4:7], s34 offen offset:0 sc1
    buffer_load_dwordx4 v[148:151], v5, s[4:7], s34 offen offset:1024 sc1
    buffer_load_dwordx4 v[152:155], v5, s[4:7], s34 offen offset:2048 sc1
    buffer_load_dwordx4 v[156:159], v5, s[4:7], s34 offen offset:3072 sc1
    s_add_u32 s34, s34, 16384
    buffer_load_dwordx4 v[160:163], v5, s[4:7], s34 offen offset:0 sc1
    buffer_load_dwordx4 v[164:167], v5, s[4:7], s34 offen offset:1024 sc1
    buffer_load_dwordx4 v[168:171], v5, s[4:7], s34 offen offset:2048 sc1
    buffer_load_dwordx4 v[172:175], v5, s[4:7], s34 offen offset:3072 sc1
    s_add_u32 s34, s34, 16384
    buffer_load_dwordx4 v[176:179], v5, s[4:7], s34 offen offset:0 sc1
    buffer_load_dwordx4 v[180:183], v5, s[4:7], s34 offen offset:1024 sc1
    buffer_load_dwordx4 v[184:187], v5, s[4:7], s34 offen offset:2048 sc1
    buffer_load_dwordx4 v[188:191], v5, s[4:7], s34 offen offset:3072 sc1
    s_add_u32 s34, s34, 16384
    buffer_load_dwordx4 v[192:195], v5, s[4:7], s34 offen offset:0 sc1
    buffer_load_dwordx4 v[196:199], v5, s[4:7], s34 offen offset:1024 sc1
    buffer_load_dwordx4 v[200:203], v5, s[4:7], s34 offen offset:2048 sc1
    buffer_load_dwordx4 v[204:207], v5, s[4:7], s34 offen offset:3072 sc1
    s_add_u32 s34, s34, 16384
    buffer_load_dwordx4 v[208:211], v5, s[4:7], s34 offen offset:0 sc1
    buffer_load_dwordx4 v[212:215], v5, s[4:7], s34 offen offset:1024 sc1
    buffer_load_dwordx4 v[216:219], v5, s[4:7], s34 offen offset:2048 sc1
    buffer_load_dwordx4 v[220:223], v5, s[4:7], s34 offen offset:3072 sc1
    s_add_u32 s34, s34, 16384
    buffer_load_dwordx4 v[224:227], v5, s[4:7], s34 offen offset:0 sc1
    buffer_load_dwordx4 v[228:231], v5, s[4:7], s34 offen offset:1024 sc1
    buffer_load_dwordx4 v[232:235], v5, s[4:7], s34 offen offset:2048 sc1
    buffer_load_dwordx4 v[236:239], v5, s[4:7], s34 offen offset:3072 sc1
    s_add_u32 s34, s34, 16384
    buffer_load_dwordx4 v[240:243], v5, s[4:7], s34 offen offset:0 sc1
    buffer_load_dwordx4 v[244:247], v5, s[4:7], s34 offen offset:1024 sc1
    buffer_load_dwordx4 v[248:251], v5, s[4:7], s34 offen offset:2048 sc1
    buffer_load_dwordx4 v[252:255], v5, s[4:7], s34 offen offset:3072 sc1
    s_waitcnt vmcnt(0)
    v_add_f32 v128, v128, v144
    v_add_f32 v129, v129, v145
    v_add_f32 v130, v130, v146
    v_add_f32 v131, v131, v147
    v_add_f32 v132, v132, v148
    v_add_f32 v133, v133, v149
    v_add_f32 v134, v134, v150
    v_add_f32 v135, v135, v151
    v_add_f32 v136, v136, v152
    v_add_f32 v137, v137, v153
    v_add_f32 v138, v138, v154
    v_add_f32 v139, v139, v155
    v_add_f32 v140, v140, v156
    v_add_f32 v141, v141, v157
    v_add_f32 v142, v142, v158
    v_add_f32 v143, v143, v159
    v_add_f32 v128, v128, v160
    v_add_f32 v129, v129, v161
    v_add_f32 v130, v130, v162
    v_add_f32 v131, v131, v163
    v_add_f32 v132, v132, v164
    v_add_f32 v133, v133, v165
    v_add_f32 v134, v134, v166
    v_add_f32 v135, v135, v167
    v_add_f32 v136, v136, v168
    v_add_f32 v137, v137, v169
    v_add_f32 v138, v138, v170
    v_add_f32 v139, v139, v171
    v_add_f32 v140, v140, v172
    v_add_f32 v141, v141, v173
    v_add_f32 v142, v142, v174
    v_add_f32 v143, v143, v175
    v_add_f32 v128, v128, v176
    v_add_f32 v129, v129, v177
    v_add_f32 v130, v130, v178
    v_add_f32 v131, v131, v179
    v_add_f32 v132, v132, v180
    v_add_f32 v133, v133, v181
    v_add_f32 v134, v134, v182
    v_add_f32 v135, v135, v183
    v_add_f32 v136, v136, v184
    v_add_f32 v137, v137, v185
    v_add_f32 v138, v138, v186
    v_add_f32 v139, v139, v187
    v_add_f32 v140, v140, v188
    v_add_f32 v141, v141, v189
    v_add_f32 v142, v142, v190
    v_add_f32 v143, v143, v191
    v_add_f32 v128, v128, v192
    v_add_f32 v129, v129, v193
    v_add_f32 v130, v130, v194
    v_add_f32 v131, v131, v195
    v_add_f32 v132, v132, v196
    v_add_f32 v133, v133, v197
    v_add_f32 v134, v134, v198
    v_add_f32 v135, v135, v199
    v_add_f32 v136, v136, v200
    v_add_f32 v137, v137, v201
    v_add_f32 v138, v138, v202
    v_add_f32 v139, v139, v203
    v_add_f32 v140, v140, v204
    v_add_f32 v141, v141, v205
    v_add_f32 v142, v142, v206
    v_add_f32 v143, v143, v207
    v_add_f32 v128, v128, v208
    v_add_f32 v129, v129, v209
    v_add_f32 v130, v130, v210
    v_add_f32 v131, v131, v211
    v_add_f32 v132, v132, v212
    v_add_f32 v133, v133, v213
    v_add_f32 v134, v134, v214
    v_add_f32 v135, v135, v215
    v_add_f32 v136, v136, v216
    v_add_f32 v137, v137, v217
    v_add_f32 v138, v138, v218
    v_add_f32 v139, v139, v219
    v_add_f32 v140, v140, v220
    v_add_f32 v141, v141, v221
    v_add_f32 v142, v142, v222
    v_add_f32 v143, v143, v223
    v_add_f32 v128, v128, v224
    v_add_f32 v129, v129, v225
    v_add_f32 v130, v130, v226
    v_add_f32 v131, v131, v227
    v_add_f32 v132, v132, v228
    v_add_f32 v133, v133, v229
    v_add_f32 v134, v134, v230
    v_add_f32 v135, v135, v231
    v_add_f32 v136, v136, v232
    v_add_f32 v137, v137, v233
    v_add_f32 v138, v138, v234
    v_add_f32 v139, v139, v235
    v_add_f32 v140, v140, v236
    v_add_f32 v141, v141, v237
    v_add_f32 v142, v142, v238
    v_add_f32 v143, v143, v239
    v_add_f32 v128, v128, v240
    v_add_f32 v129, v129, v241
    v_add_f32 v130, v130, v242
    v_add_f32 v131, v131, v243
    v_add_f32 v132, v132, v244
    v_add_f32 v133, v133, v245
    v_add_f32 v134, v134, v246
    v_add_f32 v135, v135, v247
    v_add_f32 v136, v136, v248
    v_add_f32 v137, v137, v249
    v_add_f32 v138, v138, v250
    v_add_f32 v139, v139, v251
    v_add_f32 v140, v140, v252
    v_add_f32 v141, v141, v253
    v_add_f32 v142, v142, v254
    v_add_f32 v143, v143, v255
    v_cvt_pk_bf16_f32 v24, v128, v129
    v_cvt_pk_bf16_f32 v25, v130, v131
    v_mov_b32 v26, 0
    v_mov_b32 v27, 0
    v_cvt_pk_bf16_f32 v28, v132, v133
    v_cvt_pk_bf16_f32 v29, v134, v135
    v_cvt_pk_bf16_f32 v30, v136, v137
    v_cvt_pk_bf16_f32 v31, v138, v139
    v_mov_b32 v32, 0
    v_mov_b32 v33, 0
    v_cvt_pk_bf16_f32 v34, v140, v141
    v_cvt_pk_bf16_f32 v35, v142, v143
    s_mov_b32 s34, s40
    buffer_load_dwordx4 v[128:131], v5, s[4:7], s34 offen offset:0 sc1
    buffer_load_dwordx4 v[132:135], v5, s[4:7], s34 offen offset:1024 sc1
    s_add_u32 s34, s34, 8192
    buffer_load_dwordx4 v[136:139], v5, s[4:7], s34 offen offset:0 sc1
    buffer_load_dwordx4 v[140:143], v5, s[4:7], s34 offen offset:1024 sc1
    s_add_u32 s34, s34, 8192
    buffer_load_dwordx4 v[144:147], v5, s[4:7], s34 offen offset:0 sc1
    buffer_load_dwordx4 v[148:151], v5, s[4:7], s34 offen offset:1024 sc1
    s_add_u32 s34, s34, 8192
    buffer_load_dwordx4 v[152:155], v5, s[4:7], s34 offen offset:0 sc1
    buffer_load_dwordx4 v[156:159], v5, s[4:7], s34 offen offset:1024 sc1
    s_add_u32 s34, s34, 8192
    buffer_load_dwordx4 v[160:163], v5, s[4:7], s34 offen offset:0 sc1
    buffer_load_dwordx4 v[164:167], v5, s[4:7], s34 offen offset:1024 sc1
    s_add_u32 s34, s34, 8192
    buffer_load_dwordx4 v[168:171], v5, s[4:7], s34 offen offset:0 sc1
    buffer_load_dwordx4 v[172:175], v5, s[4:7], s34 offen offset:1024 sc1
    s_add_u32 s34, s34, 8192
    buffer_load_dwordx4 v[176:179], v5, s[4:7], s34 offen offset:0 sc1
    buffer_load_dwordx4 v[180:183], v5, s[4:7], s34 offen offset:1024 sc1
    s_add_u32 s34, s34, 8192
    buffer_load_dwordx4 v[184:187], v5, s[4:7], s34 offen offset:0 sc1
    buffer_load_dwordx4 v[188:191], v5, s[4:7], s34 offen offset:1024 sc1
    s_lshl_b32 s34, s29, 18
    s_lshl_b32 s35, s28, 2
    s_add_u32 s35, s35, s24
    s_lshl_b32 s35, s35, 10
    s_add_u32 s34, s34, s35
    s_add_u32 s34, s34, 4194304
    s_waitcnt vmcnt(0)
    v_mfma_f32_16x16x32_bf16 v[40:43], v[24:27], v[128:131], 0
    v_mfma_f32_16x16x32_bf16 v[48:51], v[30:33], v[128:131], 0
    v_mfma_f32_16x16x32_bf16 v[44:47], v[26:29], v[128:131], 0
    v_mfma_f32_16x16x32_bf16 v[52:55], v[32:35], v[128:131], 0
    v_add_f32 v48, s43, v48
    v_rcp_f32 v48, v48
    s_nop 5
    v_add_f32 v52, s43, v52
    v_rcp_f32 v52, v52
    v_mul_f32 v40, v40, v48
    v_mul_f32 v41, v41, v48
    v_mul_f32 v42, v42, v48
    v_mul_f32 v43, v43, v48
    v_mul_f32 v44, v44, v52
    v_mul_f32 v45, v45, v52
    v_mul_f32 v46, v46, v52
    v_mul_f32 v47, v47, v52
    v_cvt_pk_bf16_f32 v72, v40, v41
    v_cvt_pk_bf16_f32 v73, v42, v43
    v_cvt_pk_bf16_f32 v74, v44, v45
    v_cvt_pk_bf16_f32 v75, v46, v47
    buffer_store_dwordx4 v[72:75], v5, s[4:7], s34 offen sc1
    v_mfma_f32_16x16x32_bf16 v[56:59], v[24:27], v[132:135], 0
    v_mfma_f32_16x16x32_bf16 v[64:67], v[30:33], v[132:135], 0
    v_mfma_f32_16x16x32_bf16 v[60:63], v[26:29], v[132:135], 0
    v_mfma_f32_16x16x32_bf16 v[68:71], v[32:35], v[132:135], 0
    v_add_f32 v64, s43, v64
    v_rcp_f32 v64, v64
    s_nop 5
    v_add_f32 v68, s43, v68
    v_rcp_f32 v68, v68
    v_mul_f32 v56, v56, v64
    v_mul_f32 v57, v57, v64
    v_mul_f32 v58, v58, v64
    v_mul_f32 v59, v59, v64
    v_mul_f32 v60, v60, v68
    v_mul_f32 v61, v61, v68
    v_mul_f32 v62, v62, v68
    v_mul_f32 v63, v63, v68
    v_cvt_pk_bf16_f32 v76, v56, v57
    v_cvt_pk_bf16_f32 v77, v58, v59
    v_cvt_pk_bf16_f32 v78, v60, v61
    v_cvt_pk_bf16_f32 v79, v62, v63
    s_add_u32 s34, s34, 16384
    buffer_store_dwordx4 v[76:79], v5, s[4:7], s34 offen sc1
    v_mfma_f32_16x16x32_bf16 v[40:43], v[24:27], v[136:139], 0
    v_mfma_f32_16x16x32_bf16 v[48:51], v[30:33], v[136:139], 0
    v_mfma_f32_16x16x32_bf16 v[44:47], v[26:29], v[136:139], 0
    v_mfma_f32_16x16x32_bf16 v[52:55], v[32:35], v[136:139], 0
    v_add_f32 v48, s43, v48
    v_rcp_f32 v48, v48
    s_nop 5
    v_add_f32 v52, s43, v52
    v_rcp_f32 v52, v52
    v_mul_f32 v40, v40, v48
    v_mul_f32 v41, v41, v48
    v_mul_f32 v42, v42, v48
    v_mul_f32 v43, v43, v48
    v_mul_f32 v44, v44, v52
    v_mul_f32 v45, v45, v52
    v_mul_f32 v46, v46, v52
    v_mul_f32 v47, v47, v52
    v_cvt_pk_bf16_f32 v80, v40, v41
    v_cvt_pk_bf16_f32 v81, v42, v43
    v_cvt_pk_bf16_f32 v82, v44, v45
    v_cvt_pk_bf16_f32 v83, v46, v47
    s_add_u32 s34, s34, 16384
    buffer_store_dwordx4 v[80:83], v5, s[4:7], s34 offen sc1
    v_mfma_f32_16x16x32_bf16 v[56:59], v[24:27], v[140:143], 0
    v_mfma_f32_16x16x32_bf16 v[64:67], v[30:33], v[140:143], 0
    v_mfma_f32_16x16x32_bf16 v[60:63], v[26:29], v[140:143], 0
    v_mfma_f32_16x16x32_bf16 v[68:71], v[32:35], v[140:143], 0
    v_add_f32 v64, s43, v64
    v_rcp_f32 v64, v64
    s_nop 5
    v_add_f32 v68, s43, v68
    v_rcp_f32 v68, v68
    v_mul_f32 v56, v56, v64
    v_mul_f32 v57, v57, v64
    v_mul_f32 v58, v58, v64
    v_mul_f32 v59, v59, v64
    v_mul_f32 v60, v60, v68
    v_mul_f32 v61, v61, v68
    v_mul_f32 v62, v62, v68
    v_mul_f32 v63, v63, v68
    v_cvt_pk_bf16_f32 v84, v56, v57
    v_cvt_pk_bf16_f32 v85, v58, v59
    v_cvt_pk_bf16_f32 v86, v60, v61
    v_cvt_pk_bf16_f32 v87, v62, v63
    s_add_u32 s34, s34, 16384
    buffer_store_dwordx4 v[84:87], v5, s[4:7], s34 offen sc1
    v_mfma_f32_16x16x32_bf16 v[40:43], v[24:27], v[144:147], 0
    v_mfma_f32_16x16x32_bf16 v[48:51], v[30:33], v[144:147], 0
    v_mfma_f32_16x16x32_bf16 v[44:47], v[26:29], v[144:147], 0
    v_mfma_f32_16x16x32_bf16 v[52:55], v[32:35], v[144:147], 0
    v_add_f32 v48, s43, v48
    v_rcp_f32 v48, v48
    s_nop 5
    v_add_f32 v52, s43, v52
    v_rcp_f32 v52, v52
    v_mul_f32 v40, v40, v48
    v_mul_f32 v41, v41, v48
    v_mul_f32 v42, v42, v48
    v_mul_f32 v43, v43, v48
    v_mul_f32 v44, v44, v52
    v_mul_f32 v45, v45, v52
    v_mul_f32 v46, v46, v52
    v_mul_f32 v47, v47, v52
    v_cvt_pk_bf16_f32 v72, v40, v41
    v_cvt_pk_bf16_f32 v73, v42, v43
    v_cvt_pk_bf16_f32 v74, v44, v45
    v_cvt_pk_bf16_f32 v75, v46, v47
    s_add_u32 s34, s34, 16384
    buffer_store_dwordx4 v[72:75], v5, s[4:7], s34 offen sc1
    v_mfma_f32_16x16x32_bf16 v[56:59], v[24:27], v[148:151], 0
    v_mfma_f32_16x16x32_bf16 v[64:67], v[30:33], v[148:151], 0
    v_mfma_f32_16x16x32_bf16 v[60:63], v[26:29], v[148:151], 0
    v_mfma_f32_16x16x32_bf16 v[68:71], v[32:35], v[148:151], 0
    v_add_f32 v64, s43, v64
    v_rcp_f32 v64, v64
    s_nop 5
    v_add_f32 v68, s43, v68
    v_rcp_f32 v68, v68
    v_mul_f32 v56, v56, v64
    v_mul_f32 v57, v57, v64
    v_mul_f32 v58, v58, v64
    v_mul_f32 v59, v59, v64
    v_mul_f32 v60, v60, v68
    v_mul_f32 v61, v61, v68
    v_mul_f32 v62, v62, v68
    v_mul_f32 v63, v63, v68
    v_cvt_pk_bf16_f32 v76, v56, v57
    v_cvt_pk_bf16_f32 v77, v58, v59
    v_cvt_pk_bf16_f32 v78, v60, v61
    v_cvt_pk_bf16_f32 v79, v62, v63
    s_add_u32 s34, s34, 16384
    buffer_store_dwordx4 v[76:79], v5, s[4:7], s34 offen sc1
    v_mfma_f32_16x16x32_bf16 v[40:43], v[24:27], v[152:155], 0
    v_mfma_f32_16x16x32_bf16 v[48:51], v[30:33], v[152:155], 0
    v_mfma_f32_16x16x32_bf16 v[44:47], v[26:29], v[152:155], 0
    v_mfma_f32_16x16x32_bf16 v[52:55], v[32:35], v[152:155], 0
    v_add_f32 v48, s43, v48
    v_rcp_f32 v48, v48
    s_nop 5
    v_add_f32 v52, s43, v52
    v_rcp_f32 v52, v52
    v_mul_f32 v40, v40, v48
    v_mul_f32 v41, v41, v48
    v_mul_f32 v42, v42, v48
    v_mul_f32 v43, v43, v48
    v_mul_f32 v44, v44, v52
    v_mul_f32 v45, v45, v52
    v_mul_f32 v46, v46, v52
    v_mul_f32 v47, v47, v52
    v_cvt_pk_bf16_f32 v80, v40, v41
    v_cvt_pk_bf16_f32 v81, v42, v43
    v_cvt_pk_bf16_f32 v82, v44, v45
    v_cvt_pk_bf16_f32 v83, v46, v47
    s_add_u32 s34, s34, 16384
    buffer_store_dwordx4 v[80:83], v5, s[4:7], s34 offen sc1
    v_mfma_f32_16x16x32_bf16 v[56:59], v[24:27], v[156:159], 0
    v_mfma_f32_16x16x32_bf16 v[64:67], v[30:33], v[156:159], 0
    v_mfma_f32_16x16x32_bf16 v[60:63], v[26:29], v[156:159], 0
    v_mfma_f32_16x16x32_bf16 v[68:71], v[32:35], v[156:159], 0
    v_add_f32 v64, s43, v64
    v_rcp_f32 v64, v64
    s_nop 5
    v_add_f32 v68, s43, v68
    v_rcp_f32 v68, v68
    v_mul_f32 v56, v56, v64
    v_mul_f32 v57, v57, v64
    v_mul_f32 v58, v58, v64
    v_mul_f32 v59, v59, v64
    v_mul_f32 v60, v60, v68
    v_mul_f32 v61, v61, v68
    v_mul_f32 v62, v62, v68
    v_mul_f32 v63, v63, v68
    v_cvt_pk_bf16_f32 v84, v56, v57
    v_cvt_pk_bf16_f32 v85, v58, v59
    v_cvt_pk_bf16_f32 v86, v60, v61
    v_cvt_pk_bf16_f32 v87, v62, v63
    s_add_u32 s34, s34, 16384
    buffer_store_dwordx4 v[84:87], v5, s[4:7], s34 offen sc1
    v_mfma_f32_16x16x32_bf16 v[40:43], v[24:27], v[160:163], 0
    v_mfma_f32_16x16x32_bf16 v[48:51], v[30:33], v[160:163], 0
    v_mfma_f32_16x16x32_bf16 v[44:47], v[26:29], v[160:163], 0
    v_mfma_f32_16x16x32_bf16 v[52:55], v[32:35], v[160:163], 0
    v_add_f32 v48, s43, v48
    v_rcp_f32 v48, v48
    s_nop 5
    v_add_f32 v52, s43, v52
    v_rcp_f32 v52, v52
    v_mul_f32 v40, v40, v48
    v_mul_f32 v41, v41, v48
    v_mul_f32 v42, v42, v48
    v_mul_f32 v43, v43, v48
    v_mul_f32 v44, v44, v52
    v_mul_f32 v45, v45, v52
    v_mul_f32 v46, v46, v52
    v_mul_f32 v47, v47, v52
    v_cvt_pk_bf16_f32 v72, v40, v41
    v_cvt_pk_bf16_f32 v73, v42, v43
    v_cvt_pk_bf16_f32 v74, v44, v45
    v_cvt_pk_bf16_f32 v75, v46, v47
    s_add_u32 s34, s34, 16384
    buffer_store_dwordx4 v[72:75], v5, s[4:7], s34 offen sc1
    v_mfma_f32_16x16x32_bf16 v[56:59], v[24:27], v[164:167], 0
    v_mfma_f32_16x16x32_bf16 v[64:67], v[30:33], v[164:167], 0
    v_mfma_f32_16x16x32_bf16 v[60:63], v[26:29], v[164:167], 0
    v_mfma_f32_16x16x32_bf16 v[68:71], v[32:35], v[164:167], 0
    v_add_f32 v64, s43, v64
    v_rcp_f32 v64, v64
    s_nop 5
    v_add_f32 v68, s43, v68
    v_rcp_f32 v68, v68
    v_mul_f32 v56, v56, v64
    v_mul_f32 v57, v57, v64
    v_mul_f32 v58, v58, v64
    v_mul_f32 v59, v59, v64
    v_mul_f32 v60, v60, v68
    v_mul_f32 v61, v61, v68
    v_mul_f32 v62, v62, v68
    v_mul_f32 v63, v63, v68
    v_cvt_pk_bf16_f32 v76, v56, v57
    v_cvt_pk_bf16_f32 v77, v58, v59
    v_cvt_pk_bf16_f32 v78, v60, v61
    v_cvt_pk_bf16_f32 v79, v62, v63
    s_add_u32 s34, s34, 16384
    buffer_store_dwordx4 v[76:79], v5, s[4:7], s34 offen sc1
    v_mfma_f32_16x16x32_bf16 v[40:43], v[24:27], v[168:171], 0
    v_mfma_f32_16x16x32_bf16 v[48:51], v[30:33], v[168:171], 0
    v_mfma_f32_16x16x32_bf16 v[44:47], v[26:29], v[168:171], 0
    v_mfma_f32_16x16x32_bf16 v[52:55], v[32:35], v[168:171], 0
    v_add_f32 v48, s43, v48
    v_rcp_f32 v48, v48
    s_nop 5
    v_add_f32 v52, s43, v52
    v_rcp_f32 v52, v52
    v_mul_f32 v40, v40, v48
    v_mul_f32 v41, v41, v48
    v_mul_f32 v42, v42, v48
    v_mul_f32 v43, v43, v48
    v_mul_f32 v44, v44, v52
    v_mul_f32 v45, v45, v52
    v_mul_f32 v46, v46, v52
    v_mul_f32 v47, v47, v52
    v_cvt_pk_bf16_f32 v80, v40, v41
    v_cvt_pk_bf16_f32 v81, v42, v43
    v_cvt_pk_bf16_f32 v82, v44, v45
    v_cvt_pk_bf16_f32 v83, v46, v47
    s_add_u32 s34, s34, 16384
    buffer_store_dwordx4 v[80:83], v5, s[4:7], s34 offen sc1
    v_mfma_f32_16x16x32_bf16 v[56:59], v[24:27], v[172:175], 0
    v_mfma_f32_16x16x32_bf16 v[64:67], v[30:33], v[172:175], 0
    v_mfma_f32_16x16x32_bf16 v[60:63], v[26:29], v[172:175], 0
    v_mfma_f32_16x16x32_bf16 v[68:71], v[32:35], v[172:175], 0
    v_add_f32 v64, s43, v64
    v_rcp_f32 v64, v64
    s_nop 5
    v_add_f32 v68, s43, v68
    v_rcp_f32 v68, v68
    v_mul_f32 v56, v56, v64
    v_mul_f32 v57, v57, v64
    v_mul_f32 v58, v58, v64
    v_mul_f32 v59, v59, v64
    v_mul_f32 v60, v60, v68
    v_mul_f32 v61, v61, v68
    v_mul_f32 v62, v62, v68
    v_mul_f32 v63, v63, v68
    v_cvt_pk_bf16_f32 v84, v56, v57
    v_cvt_pk_bf16_f32 v85, v58, v59
    v_cvt_pk_bf16_f32 v86, v60, v61
    v_cvt_pk_bf16_f32 v87, v62, v63
    s_add_u32 s34, s34, 16384
    buffer_store_dwordx4 v[84:87], v5, s[4:7], s34 offen sc1
    v_mfma_f32_16x16x32_bf16 v[40:43], v[24:27], v[176:179], 0
    v_mfma_f32_16x16x32_bf16 v[48:51], v[30:33], v[176:179], 0
    v_mfma_f32_16x16x32_bf16 v[44:47], v[26:29], v[176:179], 0
    v_mfma_f32_16x16x32_bf16 v[52:55], v[32:35], v[176:179], 0
    v_add_f32 v48, s43, v48
    v_rcp_f32 v48, v48
    s_nop 5
    v_add_f32 v52, s43, v52
    v_rcp_f32 v52, v52
    v_mul_f32 v40, v40, v48
    v_mul_f32 v41, v41, v48
    v_mul_f32 v42, v42, v48
    v_mul_f32 v43, v43, v48
    v_mul_f32 v44, v44, v52
    v_mul_f32 v45, v45, v52
    v_mul_f32 v46, v46, v52
    v_mul_f32 v47, v47, v52
    v_cvt_pk_bf16_f32 v72, v40, v41
    v_cvt_pk_bf16_f32 v73, v42, v43
    v_cvt_pk_bf16_f32 v74, v44, v45
    v_cvt_pk_bf16_f32 v75, v46, v47
    s_add_u32 s34, s34, 16384
    buffer_store_dwordx4 v[72:75], v5, s[4:7], s34 offen sc1
    v_mfma_f32_16x16x32_bf16 v[56:59], v[24:27], v[180:183], 0
    v_mfma_f32_16x16x32_bf16 v[64:67], v[30:33], v[180:183], 0
    v_mfma_f32_16x16x32_bf16 v[60:63], v[26:29], v[180:183], 0
    v_mfma_f32_16x16x32_bf16 v[68:71], v[32:35], v[180:183], 0
    v_add_f32 v64, s43, v64
    v_rcp_f32 v64, v64
    s_nop 5
    v_add_f32 v68, s43, v68
    v_rcp_f32 v68, v68
    v_mul_f32 v56, v56, v64
    v_mul_f32 v57, v57, v64
    v_mul_f32 v58, v58, v64
    v_mul_f32 v59, v59, v64
    v_mul_f32 v60, v60, v68
    v_mul_f32 v61, v61, v68
    v_mul_f32 v62, v62, v68
    v_mul_f32 v63, v63, v68
    v_cvt_pk_bf16_f32 v76, v56, v57
    v_cvt_pk_bf16_f32 v77, v58, v59
    v_cvt_pk_bf16_f32 v78, v60, v61
    v_cvt_pk_bf16_f32 v79, v62, v63
    s_add_u32 s34, s34, 16384
    buffer_store_dwordx4 v[76:79], v5, s[4:7], s34 offen sc1
    v_mfma_f32_16x16x32_bf16 v[40:43], v[24:27], v[184:187], 0
    v_mfma_f32_16x16x32_bf16 v[48:51], v[30:33], v[184:187], 0
    v_mfma_f32_16x16x32_bf16 v[44:47], v[26:29], v[184:187], 0
    v_mfma_f32_16x16x32_bf16 v[52:55], v[32:35], v[184:187], 0
    v_add_f32 v48, s43, v48
    v_rcp_f32 v48, v48
    s_nop 5
    v_add_f32 v52, s43, v52
    v_rcp_f32 v52, v52
    v_mul_f32 v40, v40, v48
    v_mul_f32 v41, v41, v48
    v_mul_f32 v42, v42, v48
    v_mul_f32 v43, v43, v48
    v_mul_f32 v44, v44, v52
    v_mul_f32 v45, v45, v52
    v_mul_f32 v46, v46, v52
    v_mul_f32 v47, v47, v52
    v_cvt_pk_bf16_f32 v80, v40, v41
    v_cvt_pk_bf16_f32 v81, v42, v43
    v_cvt_pk_bf16_f32 v82, v44, v45
    v_cvt_pk_bf16_f32 v83, v46, v47
    s_add_u32 s34, s34, 16384
    buffer_store_dwordx4 v[80:83], v5, s[4:7], s34 offen sc1
    v_mfma_f32_16x16x32_bf16 v[56:59], v[24:27], v[188:191], 0
    v_mfma_f32_16x16x32_bf16 v[64:67], v[30:33], v[188:191], 0
    v_mfma_f32_16x16x32_bf16 v[60:63], v[26:29], v[188:191], 0
    v_mfma_f32_16x16x32_bf16 v[68:71], v[32:35], v[188:191], 0
    v_add_f32 v64, s43, v64
    v_rcp_f32 v64, v64
    s_nop 5
    v_add_f32 v68, s43, v68
    v_rcp_f32 v68, v68
    v_mul_f32 v56, v56, v64
    v_mul_f32 v57, v57, v64
    v_mul_f32 v58, v58, v64
    v_mul_f32 v59, v59, v64
    v_mul_f32 v60, v60, v68
    v_mul_f32 v61, v61, v68
    v_mul_f32 v62, v62, v68
    v_mul_f32 v63, v63, v68
    v_cvt_pk_bf16_f32 v84, v56, v57
    v_cvt_pk_bf16_f32 v85, v58, v59
    v_cvt_pk_bf16_f32 v86, v60, v61
    v_cvt_pk_bf16_f32 v87, v62, v63
    s_add_u32 s34, s34, 16384
    buffer_store_dwordx4 v[84:87], v5, s[4:7], s34 offen sc1
    s_waitcnt vmcnt(0)
    s_barrier
    s_cmp_lg_u32 s24, 0
    s_cbranch_scc1 L_wa_f2
    s_lshl_b32 s34, s29, 7
    s_lshl_b32 s35, s28, 2
    s_add_u32 s34, s34, s35
    s_add_u32 s34, s34, 21504
    v_mov_b32 v14, s34
    v_mov_b32 v15, 1
    s_mov_b64 exec, 1
    buffer_store_dword v15, v14, s[4:7], 0 offen offset:0 sc1
    s_mov_b64 exec, -1
L_wa_f2:
    v_and_b32 v14, 3, v0
    v_lshlrev_b32 v14, 2, v14
    s_lshl_b32 s34, s29, 7
    s_add_u32 s34, s34, 21504
L_poll_17:
    buffer_load_dword v15, v14, s[4:7], s34 offen offset:0 sc1
    s_waitcnt vmcnt(0)
    v_cmp_ne_u32 vcc, 1, v15
    s_cbranch_vccz L_polld_18
    s_sub_u32 s27, s27, 1
    s_cbranch_scc1 L_exit
    s_sleep 4
    s_branch L_poll_17
L_polld_18:
    v_and_b32 v14, 15, v0
    v_lshrrev_b32 v15, 4, v0
    v_lshlrev_b32 v17, 11, v14
    v_lshl_add_u32 v17, v15, 4, v17
    s_lshl_b32 s34, s28, 8
    s_lshl_b32 s35, s24, 6
    s_add_u32 s34, s34, s35
    v_add_u32 v17, s34, v17
    s_lshl_b32 s44, s29, 18
    s_add_u32 s44, s44, 4194304
    s_lshl_b32 s45, s29, 19
    s_mov_b32 s41, 0
L_wa_p3:
    buffer_load_dwordx4 v[128:131], v5, s[4:7], s44 offen offset:0 sc1
    buffer_load_dwordx4 v[132:135], v5, s[4:7], s44 offen offset:1024 sc1
    buffer_load_dwordx4 v[136:139], v5, s[4:7], s44 offen offset:2048 sc1
    buffer_load_dwordx4 v[140:143], v5, s[4:7], s44 offen offset:3072 sc1
    s_add_u32 s44, s44, 4096
    buffer_load_dwordx4 v[144:147], v5, s[4:7], s44 offen offset:0 sc1
    buffer_load_dwordx4 v[148:151], v5, s[4:7], s44 offen offset:1024 sc1
    buffer_load_dwordx4 v[152:155], v5, s[4:7], s44 offen offset:2048 sc1
    buffer_load_dwordx4 v[156:159], v5, s[4:7], s44 offen offset:3072 sc1
    s_add_u32 s44, s44, 4096
    buffer_load_dwordx4 v[160:163], v5, s[4:7], s44 offen offset:0 sc1
    buffer_load_dwordx4 v[164:167], v5, s[4:7], s44 offen offset:1024 sc1
    buffer_load_dwordx4 v[168:171], v5, s[4:7], s44 offen offset:2048 sc1
    buffer_load_dwordx4 v[172:175], v5, s[4:7], s44 offen offset:3072 sc1
    s_add_u32 s44, s44, 4096
    buffer_load_dwordx4 v[176:179], v5, s[4:7], s44 offen offset:0 sc1
    buffer_load_dwordx4 v[180:183], v5, s[4:7], s44 offen offset:1024 sc1
    buffer_load_dwordx4 v[184:187], v5, s[4:7], s44 offen offset:2048 sc1
    buffer_load_dwordx4 v[188:191], v5, s[4:7], s44 offen offset:3072 sc1
    s_add_u32 s44, s44, 4096
    buffer_load_dwordx4 v[192:195], v5, s[4:7], s44 offen offset:0 sc1
    buffer_load_dwordx4 v[196:199], v5, s[4:7], s44 offen offset:1024 sc1
    buffer_load_dwordx4 v[200:203], v5, s[4:7], s44 offen offset:2048 sc1
    buffer_load_dwordx4 v[204:207], v5, s[4:7], s44 offen offset:3072 sc1
    s_add_u32 s44, s44, 4096
    buffer_load_dwordx4 v[208:211], v5, s[4:7], s44 offen offset:0 sc1
    buffer_load_dwordx4 v[212:215], v5, s[4:7], s44 offen offset:1024 sc1
    buffer_load_dwordx4 v[216:219], v5, s[4:7], s44 offen offset:2048 sc1
    buffer_load_dwordx4 v[220:223], v5, s[4:7], s44 offen offset:3072 sc1
    s_add_u32 s44, s44, 4096
    buffer_load_dwordx4 v[224:227], v5, s[4:7], s44 offen offset:0 sc1
    buffer_load_dwordx4 v[228:231], v5, s[4:7], s44 offen offset:1024 sc1
    buffer_load_dwordx4 v[232:235], v5, s[4:7], s44 offen offset:2048 sc1
    buffer_load_dwordx4 v[236:239], v5, s[4:7], s44 offen offset:3072 sc1
    s_add_u32 s44, s44, 4096
    buffer_load_dwordx4 v[240:243], v5, s[4:7], s44 offen offset:0 sc1
    buffer_load_dwordx4 v[244:247], v5, s[4:7], s44 offen offset:1024 sc1
    buffer_load_dwordx4 v[248:251], v5, s[4:7], s44 offen offset:2048 sc1
    buffer_load_dwordx4 v[252:255], v5, s[4:7], s44 offen offset:3072 sc1
    s_add_u32 s44, s44, 4096
    s_waitcnt vmcnt(31)
    v_mfma_f32_16x16x32_bf16 v[40:43], a[0:3], v[128:131], 0
    v_mfma_f32_16x16x32_bf16 v[44:47], a[8:11], v[128:131], 0
    s_waitcnt vmcnt(30)
    v_mfma_f32_16x16x32_bf16 v[40:43], a[4:7], v[132:135], v[40:43]
    v_mfma_f32_16x16x32_bf16 v[44:47], a[12:15], v[132:135], v[44:47]
    s_waitcnt vmcnt(29)
    v_mfma_f32_16x16x32_bf16 v[40:43], a[16:19], v[136:139], v[40:43]
    v_mfma_f32_16x16x32_bf16 v[44:47], a[24:27], v[136:139], v[44:47]
    s_waitcnt vmcnt(28)
    v_mfma_f32_16x16x32_bf16 v[40:43], a[20:23], v[140:143], v[40:43]
    v_mfma_f32_16x16x32_bf16 v[44:47], a[28:31], v[140:143], v[44:47]
    s_waitcnt vmcnt(27)
    v_mfma_f32_16x16x32_bf16 v[40:43], a[32:35], v[144:147], v[40:43]
    v_mfma_f32_16x16x32_bf16 v[44:47], a[40:43], v[144:147], v[44:47]
    s_waitcnt vmcnt(26)
    v_mfma_f32_16x16x32_bf16 v[40:43], a[36:39], v[148:151], v[40:43]
    v_mfma_f32_16x16x32_bf16 v[44:47], a[44:47], v[148:151], v[44:47]
    s_waitcnt vmcnt(25)
    v_mfma_f32_16x16x32_bf16 v[40:43], a[48:51], v[152:155], v[40:43]
    v_mfma_f32_16x16x32_bf16 v[44:47], a[56:59], v[152:155], v[44:47]
    s_waitcnt vmcnt(24)
    v_mfma_f32_16x16x32_bf16 v[40:43], a[52:55], v[156:159], v[40:43]
    v_mfma_f32_16x16x32_bf16 v[44:47], a[60:63], v[156:159], v[44:47]
    s_waitcnt vmcnt(23)
    v_mfma_f32_16x16x32_bf16 v[40:43], a[64:67], v[160:163], v[40:43]
    v_mfma_f32_16x16x32_bf16 v[44:47], a[72:75], v[160:163], v[44:47]
    s_waitcnt vmcnt(22)
    v_mfma_f32_16x16x32_bf16 v[40:43], a[68:71], v[164:167], v[40:43]
    v_mfma_f32_16x16x32_bf16 v[44:47], a[76:79], v[164:167], v[44:47]
    s_waitcnt vmcnt(21)
    v_mfma_f32_16x16x32_bf16 v[40:43], a[80:83], v[168:171], v[40:43]
    v_mfma_f32_16x16x32_bf16 v[44:47], a[88:91], v[168:171], v[44:47]
    s_waitcnt vmcnt(20)
    v_mfma_f32_16x16x32_bf16 v[40:43], a[84:87], v[172:175], v[40:43]
    v_mfma_f32_16x16x32_bf16 v[44:47], a[92:95], v[172:175], v[44:47]
    s_waitcnt vmcnt(19)
    v_mfma_f32_16x16x32_bf16 v[40:43], a[96:99], v[176:179], v[40:43]
    v_mfma_f32_16x16x32_bf16 v[44:47], a[104:107], v[176:179], v[44:47]
    s_waitcnt vmcnt(18)
    v_mfma_f32_16x16x32_bf16 v[40:43], a[100:103], v[180:183], v[40:43]
    v_mfma_f32_16x16x32_bf16 v[44:47], a[108:111], v[180:183], v[44:47]
    s_waitcnt vmcnt(17)
    v_mfma_f32_16x16x32_bf16 v[40:43], a[112:115], v[184:187], v[40:43]
    v_mfma_f32_16x16x32_bf16 v[44:47], a[120:123], v[184:187], v[44:47]
    s_waitcnt vmcnt(16)
    v_mfma_f32_16x16x32_bf16 v[40:43], a[116:119], v[188:191], v[40:43]
    v_mfma_f32_16x16x32_bf16 v[44:47], a[124:127], v[188:191], v[44:47]
    s_waitcnt vmcnt(15)
    v_mfma_f32_16x16x32_bf16 v[48:51], a[0:3], v[192:195], 0
    v_mfma_f32_16x16x32_bf16 v[52:55], a[8:11], v[192:195], 0
    s_waitcnt vmcnt(14)
    v_mfma_f32_16x16x32_bf16 v[48:51], a[4:7], v[196:199], v[48:51]
    v_mfma_f32_16x16x32_bf16 v[52:55], a[12:15], v[196:199], v[52:55]
    s_waitcnt vmcnt(13)
    v_mfma_f32_16x16x32_bf16 v[48:51], a[16:19], v[200:203], v[48:51]
    v_mfma_f32_16x16x32_bf16 v[52:55], a[24:27], v[200:203], v[52:55]
    s_waitcnt vmcnt(12)
    v_mfma_f32_16x16x32_bf16 v[48:51], a[20:23], v[204:207], v[48:51]
    v_mfma_f32_16x16x32_bf16 v[52:55], a[28:31], v[204:207], v[52:55]
    s_waitcnt vmcnt(11)
    v_mfma_f32_16x16x32_bf16 v[48:51], a[32:35], v[208:211], v[48:51]
    v_mfma_f32_16x16x32_bf16 v[52:55], a[40:43], v[208:211], v[52:55]
    s_waitcnt vmcnt(10)
    v_mfma_f32_16x16x32_bf16 v[48:51], a[36:39], v[212:215], v[48:51]
    v_mfma_f32_16x16x32_bf16 v[52:55], a[44:47], v[212:215], v[52:55]
    s_waitcnt vmcnt(9)
    v_mfma_f32_16x16x32_bf16 v[48:51], a[48:51], v[216:219], v[48:51]
    v_mfma_f32_16x16x32_bf16 v[52:55], a[56:59], v[216:219], v[52:55]
    s_waitcnt vmcnt(8)
    v_mfma_f32_16x16x32_bf16 v[48:51], a[52:55], v[220:223], v[48:51]
    v_mfma_f32_16x16x32_bf16 v[52:55], a[60:63], v[220:223], v[52:55]
    s_waitcnt vmcnt(7)
    v_mfma_f32_16x16x32_bf16 v[48:51], a[64:67], v[224:227], v[48:51]
    v_mfma_f32_16x16x32_bf16 v[52:55], a[72:75], v[224:227], v[52:55]
    s_waitcnt vmcnt(6)
    v_mfma_f32_16x16x32_bf16 v[48:51], a[68:71], v[228:231], v[48:51]
    v_mfma_f32_16x16x32_bf16 v[52:55], a[76:79], v[228:231], v[52:55]
    s_waitcnt vmcnt(5)
    v_mfma_f32_16x16x32_bf16 v[48:51], a[80:83], v[232:235], v[48:51]
    v_mfma_f32_16x16x32_bf16 v[52:55], a[88:91], v[232:235], v[52:55]
    s_waitcnt vmcnt(4)
    v_mfma_f32_16x16x32_bf16 v[48:51], a[84:87], v[236:239], v[48:51]
    v_mfma_f32_16x16x32_bf16 v[52:55], a[92:95], v[236:239], v[52:55]
    s_waitcnt vmcnt(3)
    v_mfma_f32_16x16x32_bf16 v[48:51], a[96:99], v[240:243], v[48:51]
    v_mfma_f32_16x16x32_bf16 v[52:55], a[104:107], v[240:243], v[52:55]
    s_waitcnt vmcnt(2)
    v_mfma_f32_16x16x32_bf16 v[48:51], a[100:103], v[244:247], v[48:51]
    v_mfma_f32_16x16x32_bf16 v[52:55], a[108:111], v[244:247], v[52:55]
    s_waitcnt vmcnt(1)
    v_mfma_f32_16x16x32_bf16 v[48:51], a[112:115], v[248:251], v[48:51]
    v_mfma_f32_16x16x32_bf16 v[52:55], a[120:123], v[248:251], v[52:55]
    s_waitcnt vmcnt(0)
    v_mfma_f32_16x16x32_bf16 v[48:51], a[116:119], v[252:255], v[48:51]
    v_mfma_f32_16x16x32_bf16 v[52:55], a[124:127], v[252:255], v[52:55]
    v_cvt_pk_bf16_f32 v56, v40, v41
    v_cvt_pk_bf16_f32 v57, v42, v43
    v_cvt_pk_bf16_f32 v58, v44, v45
    v_cvt_pk_bf16_f32 v59, v46, v47
    buffer_store_dwordx4 v[56:59], v17, s[20:23], s45 offen sc1
    s_add_u32 s45, s45, 32768
    v_cvt_pk_bf16_f32 v60, v48, v49
    v_cvt_pk_bf16_f32 v61, v50, v51
    v_cvt_pk_bf16_f32 v62, v52, v53
    v_cvt_pk_bf16_f32 v63, v54, v55
    buffer_store_dwordx4 v[60:63], v17, s[20:23], s45 offen sc1
    s_add_u32 s45, s45, 32768
    s_add_u32 s41, s41, 1
    s_cmp_lt_u32 s41, 8
    s_cbranch_scc1 L_wa_p3
    s_waitcnt vmcnt(0)
    s_endpgm
.section .rodata,"a"
.p2align 6
.amdhsa_kernel concat_heads__linear_attn_block__memory_aug_recurrent_mem_tr__prompt_kernel
  .amdhsa_next_free_vgpr 512
  .amdhsa_next_free_sgpr 96
  .amdhsa_accum_offset 256
  .amdhsa_group_segment_fixed_size 0
  .amdhsa_kernarg_size 104
  .amdhsa_user_sgpr_count 2
  .amdhsa_user_sgpr_kernarg_segment_ptr 1
  .amdhsa_system_sgpr_workgroup_id_x 1
  .amdhsa_float_denorm_mode_32 3
.end_amdhsa_kernel
```
